```python
import torch

def _softmax(x, axis=-1):
    return torch.softmax(x, dim=axis)
def _gelu(x):
    return torch.nn.functional.gelu(x, approximate="tanh")
def _silu(x):
    return torch.nn.functional.silu(x)
def _sigmoid(x):
    return torch.sigmoid(x)
def _layernorm(x, axis=-1, eps=1e-5):
    m = x.mean(dim=axis, keepdim=True)
    v = x.var(dim=axis, keepdim=True, unbiased=False)
    return (x - m) / torch.sqrt(v + eps)
def _scatter_add(tgt, idx, src, axis=0):
    return tgt.clone().index_add_(axis, idx, src)
def _segment_sum(src, seg, n):
    out = torch.zeros((n,) + src.shape[1:], dtype=src.dtype)
    return out.index_add_(0, seg, src)
def _pad(x, pw):
    flat = tuple(v for pair in reversed(pw) for v in pair)
    return torch.nn.functional.pad(x, flat)

kernel_name = 'gated_mix__mha_block__sliding_local_dilated__prompt'

def setup_inputs():

    _w = (lambda a: (lambda t: t.to(torch.bfloat16) if t.is_floating_point() else t)(torch.as_tensor(a)))
    def _A_setup():
        B, S, D, H = 1, 2048, 1024, 32
        return {
            "x": _w((lambda *s: torch.randn(*s, dtype=torch.bfloat16) * 0.05)(B, S, D)),
            "wqkv": _w((lambda *s: torch.randn(*s, dtype=torch.bfloat16) * 0.8)(D, 3 * D)),
            "wo": _w((lambda *s: torch.randn(*s, dtype=torch.bfloat16) * 0.1)(D, D)),
        }
    _A_in = _A_setup()

    def _B_setup():
        B, S, D = 1, 2048, 1024
        return {
            "x": _w((lambda *s: torch.randn(*s, dtype=torch.bfloat16) * 0.05)(B, S, D)),
            "wqkv": _w((lambda *s: torch.randn(*s, dtype=torch.bfloat16) * 0.8)(D, 3 * D)),
            "wo": _w((lambda *s: torch.randn(*s, dtype=torch.bfloat16) * 0.05)(D, D)),
        }
    _B_in = _B_setup()

    return {
        "A_x": _A_in["x"],
        "A_wqkv": _A_in["wqkv"],
        "A_wo": _A_in["wo"],
        "B_x": _B_in["x"],
        "B_wqkv": _B_in["wqkv"],
        "B_wo": _B_in["wo"],
        "gate_w": _w((lambda *s: torch.randn(*s, dtype=torch.bfloat16) * 0.05)(1024) * 16.0),
    }

def reference(A_x, A_wqkv, A_wo, B_x, B_wqkv, B_wo, gate_w):
    def _A_ref(x, wqkv, wo):
        B, S, D = x.shape
        H = 32
        Dh = D // H
        qkv = (lambda x, *d: x.permute(*d))((x @ wqkv).reshape(B, S, 3, H, Dh), 2, 0, 3, 1, 4)
        q, k, v = qkv[0], qkv[1], qkv[2]
        scores = torch.einsum("bhqd,bhkd->bhqk", q, k) * (Dh ** -0.5)
        p = _softmax(scores, axis=-1)
        o = torch.einsum("bhqk,bhkd->bhqd", p, v)
        return (lambda x, *d: x.permute(*d))(o, 0, 2, 1, 3).reshape(B, S, D) @ wo

    def _B_ref(x, wqkv, wo):
        B, S, D = x.shape
        H = 32; Dh = D // H
        W, dil = 8, 2
        qkv = (lambda x, *d: x.permute(*d))((x @ wqkv).reshape(B, S, 3, H, Dh), 2, 0, 3, 1, 4)
        q, k, v = qkv[0], qkv[1], qkv[2]
        scale = Dh ** -0.5
        pos = torch.arange(S)
        off = torch.arange(W) * dil
        idx = pos[:, None] - off[None, :]
        mask = idx >= 0
        idx_c = torch.where(mask, idx, 0).reshape(-1)
        kg = k[:, :, idx_c, :].reshape(B, H, S, W, Dh)
        vg = v[:, :, idx_c, :].reshape(B, H, S, W, Dh)
        logits = torch.einsum("bhsd,bhswd->bhsw", q, kg) * scale
        logits = torch.where(mask[None, None, :, :], logits, -1e9)
        attn = _softmax(logits, axis=-1)
        o = torch.einsum("bhsw,bhswd->bhsd", attn, vg)
        return (lambda x, *d: x.permute(*d))(o, 0, 2, 1, 3).reshape(B, S, D) @ wo

    x = A_x
    g = _sigmoid((x * gate_w).sum(-1, keepdims=True))
    a = _A_ref(x, A_wqkv, A_wo)
    b = _B_ref(x, B_wqkv, B_wo)
    return g * a + (1 - g) * b
```

```asm
; @launch kernel=qkv_kernel grid=(256,1,1) block=(512,1,1) lds=159744
; @launch kernel=att_kernel grid=(256,1,1) block=(512,1,1) lds=131072
; @launch kernel=proj_kernel grid=(256,1,1) block=(256,1,1) lds=65536
.amdgcn_target "amdgcn-amd-amdhsa--gfx950"
.text
.globl qkv_kernel
.p2align 8
.type qkv_kernel,@function
qkv_kernel:
  s_cmp_lt_u32 s2, 256
  s_cbranch_scc1 L_qkv_kernel_go
  s_endpgm
L_qkv_kernel_go:
  s_load_dwordx4 s[4:7], s[0:1], 0
  s_load_dwordx2 s[38:39], s[0:1], 32
  s_load_dwordx2 s[34:35], s[0:1], 72
  s_load_dwordx2 s[32:33], s[0:1], 48
  v_and_b32 v1, 63, v0
  v_lshrrev_b32 v2, 6, v0
  s_and_b32 s48, s2, 7
  v_readfirstlane_b32 s20, v2
  s_lshr_b32 s3, s2, 3
  s_and_b32 s23, s3, 7
  s_lshr_b32 s3, s3, 3
  s_and_b32 s25, s3, 1
  s_lshr_b32 s24, s3, 1
  s_lshl_b32 s48, s48, 1
  s_add_u32 s24, s24, s48
  s_cmp_lt_u32 s20, 2
  s_cbranch_scc0 L_qkv_kernel_npf
  s_getpc_b64 s[40:41]
L_qkv_kernel_pc:
  s_lshr_b32 s42, s2, 3
  s_and_b32 s42, s42, 3
  s_mul_i32 s42, s42, 16384
  v_lshlrev_b32 v60, 7, v0
  v_add_u32 v60, s42, v60
  v_min_u32 v60, att_kernel - L_qkv_kernel_pc - 4, v60
  v_mov_b32 v61, s41
  v_add_co_u32 v60, vcc, s40, v60
  s_nop 1
  v_addc_co_u32 v61, vcc, 0, v61, vcc
  global_load_dword v62, v[60:61], off
L_qkv_kernel_npf:
  s_cmp_eq_u32 s20, 7
  s_cbranch_scc1 L_qkv_kernel_gate
  s_cmp_eq_u32 s20, 6
  s_cbranch_scc1 L_qkv_kernel_wl
  s_cmp_ge_u32 s20, 4
  s_cbranch_scc1 L_qkv_kernel_xl
  s_lshr_b32 s21, s20, 1
  s_and_b32 s22, s20, 1
  v_and_b32 v8, 15, v1
  s_lshl_b32 s48, s21, 7
  v_add_u32 v8, s48, v8
  v_lshlrev_b32 v8, 7, v8
  v_lshrrev_b32 v9, 4, v1
  v_bfe_u32 v10, v1, 1, 3
  v_xor_b32 v9, v9, v10
  v_lshlrev_b32 v9, 4, v9
  v_add_u32 v2, v8, v9
  v_xor_b32 v9, 64, v9
  v_add_u32 v3, v8, v9
  v_lshrrev_b32 v8, 4, v1
  v_and_b32 v11, 1, v8
  v_mul_u32_u24 v8, 3072, v8
  v_bfe_u32 v9, v1, 2, 2
  v_lshlrev_b32 v10, 7, v9
  v_lshrrev_b32 v9, 1, v9
  v_xor_b32 v9, s22, v9
  v_lshlrev_b32 v9, 6, v9
  v_add3_u32 v8, v8, v9, v10
  v_and_b32 v10, 3, v1
  v_lshlrev_b32 v10, 3, v10
  v_lshlrev_b32 v11, 5, v11
  v_add_u32 v8, v8, v10
  v_add_u32 v8, 98304, v8
  v_add_u32 v4, v8, v11
  v_xor_b32 v11, 32, v11
  v_add_u32 v5, v8, v11
  v_and_b32 v8, 15, v1
  v_lshrrev_b32 v9, 5, v1
  v_lshlrev_b32 v9, 10, v9
  v_bfe_u32 v10, v1, 4, 1
  v_lshlrev_b32 v10, 9, v10
  v_add_u32 v9, v9, v10
  v_lshlrev_b32 v10, 4, v8
  v_add_u32 v6, v9, v10
  v_and_b32 v10, 7, v8
  v_lshlrev_b32 v10, 4, v10
  v_lshrrev_b32 v8, 3, v8
  v_lshlrev_b32 v8, 8, v8
  v_add3_u32 v7, v9, v10, v8
  s_lshl_b32 s49, s24, 1
  s_add_u32 s49, s49, s22
  s_lshl_b32 s53, s23, 3
  s_lshl_b32 s52, s21, 2
  s_add_u32 s53, s53, s52
  s_lshl_b32 s53, s53, 17
  s_add_u32 s52, s49, 32
  s_lshl_b32 s52, s52, 11
  s_add_u32 s53, s53, s52
  s_add_u32 s53, s53, 25165824
  s_mul_i32 s54, s49, 40960
  s_mul_i32 s52, s23, 5120
  s_add_u32 s54, s54, s52
  s_add_u32 s54, s54, 34603008
  v_and_b32 v8, 15, v1
  v_lshrrev_b32 v9, 4, v1
  v_lshlrev_b32 v9, 2, v9
  v_sub_u32 v8, v8, v9
  v_and_b32 v9, 1, v8
  v_cmp_eq_u32 s[56:57], 0, v9
  v_cmp_eq_u32 s[50:51], 1, v9
  v_cmp_le_i32 vcc, 0, v8
  s_nop 3
  s_and_b64 s[60:61], vcc, s[56:57]
  s_andn2_b64 s[62:63], s[56:57], vcc
  v_cmp_le_i32 vcc, 1, v8
  s_nop 3
  s_and_b64 s[64:65], vcc, s[50:51]
  s_andn2_b64 s[66:67], s[50:51], vcc
  v_cmp_le_i32 vcc, 2, v8
  s_nop 3
  s_and_b64 s[68:69], vcc, s[56:57]
  s_andn2_b64 s[70:71], s[56:57], vcc
  v_cmp_le_i32 vcc, 3, v8
  s_nop 3
  s_and_b64 s[72:73], vcc, s[50:51]
  s_andn2_b64 s[74:75], s[50:51], vcc
  s_waitcnt lgkmcnt(0)
  s_cmp_eq_u32 s25, 0
  s_cselect_b32 s6, s6, s38
  s_cselect_b32 s7, s7, s39
  s_mov_b32 s8, s4
  s_and_b32 s9, s5, 0xffff
  s_mov_b32 s10, 0x400000
  s_mov_b32 s11, 0x20000
  s_mov_b32 s12, s6
  s_and_b32 s13, s7, 0xffff
  s_mov_b32 s14, 0x600000
  s_mov_b32 s15, 0x20000
  s_mov_b32 s16, s34
  s_and_b32 s17, s35, 0xffff
  s_mov_b32 s18, 0x3000000
  s_mov_b32 s19, 0x20000
  s_cmp_eq_u32 s25, 1
  s_cbranch_scc0 L_qkv_kernel_dry1
  s_mov_b64 exec, 0
  s_cmp_eq_u32 s20, 0
  s_cbranch_scc1 L_qkv_kernel_d0
  s_cmp_eq_u32 s20, 1
  s_cbranch_scc1 L_qkv_kernel_d1
  s_cmp_eq_u32 s20, 2
  s_cbranch_scc1 L_qkv_kernel_d2
  s_branch L_qkv_kernel_d3
L_qkv_kernel_dryret:
  s_mov_b64 exec, -1
L_qkv_kernel_dry1:
  s_waitcnt vmcnt(0)
  s_barrier
  ds_read_b128 v[8:11], v2 offset:0
  ds_read_b128 v[12:15], v2 offset:2048
  ds_read_b128 v[16:19], v2 offset:4096
  ds_read_b128 v[20:23], v2 offset:6144
  ds_read_b64_tr_b16 v[40:41], v4 offset:0
  ds_read_b64_tr_b16 v[42:43], v4 offset:1536
  ds_read_b64_tr_b16 v[44:45], v5 offset:0
  ds_read_b64_tr_b16 v[46:47], v5 offset:1536
  ds_read_b64_tr_b16 v[48:49], v4 offset:512
  ds_read_b64_tr_b16 v[50:51], v4 offset:2048
  ds_read_b64_tr_b16 v[52:53], v5 offset:512
  ds_read_b64_tr_b16 v[54:55], v5 offset:2048
  ds_read_b64_tr_b16 v[56:57], v4 offset:1024
  ds_read_b64_tr_b16 v[58:59], v4 offset:2560
L_qkv_kernel_st0:
  s_waitcnt lgkmcnt(8)
  v_mfma_f32_16x16x32_bf16 v[64:67], v[40:43], v[8:11], 0
  ds_read_b64_tr_b16 v[60:61], v5 offset:1024
  v_mfma_f32_16x16x32_bf16 v[88:91], v[40:43], v[12:15], 0
  ds_read_b64_tr_b16 v[62:63], v5 offset:2560
  v_mfma_f32_16x16x32_bf16 v[112:115], v[40:43], v[16:19], 0
  ds_read_b128 v[24:27], v2 offset:8192
  v_mfma_f32_16x16x32_bf16 v[136:139], v[40:43], v[20:23], 0
  ds_read_b128 v[28:31], v2 offset:10240
  s_waitcnt lgkmcnt(10)
  v_mfma_f32_16x16x32_bf16 v[68:71], v[44:47], v[8:11], 0
  ds_read_b128 v[32:35], v2 offset:12288
  v_mfma_f32_16x16x32_bf16 v[92:95], v[44:47], v[12:15], 0
  ds_read_b128 v[36:39], v2 offset:14336
  v_mfma_f32_16x16x32_bf16 v[116:119], v[44:47], v[16:19], 0
  v_mfma_f32_16x16x32_bf16 v[140:143], v[44:47], v[20:23], 0
  s_waitcnt lgkmcnt(10)
  v_mfma_f32_16x16x32_bf16 v[72:75], v[48:51], v[8:11], 0
  v_mfma_f32_16x16x32_bf16 v[96:99], v[48:51], v[12:15], 0
  v_mfma_f32_16x16x32_bf16 v[120:123], v[48:51], v[16:19], 0
  v_mfma_f32_16x16x32_bf16 v[144:147], v[48:51], v[20:23], 0
  s_waitcnt lgkmcnt(8)
  v_mfma_f32_16x16x32_bf16 v[76:79], v[52:55], v[8:11], 0
  v_mfma_f32_16x16x32_bf16 v[100:103], v[52:55], v[12:15], 0
  v_mfma_f32_16x16x32_bf16 v[124:127], v[52:55], v[16:19], 0
  v_mfma_f32_16x16x32_bf16 v[148:151], v[52:55], v[20:23], 0
  s_waitcnt lgkmcnt(6)
  v_mfma_f32_16x16x32_bf16 v[80:83], v[8:11], v[56:59], 0
  v_mfma_f32_16x16x32_bf16 v[104:107], v[12:15], v[56:59], 0
  v_mfma_f32_16x16x32_bf16 v[128:131], v[16:19], v[56:59], 0
  v_mfma_f32_16x16x32_bf16 v[152:155], v[20:23], v[56:59], 0
  s_waitcnt lgkmcnt(4)
  v_mfma_f32_16x16x32_bf16 v[84:87], v[8:11], v[60:63], 0
  v_mfma_f32_16x16x32_bf16 v[108:111], v[12:15], v[60:63], 0
  v_mfma_f32_16x16x32_bf16 v[132:135], v[16:19], v[60:63], 0
  v_mfma_f32_16x16x32_bf16 v[156:159], v[20:23], v[60:63], 0
  s_waitcnt lgkmcnt(0)
  s_barrier
  v_mfma_f32_16x16x32_bf16 v[160:163], v[40:43], v[24:27], 0
  ds_read_b128 v[8:11], v3 offset:0
  v_mfma_f32_16x16x32_bf16 v[184:187], v[40:43], v[28:31], 0
  ds_read_b128 v[12:15], v3 offset:2048
  v_mfma_f32_16x16x32_bf16 v[208:211], v[40:43], v[32:35], 0
  ds_read_b128 v[16:19], v3 offset:4096
  v_mfma_f32_16x16x32_bf16 v[232:235], v[40:43], v[36:39], 0
  ds_read_b128 v[20:23], v3 offset:6144
  v_mfma_f32_16x16x32_bf16 v[164:167], v[44:47], v[24:27], 0
  v_add_u32 v4, 0x3000, v4
  ds_read_b64_tr_b16 v[40:41], v4 offset:0
  v_mfma_f32_16x16x32_bf16 v[188:191], v[44:47], v[28:31], 0
  ds_read_b64_tr_b16 v[42:43], v4 offset:1536
  v_mfma_f32_16x16x32_bf16 v[212:215], v[44:47], v[32:35], 0
  v_mfma_f32_16x16x32_bf16 v[236:239], v[44:47], v[36:39], 0
  v_mfma_f32_16x16x32_bf16 v[168:171], v[48:51], v[24:27], 0
  v_add_u32 v5, 0x3000, v5
  ds_read_b64_tr_b16 v[44:45], v5 offset:0
  v_mfma_f32_16x16x32_bf16 v[192:195], v[48:51], v[28:31], 0
  ds_read_b64_tr_b16 v[46:47], v5 offset:1536
  v_mfma_f32_16x16x32_bf16 v[216:219], v[48:51], v[32:35], 0
  v_mfma_f32_16x16x32_bf16 v[240:243], v[48:51], v[36:39], 0
  v_mfma_f32_16x16x32_bf16 v[172:175], v[52:55], v[24:27], 0
  ds_read_b64_tr_b16 v[48:49], v4 offset:512
  v_mfma_f32_16x16x32_bf16 v[196:199], v[52:55], v[28:31], 0
  ds_read_b64_tr_b16 v[50:51], v4 offset:2048
  v_mfma_f32_16x16x32_bf16 v[220:223], v[52:55], v[32:35], 0
  v_mfma_f32_16x16x32_bf16 v[244:247], v[52:55], v[36:39], 0
  v_mfma_f32_16x16x32_bf16 v[176:179], v[24:27], v[56:59], 0
  ds_read_b64_tr_b16 v[52:53], v5 offset:512
  v_mfma_f32_16x16x32_bf16 v[200:203], v[28:31], v[56:59], 0
  ds_read_b64_tr_b16 v[54:55], v5 offset:2048
  v_mfma_f32_16x16x32_bf16 v[224:227], v[32:35], v[56:59], 0
  v_mfma_f32_16x16x32_bf16 v[248:251], v[36:39], v[56:59], 0
  v_mfma_f32_16x16x32_bf16 v[180:183], v[24:27], v[60:63], 0
  ds_read_b64_tr_b16 v[56:57], v4 offset:1024
  v_mfma_f32_16x16x32_bf16 v[204:207], v[28:31], v[60:63], 0
  ds_read_b64_tr_b16 v[58:59], v4 offset:2560
  v_mfma_f32_16x16x32_bf16 v[228:231], v[32:35], v[60:63], 0
  v_mfma_f32_16x16x32_bf16 v[252:255], v[36:39], v[60:63], 0
L_qkv_kernel_st1:
  s_waitcnt lgkmcnt(8)
  v_mfma_f32_16x16x32_bf16 v[64:67], v[40:43], v[8:11], v[64:67]
  ds_read_b64_tr_b16 v[60:61], v5 offset:1024
  v_mfma_f32_16x16x32_bf16 v[88:91], v[40:43], v[12:15], v[88:91]
  ds_read_b64_tr_b16 v[62:63], v5 offset:2560
  v_mfma_f32_16x16x32_bf16 v[112:115], v[40:43], v[16:19], v[112:115]
  ds_read_b128 v[24:27], v3 offset:8192
  v_mfma_f32_16x16x32_bf16 v[136:139], v[40:43], v[20:23], v[136:139]
  ds_read_b128 v[28:31], v3 offset:10240
  s_waitcnt lgkmcnt(10)
  v_mfma_f32_16x16x32_bf16 v[68:71], v[44:47], v[8:11], v[68:71]
  ds_read_b128 v[32:35], v3 offset:12288
  v_mfma_f32_16x16x32_bf16 v[92:95], v[44:47], v[12:15], v[92:95]
  ds_read_b128 v[36:39], v3 offset:14336
  v_mfma_f32_16x16x32_bf16 v[116:119], v[44:47], v[16:19], v[116:119]
  v_mfma_f32_16x16x32_bf16 v[140:143], v[44:47], v[20:23], v[140:143]
  s_waitcnt lgkmcnt(10)
  v_mfma_f32_16x16x32_bf16 v[72:75], v[48:51], v[8:11], v[72:75]
  v_mfma_f32_16x16x32_bf16 v[96:99], v[48:51], v[12:15], v[96:99]
  v_mfma_f32_16x16x32_bf16 v[120:123], v[48:51], v[16:19], v[120:123]
  v_mfma_f32_16x16x32_bf16 v[144:147], v[48:51], v[20:23], v[144:147]
  s_waitcnt lgkmcnt(8)
  v_mfma_f32_16x16x32_bf16 v[76:79], v[52:55], v[8:11], v[76:79]
  v_mfma_f32_16x16x32_bf16 v[100:103], v[52:55], v[12:15], v[100:103]
  v_mfma_f32_16x16x32_bf16 v[124:127], v[52:55], v[16:19], v[124:127]
  v_mfma_f32_16x16x32_bf16 v[148:151], v[52:55], v[20:23], v[148:151]
  s_waitcnt lgkmcnt(6)
  v_mfma_f32_16x16x32_bf16 v[80:83], v[8:11], v[56:59], v[80:83]
  v_mfma_f32_16x16x32_bf16 v[104:107], v[12:15], v[56:59], v[104:107]
  v_mfma_f32_16x16x32_bf16 v[128:131], v[16:19], v[56:59], v[128:131]
  v_mfma_f32_16x16x32_bf16 v[152:155], v[20:23], v[56:59], v[152:155]
  s_waitcnt lgkmcnt(4)
  v_mfma_f32_16x16x32_bf16 v[84:87], v[8:11], v[60:63], v[84:87]
  v_mfma_f32_16x16x32_bf16 v[108:111], v[12:15], v[60:63], v[108:111]
  v_mfma_f32_16x16x32_bf16 v[132:135], v[16:19], v[60:63], v[132:135]
  v_mfma_f32_16x16x32_bf16 v[156:159], v[20:23], v[60:63], v[156:159]
  s_waitcnt lgkmcnt(0)
  s_barrier
  v_mfma_f32_16x16x32_bf16 v[160:163], v[40:43], v[24:27], v[160:163]
  v_add_u32 v2, 0x8000, v2
  ds_read_b128 v[8:11], v2 offset:0
  v_mfma_f32_16x16x32_bf16 v[184:187], v[40:43], v[28:31], v[184:187]
  ds_read_b128 v[12:15], v2 offset:2048
  v_mfma_f32_16x16x32_bf16 v[208:211], v[40:43], v[32:35], v[208:211]
  ds_read_b128 v[16:19], v2 offset:4096
  v_mfma_f32_16x16x32_bf16 v[232:235], v[40:43], v[36:39], v[232:235]
  ds_read_b128 v[20:23], v2 offset:6144
  v_mfma_f32_16x16x32_bf16 v[164:167], v[44:47], v[24:27], v[164:167]
  v_add_u32 v4, 0x3000, v4
  ds_read_b64_tr_b16 v[40:41], v4 offset:0
  v_mfma_f32_16x16x32_bf16 v[188:191], v[44:47], v[28:31], v[188:191]
  ds_read_b64_tr_b16 v[42:43], v4 offset:1536
  v_mfma_f32_16x16x32_bf16 v[212:215], v[44:47], v[32:35], v[212:215]
  v_mfma_f32_16x16x32_bf16 v[236:239], v[44:47], v[36:39], v[236:239]
  v_mfma_f32_16x16x32_bf16 v[168:171], v[48:51], v[24:27], v[168:171]
  v_add_u32 v5, 0x3000, v5
  ds_read_b64_tr_b16 v[44:45], v5 offset:0
  v_mfma_f32_16x16x32_bf16 v[192:195], v[48:51], v[28:31], v[192:195]
  ds_read_b64_tr_b16 v[46:47], v5 offset:1536
  v_mfma_f32_16x16x32_bf16 v[216:219], v[48:51], v[32:35], v[216:219]
  v_mfma_f32_16x16x32_bf16 v[240:243], v[48:51], v[36:39], v[240:243]
  v_mfma_f32_16x16x32_bf16 v[172:175], v[52:55], v[24:27], v[172:175]
  ds_read_b64_tr_b16 v[48:49], v4 offset:512
  v_mfma_f32_16x16x32_bf16 v[196:199], v[52:55], v[28:31], v[196:199]
  ds_read_b64_tr_b16 v[50:51], v4 offset:2048
  v_mfma_f32_16x16x32_bf16 v[220:223], v[52:55], v[32:35], v[220:223]
  v_mfma_f32_16x16x32_bf16 v[244:247], v[52:55], v[36:39], v[244:247]
  v_mfma_f32_16x16x32_bf16 v[176:179], v[24:27], v[56:59], v[176:179]
  ds_read_b64_tr_b16 v[52:53], v5 offset:512
  v_mfma_f32_16x16x32_bf16 v[200:203], v[28:31], v[56:59], v[200:203]
  ds_read_b64_tr_b16 v[54:55], v5 offset:2048
  v_mfma_f32_16x16x32_bf16 v[224:227], v[32:35], v[56:59], v[224:227]
  v_mfma_f32_16x16x32_bf16 v[248:251], v[36:39], v[56:59], v[248:251]
  v_mfma_f32_16x16x32_bf16 v[180:183], v[24:27], v[60:63], v[180:183]
  ds_read_b64_tr_b16 v[56:57], v4 offset:1024
  v_mfma_f32_16x16x32_bf16 v[204:207], v[28:31], v[60:63], v[204:207]
  ds_read_b64_tr_b16 v[58:59], v4 offset:2560
  v_mfma_f32_16x16x32_bf16 v[228:231], v[32:35], v[60:63], v[228:231]
  v_mfma_f32_16x16x32_bf16 v[252:255], v[36:39], v[60:63], v[252:255]
L_qkv_kernel_st2:
  s_waitcnt lgkmcnt(8)
  v_mfma_f32_16x16x32_bf16 v[64:67], v[40:43], v[8:11], v[64:67]
  ds_read_b64_tr_b16 v[60:61], v5 offset:1024
  v_mfma_f32_16x16x32_bf16 v[88:91], v[40:43], v[12:15], v[88:91]
  ds_read_b64_tr_b16 v[62:63], v5 offset:2560
  v_mfma_f32_16x16x32_bf16 v[112:115], v[40:43], v[16:19], v[112:115]
  ds_read_b128 v[24:27], v2 offset:8192
  v_mfma_f32_16x16x32_bf16 v[136:139], v[40:43], v[20:23], v[136:139]
  ds_read_b128 v[28:31], v2 offset:10240
  s_waitcnt lgkmcnt(10)
  v_mfma_f32_16x16x32_bf16 v[68:71], v[44:47], v[8:11], v[68:71]
  ds_read_b128 v[32:35], v2 offset:12288
  v_mfma_f32_16x16x32_bf16 v[92:95], v[44:47], v[12:15], v[92:95]
  ds_read_b128 v[36:39], v2 offset:14336
  v_mfma_f32_16x16x32_bf16 v[116:119], v[44:47], v[16:19], v[116:119]
  v_mfma_f32_16x16x32_bf16 v[140:143], v[44:47], v[20:23], v[140:143]
  s_waitcnt lgkmcnt(10)
  v_mfma_f32_16x16x32_bf16 v[72:75], v[48:51], v[8:11], v[72:75]
  v_mfma_f32_16x16x32_bf16 v[96:99], v[48:51], v[12:15], v[96:99]
  v_mfma_f32_16x16x32_bf16 v[120:123], v[48:51], v[16:19], v[120:123]
  v_mfma_f32_16x16x32_bf16 v[144:147], v[48:51], v[20:23], v[144:147]
  s_waitcnt lgkmcnt(8)
  v_mfma_f32_16x16x32_bf16 v[76:79], v[52:55], v[8:11], v[76:79]
  v_mfma_f32_16x16x32_bf16 v[100:103], v[52:55], v[12:15], v[100:103]
  v_mfma_f32_16x16x32_bf16 v[124:127], v[52:55], v[16:19], v[124:127]
  v_mfma_f32_16x16x32_bf16 v[148:151], v[52:55], v[20:23], v[148:151]
  s_waitcnt lgkmcnt(6)
  v_mfma_f32_16x16x32_bf16 v[80:83], v[8:11], v[56:59], v[80:83]
  v_mfma_f32_16x16x32_bf16 v[104:107], v[12:15], v[56:59], v[104:107]
  v_mfma_f32_16x16x32_bf16 v[128:131], v[16:19], v[56:59], v[128:131]
  v_mfma_f32_16x16x32_bf16 v[152:155], v[20:23], v[56:59], v[152:155]
  s_waitcnt lgkmcnt(4)
  v_mfma_f32_16x16x32_bf16 v[84:87], v[8:11], v[60:63], v[84:87]
  v_mfma_f32_16x16x32_bf16 v[108:111], v[12:15], v[60:63], v[108:111]
  v_mfma_f32_16x16x32_bf16 v[132:135], v[16:19], v[60:63], v[132:135]
  v_mfma_f32_16x16x32_bf16 v[156:159], v[20:23], v[60:63], v[156:159]
  s_waitcnt lgkmcnt(0)
  s_barrier
  v_mfma_f32_16x16x32_bf16 v[160:163], v[40:43], v[24:27], v[160:163]
  v_add_u32 v3, 0x8000, v3
  ds_read_b128 v[8:11], v3 offset:0
  v_mfma_f32_16x16x32_bf16 v[184:187], v[40:43], v[28:31], v[184:187]
  ds_read_b128 v[12:15], v3 offset:2048
  v_mfma_f32_16x16x32_bf16 v[208:211], v[40:43], v[32:35], v[208:211]
  ds_read_b128 v[16:19], v3 offset:4096
  v_mfma_f32_16x16x32_bf16 v[232:235], v[40:43], v[36:39], v[232:235]
  ds_read_b128 v[20:23], v3 offset:6144
  v_mfma_f32_16x16x32_bf16 v[164:167], v[44:47], v[24:27], v[164:167]
  v_add_u32 v4, 0x3000, v4
  ds_read_b64_tr_b16 v[40:41], v4 offset:0
  v_mfma_f32_16x16x32_bf16 v[188:191], v[44:47], v[28:31], v[188:191]
  ds_read_b64_tr_b16 v[42:43], v4 offset:1536
  v_mfma_f32_16x16x32_bf16 v[212:215], v[44:47], v[32:35], v[212:215]
  v_mfma_f32_16x16x32_bf16 v[236:239], v[44:47], v[36:39], v[236:239]
  v_mfma_f32_16x16x32_bf16 v[168:171], v[48:51], v[24:27], v[168:171]
  v_add_u32 v5, 0x3000, v5
  ds_read_b64_tr_b16 v[44:45], v5 offset:0
  v_mfma_f32_16x16x32_bf16 v[192:195], v[48:51], v[28:31], v[192:195]
  ds_read_b64_tr_b16 v[46:47], v5 offset:1536
  v_mfma_f32_16x16x32_bf16 v[216:219], v[48:51], v[32:35], v[216:219]
  v_mfma_f32_16x16x32_bf16 v[240:243], v[48:51], v[36:39], v[240:243]
  v_mfma_f32_16x16x32_bf16 v[172:175], v[52:55], v[24:27], v[172:175]
  ds_read_b64_tr_b16 v[48:49], v4 offset:512
  v_mfma_f32_16x16x32_bf16 v[196:199], v[52:55], v[28:31], v[196:199]
  ds_read_b64_tr_b16 v[50:51], v4 offset:2048
  v_mfma_f32_16x16x32_bf16 v[220:223], v[52:55], v[32:35], v[220:223]
  v_mfma_f32_16x16x32_bf16 v[244:247], v[52:55], v[36:39], v[244:247]
  v_mfma_f32_16x16x32_bf16 v[176:179], v[24:27], v[56:59], v[176:179]
  ds_read_b64_tr_b16 v[52:53], v5 offset:512
  v_mfma_f32_16x16x32_bf16 v[200:203], v[28:31], v[56:59], v[200:203]
  ds_read_b64_tr_b16 v[54:55], v5 offset:2048
  v_mfma_f32_16x16x32_bf16 v[224:227], v[32:35], v[56:59], v[224:227]
  v_mfma_f32_16x16x32_bf16 v[248:251], v[36:39], v[56:59], v[248:251]
  v_mfma_f32_16x16x32_bf16 v[180:183], v[24:27], v[60:63], v[180:183]
  ds_read_b64_tr_b16 v[56:57], v4 offset:1024
  v_mfma_f32_16x16x32_bf16 v[204:207], v[28:31], v[60:63], v[204:207]
  ds_read_b64_tr_b16 v[58:59], v4 offset:2560
  v_mfma_f32_16x16x32_bf16 v[228:231], v[32:35], v[60:63], v[228:231]
  v_mfma_f32_16x16x32_bf16 v[252:255], v[36:39], v[60:63], v[252:255]
L_qkv_kernel_st3:
  s_waitcnt lgkmcnt(8)
  v_mfma_f32_16x16x32_bf16 v[64:67], v[40:43], v[8:11], v[64:67]
  ds_read_b64_tr_b16 v[60:61], v5 offset:1024
  v_mfma_f32_16x16x32_bf16 v[88:91], v[40:43], v[12:15], v[88:91]
  ds_read_b64_tr_b16 v[62:63], v5 offset:2560
  v_mfma_f32_16x16x32_bf16 v[112:115], v[40:43], v[16:19], v[112:115]
  ds_read_b128 v[24:27], v3 offset:8192
  v_mfma_f32_16x16x32_bf16 v[136:139], v[40:43], v[20:23], v[136:139]
  ds_read_b128 v[28:31], v3 offset:10240
  s_waitcnt lgkmcnt(10)
  v_mfma_f32_16x16x32_bf16 v[68:71], v[44:47], v[8:11], v[68:71]
  ds_read_b128 v[32:35], v3 offset:12288
  v_mfma_f32_16x16x32_bf16 v[92:95], v[44:47], v[12:15], v[92:95]
  ds_read_b128 v[36:39], v3 offset:14336
  v_mfma_f32_16x16x32_bf16 v[116:119], v[44:47], v[16:19], v[116:119]
  v_mfma_f32_16x16x32_bf16 v[140:143], v[44:47], v[20:23], v[140:143]
  s_waitcnt lgkmcnt(10)
  v_mfma_f32_16x16x32_bf16 v[72:75], v[48:51], v[8:11], v[72:75]
  v_mfma_f32_16x16x32_bf16 v[96:99], v[48:51], v[12:15], v[96:99]
  v_mfma_f32_16x16x32_bf16 v[120:123], v[48:51], v[16:19], v[120:123]
  v_mfma_f32_16x16x32_bf16 v[144:147], v[48:51], v[20:23], v[144:147]
  s_waitcnt lgkmcnt(8)
  v_mfma_f32_16x16x32_bf16 v[76:79], v[52:55], v[8:11], v[76:79]
  v_mfma_f32_16x16x32_bf16 v[100:103], v[52:55], v[12:15], v[100:103]
  v_mfma_f32_16x16x32_bf16 v[124:127], v[52:55], v[16:19], v[124:127]
  v_mfma_f32_16x16x32_bf16 v[148:151], v[52:55], v[20:23], v[148:151]
  s_waitcnt lgkmcnt(6)
  v_mfma_f32_16x16x32_bf16 v[80:83], v[8:11], v[56:59], v[80:83]
  v_mfma_f32_16x16x32_bf16 v[104:107], v[12:15], v[56:59], v[104:107]
  v_mfma_f32_16x16x32_bf16 v[128:131], v[16:19], v[56:59], v[128:131]
  v_mfma_f32_16x16x32_bf16 v[152:155], v[20:23], v[56:59], v[152:155]
  s_waitcnt lgkmcnt(4)
  v_mfma_f32_16x16x32_bf16 v[84:87], v[8:11], v[60:63], v[84:87]
  v_mfma_f32_16x16x32_bf16 v[108:111], v[12:15], v[60:63], v[108:111]
  v_mfma_f32_16x16x32_bf16 v[132:135], v[16:19], v[60:63], v[132:135]
  v_mfma_f32_16x16x32_bf16 v[156:159], v[20:23], v[60:63], v[156:159]
  s_waitcnt lgkmcnt(0)
  s_barrier
  v_mfma_f32_16x16x32_bf16 v[160:163], v[40:43], v[24:27], v[160:163]
  v_add_u32 v2, 0x8000, v2
  ds_read_b128 v[8:11], v2 offset:0
  v_mfma_f32_16x16x32_bf16 v[184:187], v[40:43], v[28:31], v[184:187]
  ds_read_b128 v[12:15], v2 offset:2048
  v_mfma_f32_16x16x32_bf16 v[208:211], v[40:43], v[32:35], v[208:211]
  ds_read_b128 v[16:19], v2 offset:4096
  v_mfma_f32_16x16x32_bf16 v[232:235], v[40:43], v[36:39], v[232:235]
  ds_read_b128 v[20:23], v2 offset:6144
  v_mfma_f32_16x16x32_bf16 v[164:167], v[44:47], v[24:27], v[164:167]
  v_add_u32 v4, 0x3000, v4
  ds_read_b64_tr_b16 v[40:41], v4 offset:0
  v_mfma_f32_16x16x32_bf16 v[188:191], v[44:47], v[28:31], v[188:191]
  ds_read_b64_tr_b16 v[42:43], v4 offset:1536
  v_mfma_f32_16x16x32_bf16 v[212:215], v[44:47], v[32:35], v[212:215]
  v_mfma_f32_16x16x32_bf16 v[236:239], v[44:47], v[36:39], v[236:239]
  v_mfma_f32_16x16x32_bf16 v[168:171], v[48:51], v[24:27], v[168:171]
  v_add_u32 v5, 0x3000, v5
  ds_read_b64_tr_b16 v[44:45], v5 offset:0
  v_mfma_f32_16x16x32_bf16 v[192:195], v[48:51], v[28:31], v[192:195]
  ds_read_b64_tr_b16 v[46:47], v5 offset:1536
  v_mfma_f32_16x16x32_bf16 v[216:219], v[48:51], v[32:35], v[216:219]
  v_mfma_f32_16x16x32_bf16 v[240:243], v[48:51], v[36:39], v[240:243]
  v_mfma_f32_16x16x32_bf16 v[172:175], v[52:55], v[24:27], v[172:175]
  ds_read_b64_tr_b16 v[48:49], v4 offset:512
  v_mfma_f32_16x16x32_bf16 v[196:199], v[52:55], v[28:31], v[196:199]
  ds_read_b64_tr_b16 v[50:51], v4 offset:2048
  v_mfma_f32_16x16x32_bf16 v[220:223], v[52:55], v[32:35], v[220:223]
  v_mfma_f32_16x16x32_bf16 v[244:247], v[52:55], v[36:39], v[244:247]
  v_mfma_f32_16x16x32_bf16 v[176:179], v[24:27], v[56:59], v[176:179]
  ds_read_b64_tr_b16 v[52:53], v5 offset:512
  v_mfma_f32_16x16x32_bf16 v[200:203], v[28:31], v[56:59], v[200:203]
  ds_read_b64_tr_b16 v[54:55], v5 offset:2048
  v_mfma_f32_16x16x32_bf16 v[224:227], v[32:35], v[56:59], v[224:227]
  v_mfma_f32_16x16x32_bf16 v[248:251], v[36:39], v[56:59], v[248:251]
  v_mfma_f32_16x16x32_bf16 v[180:183], v[24:27], v[60:63], v[180:183]
  ds_read_b64_tr_b16 v[56:57], v4 offset:1024
  v_mfma_f32_16x16x32_bf16 v[204:207], v[28:31], v[60:63], v[204:207]
  ds_read_b64_tr_b16 v[58:59], v4 offset:2560
  v_mfma_f32_16x16x32_bf16 v[228:231], v[32:35], v[60:63], v[228:231]
  v_mfma_f32_16x16x32_bf16 v[252:255], v[36:39], v[60:63], v[252:255]
L_qkv_kernel_st4:
  s_waitcnt lgkmcnt(8)
  v_mfma_f32_16x16x32_bf16 v[64:67], v[40:43], v[8:11], v[64:67]
  ds_read_b64_tr_b16 v[60:61], v5 offset:1024
  v_mfma_f32_16x16x32_bf16 v[88:91], v[40:43], v[12:15], v[88:91]
  ds_read_b64_tr_b16 v[62:63], v5 offset:2560
  v_mfma_f32_16x16x32_bf16 v[112:115], v[40:43], v[16:19], v[112:115]
  ds_read_b128 v[24:27], v2 offset:8192
  v_mfma_f32_16x16x32_bf16 v[136:139], v[40:43], v[20:23], v[136:139]
  ds_read_b128 v[28:31], v2 offset:10240
  s_waitcnt lgkmcnt(10)
  v_mfma_f32_16x16x32_bf16 v[68:71], v[44:47], v[8:11], v[68:71]
  ds_read_b128 v[32:35], v2 offset:12288
  v_mfma_f32_16x16x32_bf16 v[92:95], v[44:47], v[12:15], v[92:95]
  ds_read_b128 v[36:39], v2 offset:14336
  v_mfma_f32_16x16x32_bf16 v[116:119], v[44:47], v[16:19], v[116:119]
  v_mfma_f32_16x16x32_bf16 v[140:143], v[44:47], v[20:23], v[140:143]
  s_waitcnt lgkmcnt(10)
  v_mfma_f32_16x16x32_bf16 v[72:75], v[48:51], v[8:11], v[72:75]
  v_mfma_f32_16x16x32_bf16 v[96:99], v[48:51], v[12:15], v[96:99]
  v_mfma_f32_16x16x32_bf16 v[120:123], v[48:51], v[16:19], v[120:123]
  v_mfma_f32_16x16x32_bf16 v[144:147], v[48:51], v[20:23], v[144:147]
  s_waitcnt lgkmcnt(8)
  v_mfma_f32_16x16x32_bf16 v[76:79], v[52:55], v[8:11], v[76:79]
  v_mfma_f32_16x16x32_bf16 v[100:103], v[52:55], v[12:15], v[100:103]
  v_mfma_f32_16x16x32_bf16 v[124:127], v[52:55], v[16:19], v[124:127]
  v_mfma_f32_16x16x32_bf16 v[148:151], v[52:55], v[20:23], v[148:151]
  s_waitcnt lgkmcnt(6)
  v_mfma_f32_16x16x32_bf16 v[80:83], v[8:11], v[56:59], v[80:83]
  v_mfma_f32_16x16x32_bf16 v[104:107], v[12:15], v[56:59], v[104:107]
  v_mfma_f32_16x16x32_bf16 v[128:131], v[16:19], v[56:59], v[128:131]
  v_mfma_f32_16x16x32_bf16 v[152:155], v[20:23], v[56:59], v[152:155]
  s_waitcnt lgkmcnt(4)
  v_mfma_f32_16x16x32_bf16 v[84:87], v[8:11], v[60:63], v[84:87]
  v_mfma_f32_16x16x32_bf16 v[108:111], v[12:15], v[60:63], v[108:111]
  v_mfma_f32_16x16x32_bf16 v[132:135], v[16:19], v[60:63], v[132:135]
  v_mfma_f32_16x16x32_bf16 v[156:159], v[20:23], v[60:63], v[156:159]
  s_waitcnt lgkmcnt(0)
  s_barrier
  v_mfma_f32_16x16x32_bf16 v[160:163], v[40:43], v[24:27], v[160:163]
  v_add_u32 v3, 0x8000, v3
  ds_read_b128 v[8:11], v3 offset:0
  v_mfma_f32_16x16x32_bf16 v[184:187], v[40:43], v[28:31], v[184:187]
  ds_read_b128 v[12:15], v3 offset:2048
  v_mfma_f32_16x16x32_bf16 v[208:211], v[40:43], v[32:35], v[208:211]
  ds_read_b128 v[16:19], v3 offset:4096
  v_mfma_f32_16x16x32_bf16 v[232:235], v[40:43], v[36:39], v[232:235]
  ds_read_b128 v[20:23], v3 offset:6144
  v_mfma_f32_16x16x32_bf16 v[164:167], v[44:47], v[24:27], v[164:167]
  v_add_u32 v4, 0xffff4000, v4
  ds_read_b64_tr_b16 v[40:41], v4 offset:0
  v_mfma_f32_16x16x32_bf16 v[188:191], v[44:47], v[28:31], v[188:191]
  ds_read_b64_tr_b16 v[42:43], v4 offset:1536
  v_mfma_f32_16x16x32_bf16 v[212:215], v[44:47], v[32:35], v[212:215]
  v_mfma_f32_16x16x32_bf16 v[236:239], v[44:47], v[36:39], v[236:239]
  v_mfma_f32_16x16x32_bf16 v[168:171], v[48:51], v[24:27], v[168:171]
  v_add_u32 v5, 0xffff4000, v5
  ds_read_b64_tr_b16 v[44:45], v5 offset:0
  v_mfma_f32_16x16x32_bf16 v[192:195], v[48:51], v[28:31], v[192:195]
  ds_read_b64_tr_b16 v[46:47], v5 offset:1536
  v_mfma_f32_16x16x32_bf16 v[216:219], v[48:51], v[32:35], v[216:219]
  v_mfma_f32_16x16x32_bf16 v[240:243], v[48:51], v[36:39], v[240:243]
  v_mfma_f32_16x16x32_bf16 v[172:175], v[52:55], v[24:27], v[172:175]
  ds_read_b64_tr_b16 v[48:49], v4 offset:512
  v_mfma_f32_16x16x32_bf16 v[196:199], v[52:55], v[28:31], v[196:199]
  ds_read_b64_tr_b16 v[50:51], v4 offset:2048
  v_mfma_f32_16x16x32_bf16 v[220:223], v[52:55], v[32:35], v[220:223]
  v_mfma_f32_16x16x32_bf16 v[244:247], v[52:55], v[36:39], v[244:247]
  v_mfma_f32_16x16x32_bf16 v[176:179], v[24:27], v[56:59], v[176:179]
  ds_read_b64_tr_b16 v[52:53], v5 offset:512
  v_mfma_f32_16x16x32_bf16 v[200:203], v[28:31], v[56:59], v[200:203]
  ds_read_b64_tr_b16 v[54:55], v5 offset:2048
  v_mfma_f32_16x16x32_bf16 v[224:227], v[32:35], v[56:59], v[224:227]
  v_mfma_f32_16x16x32_bf16 v[248:251], v[36:39], v[56:59], v[248:251]
  v_mfma_f32_16x16x32_bf16 v[180:183], v[24:27], v[60:63], v[180:183]
  ds_read_b64_tr_b16 v[56:57], v4 offset:1024
  v_mfma_f32_16x16x32_bf16 v[204:207], v[28:31], v[60:63], v[204:207]
  ds_read_b64_tr_b16 v[58:59], v4 offset:2560
  v_mfma_f32_16x16x32_bf16 v[228:231], v[32:35], v[60:63], v[228:231]
  v_mfma_f32_16x16x32_bf16 v[252:255], v[36:39], v[60:63], v[252:255]
L_qkv_kernel_st5:
  s_waitcnt lgkmcnt(8)
  v_mfma_f32_16x16x32_bf16 v[64:67], v[40:43], v[8:11], v[64:67]
  ds_read_b64_tr_b16 v[60:61], v5 offset:1024
  v_mfma_f32_16x16x32_bf16 v[88:91], v[40:43], v[12:15], v[88:91]
  ds_read_b64_tr_b16 v[62:63], v5 offset:2560
  v_mfma_f32_16x16x32_bf16 v[112:115], v[40:43], v[16:19], v[112:115]
  ds_read_b128 v[24:27], v3 offset:8192
  v_mfma_f32_16x16x32_bf16 v[136:139], v[40:43], v[20:23], v[136:139]
  ds_read_b128 v[28:31], v3 offset:10240
  s_waitcnt lgkmcnt(10)
  v_mfma_f32_16x16x32_bf16 v[68:71], v[44:47], v[8:11], v[68:71]
  ds_read_b128 v[32:35], v3 offset:12288
  v_mfma_f32_16x16x32_bf16 v[92:95], v[44:47], v[12:15], v[92:95]
  ds_read_b128 v[36:39], v3 offset:14336
  v_mfma_f32_16x16x32_bf16 v[116:119], v[44:47], v[16:19], v[116:119]
  v_mfma_f32_16x16x32_bf16 v[140:143], v[44:47], v[20:23], v[140:143]
  s_waitcnt lgkmcnt(10)
  v_mfma_f32_16x16x32_bf16 v[72:75], v[48:51], v[8:11], v[72:75]
  v_mfma_f32_16x16x32_bf16 v[96:99], v[48:51], v[12:15], v[96:99]
  v_mfma_f32_16x16x32_bf16 v[120:123], v[48:51], v[16:19], v[120:123]
  v_mfma_f32_16x16x32_bf16 v[144:147], v[48:51], v[20:23], v[144:147]
  s_waitcnt lgkmcnt(8)
  v_mfma_f32_16x16x32_bf16 v[76:79], v[52:55], v[8:11], v[76:79]
  v_mfma_f32_16x16x32_bf16 v[100:103], v[52:55], v[12:15], v[100:103]
  v_mfma_f32_16x16x32_bf16 v[124:127], v[52:55], v[16:19], v[124:127]
  v_mfma_f32_16x16x32_bf16 v[148:151], v[52:55], v[20:23], v[148:151]
  s_waitcnt lgkmcnt(6)
  v_mfma_f32_16x16x32_bf16 v[80:83], v[8:11], v[56:59], v[80:83]
  v_mfma_f32_16x16x32_bf16 v[104:107], v[12:15], v[56:59], v[104:107]
  v_mfma_f32_16x16x32_bf16 v[128:131], v[16:19], v[56:59], v[128:131]
  v_mfma_f32_16x16x32_bf16 v[152:155], v[20:23], v[56:59], v[152:155]
  s_waitcnt lgkmcnt(4)
  v_mfma_f32_16x16x32_bf16 v[84:87], v[8:11], v[60:63], v[84:87]
  v_mfma_f32_16x16x32_bf16 v[108:111], v[12:15], v[60:63], v[108:111]
  v_mfma_f32_16x16x32_bf16 v[132:135], v[16:19], v[60:63], v[132:135]
  v_mfma_f32_16x16x32_bf16 v[156:159], v[20:23], v[60:63], v[156:159]
  s_waitcnt lgkmcnt(0)
  s_barrier
  v_mfma_f32_16x16x32_bf16 v[160:163], v[40:43], v[24:27], v[160:163]
  v_add_u32 v2, 0xffff0000, v2
  ds_read_b128 v[8:11], v2 offset:0
  v_mfma_f32_16x16x32_bf16 v[184:187], v[40:43], v[28:31], v[184:187]
  ds_read_b128 v[12:15], v2 offset:2048
  v_mfma_f32_16x16x32_bf16 v[208:211], v[40:43], v[32:35], v[208:211]
  ds_read_b128 v[16:19], v2 offset:4096
  v_mfma_f32_16x16x32_bf16 v[232:235], v[40:43], v[36:39], v[232:235]
  ds_read_b128 v[20:23], v2 offset:6144
  v_mfma_f32_16x16x32_bf16 v[164:167], v[44:47], v[24:27], v[164:167]
  v_add_u32 v4, 0x3000, v4
  ds_read_b64_tr_b16 v[40:41], v4 offset:0
  v_mfma_f32_16x16x32_bf16 v[188:191], v[44:47], v[28:31], v[188:191]
  ds_read_b64_tr_b16 v[42:43], v4 offset:1536
  v_mfma_f32_16x16x32_bf16 v[212:215], v[44:47], v[32:35], v[212:215]
  v_mfma_f32_16x16x32_bf16 v[236:239], v[44:47], v[36:39], v[236:239]
  v_mfma_f32_16x16x32_bf16 v[168:171], v[48:51], v[24:27], v[168:171]
  v_add_u32 v5, 0x3000, v5
  ds_read_b64_tr_b16 v[44:45], v5 offset:0
  v_mfma_f32_16x16x32_bf16 v[192:195], v[48:51], v[28:31], v[192:195]
  ds_read_b64_tr_b16 v[46:47], v5 offset:1536
  v_mfma_f32_16x16x32_bf16 v[216:219], v[48:51], v[32:35], v[216:219]
  v_mfma_f32_16x16x32_bf16 v[240:243], v[48:51], v[36:39], v[240:243]
  v_mfma_f32_16x16x32_bf16 v[172:175], v[52:55], v[24:27], v[172:175]
  ds_read_b64_tr_b16 v[48:49], v4 offset:512
  v_mfma_f32_16x16x32_bf16 v[196:199], v[52:55], v[28:31], v[196:199]
  ds_read_b64_tr_b16 v[50:51], v4 offset:2048
  v_mfma_f32_16x16x32_bf16 v[220:223], v[52:55], v[32:35], v[220:223]
  v_mfma_f32_16x16x32_bf16 v[244:247], v[52:55], v[36:39], v[244:247]
  v_mfma_f32_16x16x32_bf16 v[176:179], v[24:27], v[56:59], v[176:179]
  ds_read_b64_tr_b16 v[52:53], v5 offset:512
  v_mfma_f32_16x16x32_bf16 v[200:203], v[28:31], v[56:59], v[200:203]
  ds_read_b64_tr_b16 v[54:55], v5 offset:2048
  v_mfma_f32_16x16x32_bf16 v[224:227], v[32:35], v[56:59], v[224:227]
  v_mfma_f32_16x16x32_bf16 v[248:251], v[36:39], v[56:59], v[248:251]
  v_mfma_f32_16x16x32_bf16 v[180:183], v[24:27], v[60:63], v[180:183]
  ds_read_b64_tr_b16 v[56:57], v4 offset:1024
  v_mfma_f32_16x16x32_bf16 v[204:207], v[28:31], v[60:63], v[204:207]
  ds_read_b64_tr_b16 v[58:59], v4 offset:2560
  v_mfma_f32_16x16x32_bf16 v[228:231], v[32:35], v[60:63], v[228:231]
  v_mfma_f32_16x16x32_bf16 v[252:255], v[36:39], v[60:63], v[252:255]
L_qkv_kernel_st6:
  s_waitcnt lgkmcnt(8)
  v_mfma_f32_16x16x32_bf16 v[64:67], v[40:43], v[8:11], v[64:67]
  ds_read_b64_tr_b16 v[60:61], v5 offset:1024
  v_mfma_f32_16x16x32_bf16 v[88:91], v[40:43], v[12:15], v[88:91]
  ds_read_b64_tr_b16 v[62:63], v5 offset:2560
  v_mfma_f32_16x16x32_bf16 v[112:115], v[40:43], v[16:19], v[112:115]
  ds_read_b128 v[24:27], v2 offset:8192
  v_mfma_f32_16x16x32_bf16 v[136:139], v[40:43], v[20:23], v[136:139]
  ds_read_b128 v[28:31], v2 offset:10240
  s_waitcnt lgkmcnt(10)
  v_mfma_f32_16x16x32_bf16 v[68:71], v[44:47], v[8:11], v[68:71]
  ds_read_b128 v[32:35], v2 offset:12288
  v_mfma_f32_16x16x32_bf16 v[92:95], v[44:47], v[12:15], v[92:95]
  ds_read_b128 v[36:39], v2 offset:14336
  v_mfma_f32_16x16x32_bf16 v[116:119], v[44:47], v[16:19], v[116:119]
  v_mfma_f32_16x16x32_bf16 v[140:143], v[44:47], v[20:23], v[140:143]
  s_waitcnt lgkmcnt(10)
  v_mfma_f32_16x16x32_bf16 v[72:75], v[48:51], v[8:11], v[72:75]
  v_mfma_f32_16x16x32_bf16 v[96:99], v[48:51], v[12:15], v[96:99]
  v_mfma_f32_16x16x32_bf16 v[120:123], v[48:51], v[16:19], v[120:123]
  v_mfma_f32_16x16x32_bf16 v[144:147], v[48:51], v[20:23], v[144:147]
  s_waitcnt lgkmcnt(8)
  v_mfma_f32_16x16x32_bf16 v[76:79], v[52:55], v[8:11], v[76:79]
  v_mfma_f32_16x16x32_bf16 v[100:103], v[52:55], v[12:15], v[100:103]
  v_mfma_f32_16x16x32_bf16 v[124:127], v[52:55], v[16:19], v[124:127]
  v_mfma_f32_16x16x32_bf16 v[148:151], v[52:55], v[20:23], v[148:151]
  s_waitcnt lgkmcnt(6)
  v_mfma_f32_16x16x32_bf16 v[80:83], v[8:11], v[56:59], v[80:83]
  v_mfma_f32_16x16x32_bf16 v[104:107], v[12:15], v[56:59], v[104:107]
  v_mfma_f32_16x16x32_bf16 v[128:131], v[16:19], v[56:59], v[128:131]
  v_mfma_f32_16x16x32_bf16 v[152:155], v[20:23], v[56:59], v[152:155]
  s_waitcnt lgkmcnt(4)
  v_mfma_f32_16x16x32_bf16 v[84:87], v[8:11], v[60:63], v[84:87]
  v_mfma_f32_16x16x32_bf16 v[108:111], v[12:15], v[60:63], v[108:111]
  v_mfma_f32_16x16x32_bf16 v[132:135], v[16:19], v[60:63], v[132:135]
  v_mfma_f32_16x16x32_bf16 v[156:159], v[20:23], v[60:63], v[156:159]
  s_waitcnt lgkmcnt(0)
  s_barrier
  v_mfma_f32_16x16x32_bf16 v[160:163], v[40:43], v[24:27], v[160:163]
  v_add_u32 v3, 0xffff0000, v3
  ds_read_b128 v[8:11], v3 offset:0
  v_mfma_f32_16x16x32_bf16 v[184:187], v[40:43], v[28:31], v[184:187]
  ds_read_b128 v[12:15], v3 offset:2048
  v_mfma_f32_16x16x32_bf16 v[208:211], v[40:43], v[32:35], v[208:211]
  ds_read_b128 v[16:19], v3 offset:4096
  v_mfma_f32_16x16x32_bf16 v[232:235], v[40:43], v[36:39], v[232:235]
  ds_read_b128 v[20:23], v3 offset:6144
  v_mfma_f32_16x16x32_bf16 v[164:167], v[44:47], v[24:27], v[164:167]
  v_add_u32 v4, 0x3000, v4
  ds_read_b64_tr_b16 v[40:41], v4 offset:0
  v_mfma_f32_16x16x32_bf16 v[188:191], v[44:47], v[28:31], v[188:191]
  ds_read_b64_tr_b16 v[42:43], v4 offset:1536
  v_mfma_f32_16x16x32_bf16 v[212:215], v[44:47], v[32:35], v[212:215]
  v_mfma_f32_16x16x32_bf16 v[236:239], v[44:47], v[36:39], v[236:239]
  v_mfma_f32_16x16x32_bf16 v[168:171], v[48:51], v[24:27], v[168:171]
  v_add_u32 v5, 0x3000, v5
  ds_read_b64_tr_b16 v[44:45], v5 offset:0
  v_mfma_f32_16x16x32_bf16 v[192:195], v[48:51], v[28:31], v[192:195]
  ds_read_b64_tr_b16 v[46:47], v5 offset:1536
  v_mfma_f32_16x16x32_bf16 v[216:219], v[48:51], v[32:35], v[216:219]
  v_mfma_f32_16x16x32_bf16 v[240:243], v[48:51], v[36:39], v[240:243]
  v_mfma_f32_16x16x32_bf16 v[172:175], v[52:55], v[24:27], v[172:175]
  ds_read_b64_tr_b16 v[48:49], v4 offset:512
  v_mfma_f32_16x16x32_bf16 v[196:199], v[52:55], v[28:31], v[196:199]
  ds_read_b64_tr_b16 v[50:51], v4 offset:2048
  v_mfma_f32_16x16x32_bf16 v[220:223], v[52:55], v[32:35], v[220:223]
  v_mfma_f32_16x16x32_bf16 v[244:247], v[52:55], v[36:39], v[244:247]
  v_mfma_f32_16x16x32_bf16 v[176:179], v[24:27], v[56:59], v[176:179]
  ds_read_b64_tr_b16 v[52:53], v5 offset:512
  v_mfma_f32_16x16x32_bf16 v[200:203], v[28:31], v[56:59], v[200:203]
  ds_read_b64_tr_b16 v[54:55], v5 offset:2048
  v_mfma_f32_16x16x32_bf16 v[224:227], v[32:35], v[56:59], v[224:227]
  v_mfma_f32_16x16x32_bf16 v[248:251], v[36:39], v[56:59], v[248:251]
  v_mfma_f32_16x16x32_bf16 v[180:183], v[24:27], v[60:63], v[180:183]
  ds_read_b64_tr_b16 v[56:57], v4 offset:1024
  v_mfma_f32_16x16x32_bf16 v[204:207], v[28:31], v[60:63], v[204:207]
  ds_read_b64_tr_b16 v[58:59], v4 offset:2560
  v_mfma_f32_16x16x32_bf16 v[228:231], v[32:35], v[60:63], v[228:231]
  v_mfma_f32_16x16x32_bf16 v[252:255], v[36:39], v[60:63], v[252:255]
L_qkv_kernel_st7:
  s_waitcnt lgkmcnt(8)
  v_mfma_f32_16x16x32_bf16 v[64:67], v[40:43], v[8:11], v[64:67]
  ds_read_b64_tr_b16 v[60:61], v5 offset:1024
  v_mfma_f32_16x16x32_bf16 v[88:91], v[40:43], v[12:15], v[88:91]
  ds_read_b64_tr_b16 v[62:63], v5 offset:2560
  v_mfma_f32_16x16x32_bf16 v[112:115], v[40:43], v[16:19], v[112:115]
  ds_read_b128 v[24:27], v3 offset:8192
  v_mfma_f32_16x16x32_bf16 v[136:139], v[40:43], v[20:23], v[136:139]
  ds_read_b128 v[28:31], v3 offset:10240
  s_waitcnt lgkmcnt(10)
  v_mfma_f32_16x16x32_bf16 v[68:71], v[44:47], v[8:11], v[68:71]
  ds_read_b128 v[32:35], v3 offset:12288
  v_mfma_f32_16x16x32_bf16 v[92:95], v[44:47], v[12:15], v[92:95]
  ds_read_b128 v[36:39], v3 offset:14336
  v_mfma_f32_16x16x32_bf16 v[116:119], v[44:47], v[16:19], v[116:119]
  v_mfma_f32_16x16x32_bf16 v[140:143], v[44:47], v[20:23], v[140:143]
  s_waitcnt lgkmcnt(10)
  v_mfma_f32_16x16x32_bf16 v[72:75], v[48:51], v[8:11], v[72:75]
  v_mfma_f32_16x16x32_bf16 v[96:99], v[48:51], v[12:15], v[96:99]
  v_mfma_f32_16x16x32_bf16 v[120:123], v[48:51], v[16:19], v[120:123]
  v_mfma_f32_16x16x32_bf16 v[144:147], v[48:51], v[20:23], v[144:147]
  s_waitcnt lgkmcnt(8)
  v_mfma_f32_16x16x32_bf16 v[76:79], v[52:55], v[8:11], v[76:79]
  v_mfma_f32_16x16x32_bf16 v[100:103], v[52:55], v[12:15], v[100:103]
  v_mfma_f32_16x16x32_bf16 v[124:127], v[52:55], v[16:19], v[124:127]
  v_mfma_f32_16x16x32_bf16 v[148:151], v[52:55], v[20:23], v[148:151]
  s_waitcnt lgkmcnt(6)
  v_mfma_f32_16x16x32_bf16 v[80:83], v[8:11], v[56:59], v[80:83]
  v_mfma_f32_16x16x32_bf16 v[104:107], v[12:15], v[56:59], v[104:107]
  v_mfma_f32_16x16x32_bf16 v[128:131], v[16:19], v[56:59], v[128:131]
  v_mfma_f32_16x16x32_bf16 v[152:155], v[20:23], v[56:59], v[152:155]
  s_waitcnt lgkmcnt(4)
  v_mfma_f32_16x16x32_bf16 v[84:87], v[8:11], v[60:63], v[84:87]
  v_mfma_f32_16x16x32_bf16 v[108:111], v[12:15], v[60:63], v[108:111]
  v_mfma_f32_16x16x32_bf16 v[132:135], v[16:19], v[60:63], v[132:135]
  v_mfma_f32_16x16x32_bf16 v[156:159], v[20:23], v[60:63], v[156:159]
  s_waitcnt lgkmcnt(0)
  s_barrier
  v_mfma_f32_16x16x32_bf16 v[160:163], v[40:43], v[24:27], v[160:163]
  v_add_u32 v2, 0x8000, v2
  ds_read_b128 v[8:11], v2 offset:0
  v_mfma_f32_16x16x32_bf16 v[184:187], v[40:43], v[28:31], v[184:187]
  ds_read_b128 v[12:15], v2 offset:2048
  v_mfma_f32_16x16x32_bf16 v[208:211], v[40:43], v[32:35], v[208:211]
  ds_read_b128 v[16:19], v2 offset:4096
  v_mfma_f32_16x16x32_bf16 v[232:235], v[40:43], v[36:39], v[232:235]
  ds_read_b128 v[20:23], v2 offset:6144
  v_mfma_f32_16x16x32_bf16 v[164:167], v[44:47], v[24:27], v[164:167]
  v_add_u32 v4, 0x3000, v4
  ds_read_b64_tr_b16 v[40:41], v4 offset:0
  v_mfma_f32_16x16x32_bf16 v[188:191], v[44:47], v[28:31], v[188:191]
  ds_read_b64_tr_b16 v[42:43], v4 offset:1536
  v_mfma_f32_16x16x32_bf16 v[212:215], v[44:47], v[32:35], v[212:215]
  v_mfma_f32_16x16x32_bf16 v[236:239], v[44:47], v[36:39], v[236:239]
  v_mfma_f32_16x16x32_bf16 v[168:171], v[48:51], v[24:27], v[168:171]
  v_add_u32 v5, 0x3000, v5
  ds_read_b64_tr_b16 v[44:45], v5 offset:0
  v_mfma_f32_16x16x32_bf16 v[192:195], v[48:51], v[28:31], v[192:195]
  ds_read_b64_tr_b16 v[46:47], v5 offset:1536
  v_mfma_f32_16x16x32_bf16 v[216:219], v[48:51], v[32:35], v[216:219]
  v_mfma_f32_16x16x32_bf16 v[240:243], v[48:51], v[36:39], v[240:243]
  v_mfma_f32_16x16x32_bf16 v[172:175], v[52:55], v[24:27], v[172:175]
  ds_read_b64_tr_b16 v[48:49], v4 offset:512
  v_mfma_f32_16x16x32_bf16 v[196:199], v[52:55], v[28:31], v[196:199]
  ds_read_b64_tr_b16 v[50:51], v4 offset:2048
  v_mfma_f32_16x16x32_bf16 v[220:223], v[52:55], v[32:35], v[220:223]
  v_mfma_f32_16x16x32_bf16 v[244:247], v[52:55], v[36:39], v[244:247]
  v_mfma_f32_16x16x32_bf16 v[176:179], v[24:27], v[56:59], v[176:179]
  ds_read_b64_tr_b16 v[52:53], v5 offset:512
  v_mfma_f32_16x16x32_bf16 v[200:203], v[28:31], v[56:59], v[200:203]
  ds_read_b64_tr_b16 v[54:55], v5 offset:2048
  v_mfma_f32_16x16x32_bf16 v[224:227], v[32:35], v[56:59], v[224:227]
  v_mfma_f32_16x16x32_bf16 v[248:251], v[36:39], v[56:59], v[248:251]
  v_mfma_f32_16x16x32_bf16 v[180:183], v[24:27], v[60:63], v[180:183]
  ds_read_b64_tr_b16 v[56:57], v4 offset:1024
  v_mfma_f32_16x16x32_bf16 v[204:207], v[28:31], v[60:63], v[204:207]
  ds_read_b64_tr_b16 v[58:59], v4 offset:2560
  v_mfma_f32_16x16x32_bf16 v[228:231], v[32:35], v[60:63], v[228:231]
  v_mfma_f32_16x16x32_bf16 v[252:255], v[36:39], v[60:63], v[252:255]
L_qkv_kernel_st8:
  s_waitcnt lgkmcnt(8)
  v_mfma_f32_16x16x32_bf16 v[64:67], v[40:43], v[8:11], v[64:67]
  ds_read_b64_tr_b16 v[60:61], v5 offset:1024
  v_mfma_f32_16x16x32_bf16 v[88:91], v[40:43], v[12:15], v[88:91]
  ds_read_b64_tr_b16 v[62:63], v5 offset:2560
  v_mfma_f32_16x16x32_bf16 v[112:115], v[40:43], v[16:19], v[112:115]
  ds_read_b128 v[24:27], v2 offset:8192
  v_mfma_f32_16x16x32_bf16 v[136:139], v[40:43], v[20:23], v[136:139]
  ds_read_b128 v[28:31], v2 offset:10240
  s_waitcnt lgkmcnt(10)
  v_mfma_f32_16x16x32_bf16 v[68:71], v[44:47], v[8:11], v[68:71]
  ds_read_b128 v[32:35], v2 offset:12288
  v_mfma_f32_16x16x32_bf16 v[92:95], v[44:47], v[12:15], v[92:95]
  ds_read_b128 v[36:39], v2 offset:14336
  v_mfma_f32_16x16x32_bf16 v[116:119], v[44:47], v[16:19], v[116:119]
  v_mfma_f32_16x16x32_bf16 v[140:143], v[44:47], v[20:23], v[140:143]
  s_waitcnt lgkmcnt(10)
  v_mfma_f32_16x16x32_bf16 v[72:75], v[48:51], v[8:11], v[72:75]
  v_mfma_f32_16x16x32_bf16 v[96:99], v[48:51], v[12:15], v[96:99]
  v_mfma_f32_16x16x32_bf16 v[120:123], v[48:51], v[16:19], v[120:123]
  v_mfma_f32_16x16x32_bf16 v[144:147], v[48:51], v[20:23], v[144:147]
  s_waitcnt lgkmcnt(8)
  v_mfma_f32_16x16x32_bf16 v[76:79], v[52:55], v[8:11], v[76:79]
  v_mfma_f32_16x16x32_bf16 v[100:103], v[52:55], v[12:15], v[100:103]
  v_mfma_f32_16x16x32_bf16 v[124:127], v[52:55], v[16:19], v[124:127]
  v_mfma_f32_16x16x32_bf16 v[148:151], v[52:55], v[20:23], v[148:151]
  s_waitcnt lgkmcnt(6)
  v_mfma_f32_16x16x32_bf16 v[80:83], v[8:11], v[56:59], v[80:83]
  v_mfma_f32_16x16x32_bf16 v[104:107], v[12:15], v[56:59], v[104:107]
  v_mfma_f32_16x16x32_bf16 v[128:131], v[16:19], v[56:59], v[128:131]
  v_mfma_f32_16x16x32_bf16 v[152:155], v[20:23], v[56:59], v[152:155]
  s_waitcnt lgkmcnt(4)
  v_mfma_f32_16x16x32_bf16 v[84:87], v[8:11], v[60:63], v[84:87]
  v_mfma_f32_16x16x32_bf16 v[108:111], v[12:15], v[60:63], v[108:111]
  v_mfma_f32_16x16x32_bf16 v[132:135], v[16:19], v[60:63], v[132:135]
  v_mfma_f32_16x16x32_bf16 v[156:159], v[20:23], v[60:63], v[156:159]
  s_waitcnt lgkmcnt(0)
  s_barrier
  v_mfma_f32_16x16x32_bf16 v[160:163], v[40:43], v[24:27], v[160:163]
  v_add_u32 v3, 0x8000, v3
  ds_read_b128 v[8:11], v3 offset:0
  v_mfma_f32_16x16x32_bf16 v[184:187], v[40:43], v[28:31], v[184:187]
  ds_read_b128 v[12:15], v3 offset:2048
  v_mfma_f32_16x16x32_bf16 v[208:211], v[40:43], v[32:35], v[208:211]
  ds_read_b128 v[16:19], v3 offset:4096
  v_mfma_f32_16x16x32_bf16 v[232:235], v[40:43], v[36:39], v[232:235]
  ds_read_b128 v[20:23], v3 offset:6144
  v_mfma_f32_16x16x32_bf16 v[164:167], v[44:47], v[24:27], v[164:167]
  v_add_u32 v4, 0x3000, v4
  ds_read_b64_tr_b16 v[40:41], v4 offset:0
  v_mfma_f32_16x16x32_bf16 v[188:191], v[44:47], v[28:31], v[188:191]
  ds_read_b64_tr_b16 v[42:43], v4 offset:1536
  v_mfma_f32_16x16x32_bf16 v[212:215], v[44:47], v[32:35], v[212:215]
  v_mfma_f32_16x16x32_bf16 v[236:239], v[44:47], v[36:39], v[236:239]
  v_mfma_f32_16x16x32_bf16 v[168:171], v[48:51], v[24:27], v[168:171]
  v_add_u32 v5, 0x3000, v5
  ds_read_b64_tr_b16 v[44:45], v5 offset:0
  v_mfma_f32_16x16x32_bf16 v[192:195], v[48:51], v[28:31], v[192:195]
  ds_read_b64_tr_b16 v[46:47], v5 offset:1536
  v_mfma_f32_16x16x32_bf16 v[216:219], v[48:51], v[32:35], v[216:219]
  v_mfma_f32_16x16x32_bf16 v[240:243], v[48:51], v[36:39], v[240:243]
  v_mfma_f32_16x16x32_bf16 v[172:175], v[52:55], v[24:27], v[172:175]
  ds_read_b64_tr_b16 v[48:49], v4 offset:512
  v_mfma_f32_16x16x32_bf16 v[196:199], v[52:55], v[28:31], v[196:199]
  ds_read_b64_tr_b16 v[50:51], v4 offset:2048
  v_mfma_f32_16x16x32_bf16 v[220:223], v[52:55], v[32:35], v[220:223]
  v_mfma_f32_16x16x32_bf16 v[244:247], v[52:55], v[36:39], v[244:247]
  v_mfma_f32_16x16x32_bf16 v[176:179], v[24:27], v[56:59], v[176:179]
  ds_read_b64_tr_b16 v[52:53], v5 offset:512
  v_mfma_f32_16x16x32_bf16 v[200:203], v[28:31], v[56:59], v[200:203]
  ds_read_b64_tr_b16 v[54:55], v5 offset:2048
  v_mfma_f32_16x16x32_bf16 v[224:227], v[32:35], v[56:59], v[224:227]
  v_mfma_f32_16x16x32_bf16 v[248:251], v[36:39], v[56:59], v[248:251]
  v_mfma_f32_16x16x32_bf16 v[180:183], v[24:27], v[60:63], v[180:183]
  ds_read_b64_tr_b16 v[56:57], v4 offset:1024
  v_mfma_f32_16x16x32_bf16 v[204:207], v[28:31], v[60:63], v[204:207]
  ds_read_b64_tr_b16 v[58:59], v4 offset:2560
  v_mfma_f32_16x16x32_bf16 v[228:231], v[32:35], v[60:63], v[228:231]
  v_mfma_f32_16x16x32_bf16 v[252:255], v[36:39], v[60:63], v[252:255]
L_qkv_kernel_st9:
  s_waitcnt lgkmcnt(8)
  v_mfma_f32_16x16x32_bf16 v[64:67], v[40:43], v[8:11], v[64:67]
  ds_read_b64_tr_b16 v[60:61], v5 offset:1024
  v_mfma_f32_16x16x32_bf16 v[88:91], v[40:43], v[12:15], v[88:91]
  ds_read_b64_tr_b16 v[62:63], v5 offset:2560
  v_mfma_f32_16x16x32_bf16 v[112:115], v[40:43], v[16:19], v[112:115]
  ds_read_b128 v[24:27], v3 offset:8192
  v_mfma_f32_16x16x32_bf16 v[136:139], v[40:43], v[20:23], v[136:139]
  ds_read_b128 v[28:31], v3 offset:10240
  s_waitcnt lgkmcnt(10)
  v_mfma_f32_16x16x32_bf16 v[68:71], v[44:47], v[8:11], v[68:71]
  ds_read_b128 v[32:35], v3 offset:12288
  v_mfma_f32_16x16x32_bf16 v[92:95], v[44:47], v[12:15], v[92:95]
  ds_read_b128 v[36:39], v3 offset:14336
  v_mfma_f32_16x16x32_bf16 v[116:119], v[44:47], v[16:19], v[116:119]
  v_mfma_f32_16x16x32_bf16 v[140:143], v[44:47], v[20:23], v[140:143]
  s_waitcnt lgkmcnt(10)
  v_mfma_f32_16x16x32_bf16 v[72:75], v[48:51], v[8:11], v[72:75]
  v_mfma_f32_16x16x32_bf16 v[96:99], v[48:51], v[12:15], v[96:99]
  v_mfma_f32_16x16x32_bf16 v[120:123], v[48:51], v[16:19], v[120:123]
  v_mfma_f32_16x16x32_bf16 v[144:147], v[48:51], v[20:23], v[144:147]
  s_waitcnt lgkmcnt(8)
  v_mfma_f32_16x16x32_bf16 v[76:79], v[52:55], v[8:11], v[76:79]
  v_mfma_f32_16x16x32_bf16 v[100:103], v[52:55], v[12:15], v[100:103]
  v_mfma_f32_16x16x32_bf16 v[124:127], v[52:55], v[16:19], v[124:127]
  v_mfma_f32_16x16x32_bf16 v[148:151], v[52:55], v[20:23], v[148:151]
  s_waitcnt lgkmcnt(6)
  v_mfma_f32_16x16x32_bf16 v[80:83], v[8:11], v[56:59], v[80:83]
  v_mfma_f32_16x16x32_bf16 v[104:107], v[12:15], v[56:59], v[104:107]
  v_mfma_f32_16x16x32_bf16 v[128:131], v[16:19], v[56:59], v[128:131]
  v_mfma_f32_16x16x32_bf16 v[152:155], v[20:23], v[56:59], v[152:155]
  s_waitcnt lgkmcnt(4)
  v_mfma_f32_16x16x32_bf16 v[84:87], v[8:11], v[60:63], v[84:87]
  v_mfma_f32_16x16x32_bf16 v[108:111], v[12:15], v[60:63], v[108:111]
  v_mfma_f32_16x16x32_bf16 v[132:135], v[16:19], v[60:63], v[132:135]
  v_mfma_f32_16x16x32_bf16 v[156:159], v[20:23], v[60:63], v[156:159]
  s_waitcnt lgkmcnt(0)
  s_barrier
  v_mfma_f32_16x16x32_bf16 v[160:163], v[40:43], v[24:27], v[160:163]
  v_add_u32 v2, 0x8000, v2
  ds_read_b128 v[8:11], v2 offset:0
  v_mfma_f32_16x16x32_bf16 v[184:187], v[40:43], v[28:31], v[184:187]
  ds_read_b128 v[12:15], v2 offset:2048
  v_mfma_f32_16x16x32_bf16 v[208:211], v[40:43], v[32:35], v[208:211]
  ds_read_b128 v[16:19], v2 offset:4096
  v_mfma_f32_16x16x32_bf16 v[232:235], v[40:43], v[36:39], v[232:235]
  ds_read_b128 v[20:23], v2 offset:6144
  v_mfma_f32_16x16x32_bf16 v[164:167], v[44:47], v[24:27], v[164:167]
  v_add_u32 v4, 0xffff4000, v4
  ds_read_b64_tr_b16 v[40:41], v4 offset:0
  v_mfma_f32_16x16x32_bf16 v[188:191], v[44:47], v[28:31], v[188:191]
  ds_read_b64_tr_b16 v[42:43], v4 offset:1536
  v_mfma_f32_16x16x32_bf16 v[212:215], v[44:47], v[32:35], v[212:215]
  v_mfma_f32_16x16x32_bf16 v[236:239], v[44:47], v[36:39], v[236:239]
  v_mfma_f32_16x16x32_bf16 v[168:171], v[48:51], v[24:27], v[168:171]
  v_add_u32 v5, 0xffff4000, v5
  ds_read_b64_tr_b16 v[44:45], v5 offset:0
  v_mfma_f32_16x16x32_bf16 v[192:195], v[48:51], v[28:31], v[192:195]
  ds_read_b64_tr_b16 v[46:47], v5 offset:1536
  v_mfma_f32_16x16x32_bf16 v[216:219], v[48:51], v[32:35], v[216:219]
  v_mfma_f32_16x16x32_bf16 v[240:243], v[48:51], v[36:39], v[240:243]
  v_mfma_f32_16x16x32_bf16 v[172:175], v[52:55], v[24:27], v[172:175]
  ds_read_b64_tr_b16 v[48:49], v4 offset:512
  v_mfma_f32_16x16x32_bf16 v[196:199], v[52:55], v[28:31], v[196:199]
  ds_read_b64_tr_b16 v[50:51], v4 offset:2048
  v_mfma_f32_16x16x32_bf16 v[220:223], v[52:55], v[32:35], v[220:223]
  v_mfma_f32_16x16x32_bf16 v[244:247], v[52:55], v[36:39], v[244:247]
  v_mfma_f32_16x16x32_bf16 v[176:179], v[24:27], v[56:59], v[176:179]
  ds_read_b64_tr_b16 v[52:53], v5 offset:512
  v_mfma_f32_16x16x32_bf16 v[200:203], v[28:31], v[56:59], v[200:203]
  ds_read_b64_tr_b16 v[54:55], v5 offset:2048
  v_mfma_f32_16x16x32_bf16 v[224:227], v[32:35], v[56:59], v[224:227]
  v_mfma_f32_16x16x32_bf16 v[248:251], v[36:39], v[56:59], v[248:251]
  v_mfma_f32_16x16x32_bf16 v[180:183], v[24:27], v[60:63], v[180:183]
  ds_read_b64_tr_b16 v[56:57], v4 offset:1024
  v_mfma_f32_16x16x32_bf16 v[204:207], v[28:31], v[60:63], v[204:207]
  ds_read_b64_tr_b16 v[58:59], v4 offset:2560
  v_mfma_f32_16x16x32_bf16 v[228:231], v[32:35], v[60:63], v[228:231]
  v_mfma_f32_16x16x32_bf16 v[252:255], v[36:39], v[60:63], v[252:255]
L_qkv_kernel_st10:
  s_waitcnt lgkmcnt(8)
  v_mfma_f32_16x16x32_bf16 v[64:67], v[40:43], v[8:11], v[64:67]
  ds_read_b64_tr_b16 v[60:61], v5 offset:1024
  v_mfma_f32_16x16x32_bf16 v[88:91], v[40:43], v[12:15], v[88:91]
  ds_read_b64_tr_b16 v[62:63], v5 offset:2560
  v_mfma_f32_16x16x32_bf16 v[112:115], v[40:43], v[16:19], v[112:115]
  ds_read_b128 v[24:27], v2 offset:8192
  v_mfma_f32_16x16x32_bf16 v[136:139], v[40:43], v[20:23], v[136:139]
  ds_read_b128 v[28:31], v2 offset:10240
  s_waitcnt lgkmcnt(10)
  v_mfma_f32_16x16x32_bf16 v[68:71], v[44:47], v[8:11], v[68:71]
  ds_read_b128 v[32:35], v2 offset:12288
  v_mfma_f32_16x16x32_bf16 v[92:95], v[44:47], v[12:15], v[92:95]
  ds_read_b128 v[36:39], v2 offset:14336
  v_mfma_f32_16x16x32_bf16 v[116:119], v[44:47], v[16:19], v[116:119]
  v_mfma_f32_16x16x32_bf16 v[140:143], v[44:47], v[20:23], v[140:143]
  s_waitcnt lgkmcnt(10)
  v_mfma_f32_16x16x32_bf16 v[72:75], v[48:51], v[8:11], v[72:75]
  v_mfma_f32_16x16x32_bf16 v[96:99], v[48:51], v[12:15], v[96:99]
  v_mfma_f32_16x16x32_bf16 v[120:123], v[48:51], v[16:19], v[120:123]
  v_mfma_f32_16x16x32_bf16 v[144:147], v[48:51], v[20:23], v[144:147]
  s_waitcnt lgkmcnt(8)
  v_mfma_f32_16x16x32_bf16 v[76:79], v[52:55], v[8:11], v[76:79]
  v_mfma_f32_16x16x32_bf16 v[100:103], v[52:55], v[12:15], v[100:103]
  v_mfma_f32_16x16x32_bf16 v[124:127], v[52:55], v[16:19], v[124:127]
  v_mfma_f32_16x16x32_bf16 v[148:151], v[52:55], v[20:23], v[148:151]
  s_waitcnt lgkmcnt(6)
  v_mfma_f32_16x16x32_bf16 v[80:83], v[8:11], v[56:59], v[80:83]
  v_mfma_f32_16x16x32_bf16 v[104:107], v[12:15], v[56:59], v[104:107]
  v_mfma_f32_16x16x32_bf16 v[128:131], v[16:19], v[56:59], v[128:131]
  v_mfma_f32_16x16x32_bf16 v[152:155], v[20:23], v[56:59], v[152:155]
  s_waitcnt lgkmcnt(4)
  v_mfma_f32_16x16x32_bf16 v[84:87], v[8:11], v[60:63], v[84:87]
  v_mfma_f32_16x16x32_bf16 v[108:111], v[12:15], v[60:63], v[108:111]
  v_mfma_f32_16x16x32_bf16 v[132:135], v[16:19], v[60:63], v[132:135]
  v_mfma_f32_16x16x32_bf16 v[156:159], v[20:23], v[60:63], v[156:159]
  s_waitcnt lgkmcnt(0)
  s_barrier
  v_mfma_f32_16x16x32_bf16 v[160:163], v[40:43], v[24:27], v[160:163]
  v_add_u32 v3, 0x8000, v3
  ds_read_b128 v[8:11], v3 offset:0
  v_mfma_f32_16x16x32_bf16 v[184:187], v[40:43], v[28:31], v[184:187]
  ds_read_b128 v[12:15], v3 offset:2048
  v_mfma_f32_16x16x32_bf16 v[208:211], v[40:43], v[32:35], v[208:211]
  ds_read_b128 v[16:19], v3 offset:4096
  v_mfma_f32_16x16x32_bf16 v[232:235], v[40:43], v[36:39], v[232:235]
  ds_read_b128 v[20:23], v3 offset:6144
  v_mfma_f32_16x16x32_bf16 v[164:167], v[44:47], v[24:27], v[164:167]
  v_add_u32 v4, 0x3000, v4
  ds_read_b64_tr_b16 v[40:41], v4 offset:0
  v_mfma_f32_16x16x32_bf16 v[188:191], v[44:47], v[28:31], v[188:191]
  ds_read_b64_tr_b16 v[42:43], v4 offset:1536
  v_mfma_f32_16x16x32_bf16 v[212:215], v[44:47], v[32:35], v[212:215]
  v_mfma_f32_16x16x32_bf16 v[236:239], v[44:47], v[36:39], v[236:239]
  v_mfma_f32_16x16x32_bf16 v[168:171], v[48:51], v[24:27], v[168:171]
  v_add_u32 v5, 0x3000, v5
  ds_read_b64_tr_b16 v[44:45], v5 offset:0
  v_mfma_f32_16x16x32_bf16 v[192:195], v[48:51], v[28:31], v[192:195]
  ds_read_b64_tr_b16 v[46:47], v5 offset:1536
  v_mfma_f32_16x16x32_bf16 v[216:219], v[48:51], v[32:35], v[216:219]
  v_mfma_f32_16x16x32_bf16 v[240:243], v[48:51], v[36:39], v[240:243]
  v_mfma_f32_16x16x32_bf16 v[172:175], v[52:55], v[24:27], v[172:175]
  ds_read_b64_tr_b16 v[48:49], v4 offset:512
  v_mfma_f32_16x16x32_bf16 v[196:199], v[52:55], v[28:31], v[196:199]
  ds_read_b64_tr_b16 v[50:51], v4 offset:2048
  v_mfma_f32_16x16x32_bf16 v[220:223], v[52:55], v[32:35], v[220:223]
  v_mfma_f32_16x16x32_bf16 v[244:247], v[52:55], v[36:39], v[244:247]
  v_mfma_f32_16x16x32_bf16 v[176:179], v[24:27], v[56:59], v[176:179]
  ds_read_b64_tr_b16 v[52:53], v5 offset:512
  v_mfma_f32_16x16x32_bf16 v[200:203], v[28:31], v[56:59], v[200:203]
  ds_read_b64_tr_b16 v[54:55], v5 offset:2048
  v_mfma_f32_16x16x32_bf16 v[224:227], v[32:35], v[56:59], v[224:227]
  v_mfma_f32_16x16x32_bf16 v[248:251], v[36:39], v[56:59], v[248:251]
  v_mfma_f32_16x16x32_bf16 v[180:183], v[24:27], v[60:63], v[180:183]
  ds_read_b64_tr_b16 v[56:57], v4 offset:1024
  v_mfma_f32_16x16x32_bf16 v[204:207], v[28:31], v[60:63], v[204:207]
  ds_read_b64_tr_b16 v[58:59], v4 offset:2560
  v_mfma_f32_16x16x32_bf16 v[228:231], v[32:35], v[60:63], v[228:231]
  v_mfma_f32_16x16x32_bf16 v[252:255], v[36:39], v[60:63], v[252:255]
L_qkv_kernel_st11:
  s_waitcnt lgkmcnt(8)
  v_mfma_f32_16x16x32_bf16 v[64:67], v[40:43], v[8:11], v[64:67]
  ds_read_b64_tr_b16 v[60:61], v5 offset:1024
  v_mfma_f32_16x16x32_bf16 v[88:91], v[40:43], v[12:15], v[88:91]
  ds_read_b64_tr_b16 v[62:63], v5 offset:2560
  v_mfma_f32_16x16x32_bf16 v[112:115], v[40:43], v[16:19], v[112:115]
  ds_read_b128 v[24:27], v3 offset:8192
  v_mfma_f32_16x16x32_bf16 v[136:139], v[40:43], v[20:23], v[136:139]
  ds_read_b128 v[28:31], v3 offset:10240
  s_waitcnt lgkmcnt(10)
  v_mfma_f32_16x16x32_bf16 v[68:71], v[44:47], v[8:11], v[68:71]
  ds_read_b128 v[32:35], v3 offset:12288
  v_mfma_f32_16x16x32_bf16 v[92:95], v[44:47], v[12:15], v[92:95]
  ds_read_b128 v[36:39], v3 offset:14336
  v_mfma_f32_16x16x32_bf16 v[116:119], v[44:47], v[16:19], v[116:119]
  v_mfma_f32_16x16x32_bf16 v[140:143], v[44:47], v[20:23], v[140:143]
  s_waitcnt lgkmcnt(10)
  v_mfma_f32_16x16x32_bf16 v[72:75], v[48:51], v[8:11], v[72:75]
  v_mfma_f32_16x16x32_bf16 v[96:99], v[48:51], v[12:15], v[96:99]
  v_mfma_f32_16x16x32_bf16 v[120:123], v[48:51], v[16:19], v[120:123]
  v_mfma_f32_16x16x32_bf16 v[144:147], v[48:51], v[20:23], v[144:147]
  s_waitcnt lgkmcnt(8)
  v_mfma_f32_16x16x32_bf16 v[76:79], v[52:55], v[8:11], v[76:79]
  v_mfma_f32_16x16x32_bf16 v[100:103], v[52:55], v[12:15], v[100:103]
  v_mfma_f32_16x16x32_bf16 v[124:127], v[52:55], v[16:19], v[124:127]
  v_mfma_f32_16x16x32_bf16 v[148:151], v[52:55], v[20:23], v[148:151]
  s_waitcnt lgkmcnt(6)
  v_mfma_f32_16x16x32_bf16 v[80:83], v[8:11], v[56:59], v[80:83]
  v_mfma_f32_16x16x32_bf16 v[104:107], v[12:15], v[56:59], v[104:107]
  v_mfma_f32_16x16x32_bf16 v[128:131], v[16:19], v[56:59], v[128:131]
  v_mfma_f32_16x16x32_bf16 v[152:155], v[20:23], v[56:59], v[152:155]
  s_waitcnt lgkmcnt(4)
  v_mfma_f32_16x16x32_bf16 v[84:87], v[8:11], v[60:63], v[84:87]
  v_mfma_f32_16x16x32_bf16 v[108:111], v[12:15], v[60:63], v[108:111]
  v_mfma_f32_16x16x32_bf16 v[132:135], v[16:19], v[60:63], v[132:135]
  v_mfma_f32_16x16x32_bf16 v[156:159], v[20:23], v[60:63], v[156:159]
  s_waitcnt lgkmcnt(0)
  s_barrier
  v_mfma_f32_16x16x32_bf16 v[160:163], v[40:43], v[24:27], v[160:163]
  v_add_u32 v2, 0xffff0000, v2
  ds_read_b128 v[8:11], v2 offset:0
  v_mfma_f32_16x16x32_bf16 v[184:187], v[40:43], v[28:31], v[184:187]
  ds_read_b128 v[12:15], v2 offset:2048
  v_mfma_f32_16x16x32_bf16 v[208:211], v[40:43], v[32:35], v[208:211]
  ds_read_b128 v[16:19], v2 offset:4096
  v_mfma_f32_16x16x32_bf16 v[232:235], v[40:43], v[36:39], v[232:235]
  ds_read_b128 v[20:23], v2 offset:6144
  v_mfma_f32_16x16x32_bf16 v[164:167], v[44:47], v[24:27], v[164:167]
  v_add_u32 v4, 0x3000, v4
  ds_read_b64_tr_b16 v[40:41], v4 offset:0
  v_mfma_f32_16x16x32_bf16 v[188:191], v[44:47], v[28:31], v[188:191]
  ds_read_b64_tr_b16 v[42:43], v4 offset:1536
  v_mfma_f32_16x16x32_bf16 v[212:215], v[44:47], v[32:35], v[212:215]
  v_mfma_f32_16x16x32_bf16 v[236:239], v[44:47], v[36:39], v[236:239]
  v_mfma_f32_16x16x32_bf16 v[168:171], v[48:51], v[24:27], v[168:171]
  v_add_u32 v5, 0x3000, v5
  ds_read_b64_tr_b16 v[44:45], v5 offset:0
  v_mfma_f32_16x16x32_bf16 v[192:195], v[48:51], v[28:31], v[192:195]
  ds_read_b64_tr_b16 v[46:47], v5 offset:1536
  v_mfma_f32_16x16x32_bf16 v[216:219], v[48:51], v[32:35], v[216:219]
  v_mfma_f32_16x16x32_bf16 v[240:243], v[48:51], v[36:39], v[240:243]
  v_mfma_f32_16x16x32_bf16 v[172:175], v[52:55], v[24:27], v[172:175]
  ds_read_b64_tr_b16 v[48:49], v4 offset:512
  v_mfma_f32_16x16x32_bf16 v[196:199], v[52:55], v[28:31], v[196:199]
  ds_read_b64_tr_b16 v[50:51], v4 offset:2048
  v_mfma_f32_16x16x32_bf16 v[220:223], v[52:55], v[32:35], v[220:223]
  v_mfma_f32_16x16x32_bf16 v[244:247], v[52:55], v[36:39], v[244:247]
  v_mfma_f32_16x16x32_bf16 v[176:179], v[24:27], v[56:59], v[176:179]
  ds_read_b64_tr_b16 v[52:53], v5 offset:512
  v_mfma_f32_16x16x32_bf16 v[200:203], v[28:31], v[56:59], v[200:203]
  ds_read_b64_tr_b16 v[54:55], v5 offset:2048
  v_mfma_f32_16x16x32_bf16 v[224:227], v[32:35], v[56:59], v[224:227]
  v_mfma_f32_16x16x32_bf16 v[248:251], v[36:39], v[56:59], v[248:251]
  v_mfma_f32_16x16x32_bf16 v[180:183], v[24:27], v[60:63], v[180:183]
  ds_read_b64_tr_b16 v[56:57], v4 offset:1024
  v_mfma_f32_16x16x32_bf16 v[204:207], v[28:31], v[60:63], v[204:207]
  ds_read_b64_tr_b16 v[58:59], v4 offset:2560
  v_mfma_f32_16x16x32_bf16 v[228:231], v[32:35], v[60:63], v[228:231]
  v_mfma_f32_16x16x32_bf16 v[252:255], v[36:39], v[60:63], v[252:255]
L_qkv_kernel_st12:
  s_waitcnt lgkmcnt(8)
  v_mfma_f32_16x16x32_bf16 v[64:67], v[40:43], v[8:11], v[64:67]
  ds_read_b64_tr_b16 v[60:61], v5 offset:1024
  v_mfma_f32_16x16x32_bf16 v[88:91], v[40:43], v[12:15], v[88:91]
  ds_read_b64_tr_b16 v[62:63], v5 offset:2560
  v_mfma_f32_16x16x32_bf16 v[112:115], v[40:43], v[16:19], v[112:115]
  ds_read_b128 v[24:27], v2 offset:8192
  v_mfma_f32_16x16x32_bf16 v[136:139], v[40:43], v[20:23], v[136:139]
  ds_read_b128 v[28:31], v2 offset:10240
  s_waitcnt lgkmcnt(10)
  v_mfma_f32_16x16x32_bf16 v[68:71], v[44:47], v[8:11], v[68:71]
  ds_read_b128 v[32:35], v2 offset:12288
  v_mfma_f32_16x16x32_bf16 v[92:95], v[44:47], v[12:15], v[92:95]
  ds_read_b128 v[36:39], v2 offset:14336
  v_mfma_f32_16x16x32_bf16 v[116:119], v[44:47], v[16:19], v[116:119]
  v_mfma_f32_16x16x32_bf16 v[140:143], v[44:47], v[20:23], v[140:143]
  s_waitcnt lgkmcnt(10)
  v_mfma_f32_16x16x32_bf16 v[72:75], v[48:51], v[8:11], v[72:75]
  v_mfma_f32_16x16x32_bf16 v[96:99], v[48:51], v[12:15], v[96:99]
  v_mfma_f32_16x16x32_bf16 v[120:123], v[48:51], v[16:19], v[120:123]
  v_mfma_f32_16x16x32_bf16 v[144:147], v[48:51], v[20:23], v[144:147]
  s_waitcnt lgkmcnt(8)
  v_mfma_f32_16x16x32_bf16 v[76:79], v[52:55], v[8:11], v[76:79]
  v_mfma_f32_16x16x32_bf16 v[100:103], v[52:55], v[12:15], v[100:103]
  v_mfma_f32_16x16x32_bf16 v[124:127], v[52:55], v[16:19], v[124:127]
  v_mfma_f32_16x16x32_bf16 v[148:151], v[52:55], v[20:23], v[148:151]
  s_waitcnt lgkmcnt(6)
  v_mfma_f32_16x16x32_bf16 v[80:83], v[8:11], v[56:59], v[80:83]
  v_mfma_f32_16x16x32_bf16 v[104:107], v[12:15], v[56:59], v[104:107]
  v_mfma_f32_16x16x32_bf16 v[128:131], v[16:19], v[56:59], v[128:131]
  v_mfma_f32_16x16x32_bf16 v[152:155], v[20:23], v[56:59], v[152:155]
  s_waitcnt lgkmcnt(4)
  v_mfma_f32_16x16x32_bf16 v[84:87], v[8:11], v[60:63], v[84:87]
  v_mfma_f32_16x16x32_bf16 v[108:111], v[12:15], v[60:63], v[108:111]
  v_mfma_f32_16x16x32_bf16 v[132:135], v[16:19], v[60:63], v[132:135]
  v_mfma_f32_16x16x32_bf16 v[156:159], v[20:23], v[60:63], v[156:159]
  s_waitcnt lgkmcnt(0)
  s_barrier
  v_mfma_f32_16x16x32_bf16 v[160:163], v[40:43], v[24:27], v[160:163]
  v_add_u32 v3, 0xffff0000, v3
  ds_read_b128 v[8:11], v3 offset:0
  v_mfma_f32_16x16x32_bf16 v[184:187], v[40:43], v[28:31], v[184:187]
  ds_read_b128 v[12:15], v3 offset:2048
  v_mfma_f32_16x16x32_bf16 v[208:211], v[40:43], v[32:35], v[208:211]
  ds_read_b128 v[16:19], v3 offset:4096
  v_mfma_f32_16x16x32_bf16 v[232:235], v[40:43], v[36:39], v[232:235]
  ds_read_b128 v[20:23], v3 offset:6144
  v_mfma_f32_16x16x32_bf16 v[164:167], v[44:47], v[24:27], v[164:167]
  v_add_u32 v4, 0x3000, v4
  ds_read_b64_tr_b16 v[40:41], v4 offset:0
  v_mfma_f32_16x16x32_bf16 v[188:191], v[44:47], v[28:31], v[188:191]
  ds_read_b64_tr_b16 v[42:43], v4 offset:1536
  v_mfma_f32_16x16x32_bf16 v[212:215], v[44:47], v[32:35], v[212:215]
  v_mfma_f32_16x16x32_bf16 v[236:239], v[44:47], v[36:39], v[236:239]
  v_mfma_f32_16x16x32_bf16 v[168:171], v[48:51], v[24:27], v[168:171]
  v_add_u32 v5, 0x3000, v5
  ds_read_b64_tr_b16 v[44:45], v5 offset:0
  v_mfma_f32_16x16x32_bf16 v[192:195], v[48:51], v[28:31], v[192:195]
  ds_read_b64_tr_b16 v[46:47], v5 offset:1536
  v_mfma_f32_16x16x32_bf16 v[216:219], v[48:51], v[32:35], v[216:219]
  v_mfma_f32_16x16x32_bf16 v[240:243], v[48:51], v[36:39], v[240:243]
  v_mfma_f32_16x16x32_bf16 v[172:175], v[52:55], v[24:27], v[172:175]
  ds_read_b64_tr_b16 v[48:49], v4 offset:512
  v_mfma_f32_16x16x32_bf16 v[196:199], v[52:55], v[28:31], v[196:199]
  ds_read_b64_tr_b16 v[50:51], v4 offset:2048
  v_mfma_f32_16x16x32_bf16 v[220:223], v[52:55], v[32:35], v[220:223]
  v_mfma_f32_16x16x32_bf16 v[244:247], v[52:55], v[36:39], v[244:247]
  v_mfma_f32_16x16x32_bf16 v[176:179], v[24:27], v[56:59], v[176:179]
  ds_read_b64_tr_b16 v[52:53], v5 offset:512
  v_mfma_f32_16x16x32_bf16 v[200:203], v[28:31], v[56:59], v[200:203]
  ds_read_b64_tr_b16 v[54:55], v5 offset:2048
  v_mfma_f32_16x16x32_bf16 v[224:227], v[32:35], v[56:59], v[224:227]
  v_mfma_f32_16x16x32_bf16 v[248:251], v[36:39], v[56:59], v[248:251]
  v_mfma_f32_16x16x32_bf16 v[180:183], v[24:27], v[60:63], v[180:183]
  ds_read_b64_tr_b16 v[56:57], v4 offset:1024
  v_mfma_f32_16x16x32_bf16 v[204:207], v[28:31], v[60:63], v[204:207]
  ds_read_b64_tr_b16 v[58:59], v4 offset:2560
  v_mfma_f32_16x16x32_bf16 v[228:231], v[32:35], v[60:63], v[228:231]
  v_mfma_f32_16x16x32_bf16 v[252:255], v[36:39], v[60:63], v[252:255]
L_qkv_kernel_st13:
  s_waitcnt lgkmcnt(8)
  v_mfma_f32_16x16x32_bf16 v[64:67], v[40:43], v[8:11], v[64:67]
  ds_read_b64_tr_b16 v[60:61], v5 offset:1024
  v_mfma_f32_16x16x32_bf16 v[88:91], v[40:43], v[12:15], v[88:91]
  ds_read_b64_tr_b16 v[62:63], v5 offset:2560
  v_mfma_f32_16x16x32_bf16 v[112:115], v[40:43], v[16:19], v[112:115]
  ds_read_b128 v[24:27], v3 offset:8192
  v_mfma_f32_16x16x32_bf16 v[136:139], v[40:43], v[20:23], v[136:139]
  ds_read_b128 v[28:31], v3 offset:10240
  s_waitcnt lgkmcnt(10)
  v_mfma_f32_16x16x32_bf16 v[68:71], v[44:47], v[8:11], v[68:71]
  ds_read_b128 v[32:35], v3 offset:12288
  v_mfma_f32_16x16x32_bf16 v[92:95], v[44:47], v[12:15], v[92:95]
  ds_read_b128 v[36:39], v3 offset:14336
  v_mfma_f32_16x16x32_bf16 v[116:119], v[44:47], v[16:19], v[116:119]
  v_mfma_f32_16x16x32_bf16 v[140:143], v[44:47], v[20:23], v[140:143]
  s_waitcnt lgkmcnt(10)
  v_mfma_f32_16x16x32_bf16 v[72:75], v[48:51], v[8:11], v[72:75]
  v_mfma_f32_16x16x32_bf16 v[96:99], v[48:51], v[12:15], v[96:99]
  v_mfma_f32_16x16x32_bf16 v[120:123], v[48:51], v[16:19], v[120:123]
  v_mfma_f32_16x16x32_bf16 v[144:147], v[48:51], v[20:23], v[144:147]
  s_waitcnt lgkmcnt(8)
  v_mfma_f32_16x16x32_bf16 v[76:79], v[52:55], v[8:11], v[76:79]
  v_mfma_f32_16x16x32_bf16 v[100:103], v[52:55], v[12:15], v[100:103]
  v_mfma_f32_16x16x32_bf16 v[124:127], v[52:55], v[16:19], v[124:127]
  v_mfma_f32_16x16x32_bf16 v[148:151], v[52:55], v[20:23], v[148:151]
  s_waitcnt lgkmcnt(6)
  v_mfma_f32_16x16x32_bf16 v[80:83], v[8:11], v[56:59], v[80:83]
  v_mfma_f32_16x16x32_bf16 v[104:107], v[12:15], v[56:59], v[104:107]
  v_mfma_f32_16x16x32_bf16 v[128:131], v[16:19], v[56:59], v[128:131]
  v_mfma_f32_16x16x32_bf16 v[152:155], v[20:23], v[56:59], v[152:155]
  s_waitcnt lgkmcnt(4)
  v_mfma_f32_16x16x32_bf16 v[84:87], v[8:11], v[60:63], v[84:87]
  v_mfma_f32_16x16x32_bf16 v[108:111], v[12:15], v[60:63], v[108:111]
  v_mfma_f32_16x16x32_bf16 v[132:135], v[16:19], v[60:63], v[132:135]
  v_mfma_f32_16x16x32_bf16 v[156:159], v[20:23], v[60:63], v[156:159]
  s_waitcnt lgkmcnt(0)
  s_barrier
  v_mfma_f32_16x16x32_bf16 v[160:163], v[40:43], v[24:27], v[160:163]
  v_add_u32 v2, 0x8000, v2
  ds_read_b128 v[8:11], v2 offset:0
  v_mfma_f32_16x16x32_bf16 v[184:187], v[40:43], v[28:31], v[184:187]
  ds_read_b128 v[12:15], v2 offset:2048
  v_mfma_f32_16x16x32_bf16 v[208:211], v[40:43], v[32:35], v[208:211]
  ds_read_b128 v[16:19], v2 offset:4096
  v_mfma_f32_16x16x32_bf16 v[232:235], v[40:43], v[36:39], v[232:235]
  ds_read_b128 v[20:23], v2 offset:6144
  v_mfma_f32_16x16x32_bf16 v[164:167], v[44:47], v[24:27], v[164:167]
  v_add_u32 v4, 0x3000, v4
  ds_read_b64_tr_b16 v[40:41], v4 offset:0
  v_mfma_f32_16x16x32_bf16 v[188:191], v[44:47], v[28:31], v[188:191]
  ds_read_b64_tr_b16 v[42:43], v4 offset:1536
  v_mfma_f32_16x16x32_bf16 v[212:215], v[44:47], v[32:35], v[212:215]
  v_mfma_f32_16x16x32_bf16 v[236:239], v[44:47], v[36:39], v[236:239]
  v_mfma_f32_16x16x32_bf16 v[168:171], v[48:51], v[24:27], v[168:171]
  v_add_u32 v5, 0x3000, v5
  ds_read_b64_tr_b16 v[44:45], v5 offset:0
  v_mfma_f32_16x16x32_bf16 v[192:195], v[48:51], v[28:31], v[192:195]
  ds_read_b64_tr_b16 v[46:47], v5 offset:1536
  v_mfma_f32_16x16x32_bf16 v[216:219], v[48:51], v[32:35], v[216:219]
  v_mfma_f32_16x16x32_bf16 v[240:243], v[48:51], v[36:39], v[240:243]
  v_mfma_f32_16x16x32_bf16 v[172:175], v[52:55], v[24:27], v[172:175]
  ds_read_b64_tr_b16 v[48:49], v4 offset:512
  v_mfma_f32_16x16x32_bf16 v[196:199], v[52:55], v[28:31], v[196:199]
  ds_read_b64_tr_b16 v[50:51], v4 offset:2048
  v_mfma_f32_16x16x32_bf16 v[220:223], v[52:55], v[32:35], v[220:223]
  v_mfma_f32_16x16x32_bf16 v[244:247], v[52:55], v[36:39], v[244:247]
  v_mfma_f32_16x16x32_bf16 v[176:179], v[24:27], v[56:59], v[176:179]
  ds_read_b64_tr_b16 v[52:53], v5 offset:512
  v_mfma_f32_16x16x32_bf16 v[200:203], v[28:31], v[56:59], v[200:203]
  ds_read_b64_tr_b16 v[54:55], v5 offset:2048
  v_mfma_f32_16x16x32_bf16 v[224:227], v[32:35], v[56:59], v[224:227]
  v_mfma_f32_16x16x32_bf16 v[248:251], v[36:39], v[56:59], v[248:251]
  v_mfma_f32_16x16x32_bf16 v[180:183], v[24:27], v[60:63], v[180:183]
  ds_read_b64_tr_b16 v[56:57], v4 offset:1024
  v_mfma_f32_16x16x32_bf16 v[204:207], v[28:31], v[60:63], v[204:207]
  ds_read_b64_tr_b16 v[58:59], v4 offset:2560
  v_mfma_f32_16x16x32_bf16 v[228:231], v[32:35], v[60:63], v[228:231]
  v_mfma_f32_16x16x32_bf16 v[252:255], v[36:39], v[60:63], v[252:255]
L_qkv_kernel_st14:
  s_waitcnt lgkmcnt(8)
  v_mfma_f32_16x16x32_bf16 v[64:67], v[40:43], v[8:11], v[64:67]
  ds_read_b64_tr_b16 v[60:61], v5 offset:1024
  v_mfma_f32_16x16x32_bf16 v[88:91], v[40:43], v[12:15], v[88:91]
  ds_read_b64_tr_b16 v[62:63], v5 offset:2560
  v_mfma_f32_16x16x32_bf16 v[112:115], v[40:43], v[16:19], v[112:115]
  ds_read_b128 v[24:27], v2 offset:8192
  v_mfma_f32_16x16x32_bf16 v[136:139], v[40:43], v[20:23], v[136:139]
  ds_read_b128 v[28:31], v2 offset:10240
  s_waitcnt lgkmcnt(10)
  v_mfma_f32_16x16x32_bf16 v[68:71], v[44:47], v[8:11], v[68:71]
  ds_read_b128 v[32:35], v2 offset:12288
  v_mfma_f32_16x16x32_bf16 v[92:95], v[44:47], v[12:15], v[92:95]
  ds_read_b128 v[36:39], v2 offset:14336
  v_mfma_f32_16x16x32_bf16 v[116:119], v[44:47], v[16:19], v[116:119]
  v_mfma_f32_16x16x32_bf16 v[140:143], v[44:47], v[20:23], v[140:143]
  s_waitcnt lgkmcnt(10)
  v_mfma_f32_16x16x32_bf16 v[72:75], v[48:51], v[8:11], v[72:75]
  v_mfma_f32_16x16x32_bf16 v[96:99], v[48:51], v[12:15], v[96:99]
  v_mfma_f32_16x16x32_bf16 v[120:123], v[48:51], v[16:19], v[120:123]
  v_mfma_f32_16x16x32_bf16 v[144:147], v[48:51], v[20:23], v[144:147]
  s_waitcnt lgkmcnt(8)
  v_mfma_f32_16x16x32_bf16 v[76:79], v[52:55], v[8:11], v[76:79]
  v_mfma_f32_16x16x32_bf16 v[100:103], v[52:55], v[12:15], v[100:103]
  v_mfma_f32_16x16x32_bf16 v[124:127], v[52:55], v[16:19], v[124:127]
  v_mfma_f32_16x16x32_bf16 v[148:151], v[52:55], v[20:23], v[148:151]
  s_waitcnt lgkmcnt(6)
  v_mfma_f32_16x16x32_bf16 v[80:83], v[8:11], v[56:59], v[80:83]
  v_mfma_f32_16x16x32_bf16 v[104:107], v[12:15], v[56:59], v[104:107]
  v_mfma_f32_16x16x32_bf16 v[128:131], v[16:19], v[56:59], v[128:131]
  v_mfma_f32_16x16x32_bf16 v[152:155], v[20:23], v[56:59], v[152:155]
  s_waitcnt lgkmcnt(4)
  v_mfma_f32_16x16x32_bf16 v[84:87], v[8:11], v[60:63], v[84:87]
  v_mfma_f32_16x16x32_bf16 v[108:111], v[12:15], v[60:63], v[108:111]
  v_mfma_f32_16x16x32_bf16 v[132:135], v[16:19], v[60:63], v[132:135]
  v_mfma_f32_16x16x32_bf16 v[156:159], v[20:23], v[60:63], v[156:159]
  s_waitcnt lgkmcnt(0)
  s_barrier
  v_mfma_f32_16x16x32_bf16 v[160:163], v[40:43], v[24:27], v[160:163]
  v_add_u32 v3, 0x8000, v3
  ds_read_b128 v[8:11], v3 offset:0
  v_mfma_f32_16x16x32_bf16 v[184:187], v[40:43], v[28:31], v[184:187]
  ds_read_b128 v[12:15], v3 offset:2048
  v_mfma_f32_16x16x32_bf16 v[208:211], v[40:43], v[32:35], v[208:211]
  ds_read_b128 v[16:19], v3 offset:4096
  v_mfma_f32_16x16x32_bf16 v[232:235], v[40:43], v[36:39], v[232:235]
  ds_read_b128 v[20:23], v3 offset:6144
  v_mfma_f32_16x16x32_bf16 v[164:167], v[44:47], v[24:27], v[164:167]
  v_add_u32 v4, 0xffff4000, v4
  ds_read_b64_tr_b16 v[40:41], v4 offset:0
  v_mfma_f32_16x16x32_bf16 v[188:191], v[44:47], v[28:31], v[188:191]
  ds_read_b64_tr_b16 v[42:43], v4 offset:1536
  v_mfma_f32_16x16x32_bf16 v[212:215], v[44:47], v[32:35], v[212:215]
  v_mfma_f32_16x16x32_bf16 v[236:239], v[44:47], v[36:39], v[236:239]
  v_mfma_f32_16x16x32_bf16 v[168:171], v[48:51], v[24:27], v[168:171]
  v_add_u32 v5, 0xffff4000, v5
  ds_read_b64_tr_b16 v[44:45], v5 offset:0
  v_mfma_f32_16x16x32_bf16 v[192:195], v[48:51], v[28:31], v[192:195]
  ds_read_b64_tr_b16 v[46:47], v5 offset:1536
  v_mfma_f32_16x16x32_bf16 v[216:219], v[48:51], v[32:35], v[216:219]
  v_mfma_f32_16x16x32_bf16 v[240:243], v[48:51], v[36:39], v[240:243]
  v_mfma_f32_16x16x32_bf16 v[172:175], v[52:55], v[24:27], v[172:175]
  ds_read_b64_tr_b16 v[48:49], v4 offset:512
  v_mfma_f32_16x16x32_bf16 v[196:199], v[52:55], v[28:31], v[196:199]
  ds_read_b64_tr_b16 v[50:51], v4 offset:2048
  v_mfma_f32_16x16x32_bf16 v[220:223], v[52:55], v[32:35], v[220:223]
  v_mfma_f32_16x16x32_bf16 v[244:247], v[52:55], v[36:39], v[244:247]
  v_mfma_f32_16x16x32_bf16 v[176:179], v[24:27], v[56:59], v[176:179]
  ds_read_b64_tr_b16 v[52:53], v5 offset:512
  v_mfma_f32_16x16x32_bf16 v[200:203], v[28:31], v[56:59], v[200:203]
  ds_read_b64_tr_b16 v[54:55], v5 offset:2048
  v_mfma_f32_16x16x32_bf16 v[224:227], v[32:35], v[56:59], v[224:227]
  v_mfma_f32_16x16x32_bf16 v[248:251], v[36:39], v[56:59], v[248:251]
  v_mfma_f32_16x16x32_bf16 v[180:183], v[24:27], v[60:63], v[180:183]
  ds_read_b64_tr_b16 v[56:57], v4 offset:1024
  v_mfma_f32_16x16x32_bf16 v[204:207], v[28:31], v[60:63], v[204:207]
  ds_read_b64_tr_b16 v[58:59], v4 offset:2560
  v_mfma_f32_16x16x32_bf16 v[228:231], v[32:35], v[60:63], v[228:231]
  v_mfma_f32_16x16x32_bf16 v[252:255], v[36:39], v[60:63], v[252:255]
L_qkv_kernel_st15:
  s_waitcnt lgkmcnt(8)
  v_mfma_f32_16x16x32_bf16 v[64:67], v[40:43], v[8:11], v[64:67]
  ds_read_b64_tr_b16 v[60:61], v5 offset:1024
  v_mfma_f32_16x16x32_bf16 v[88:91], v[40:43], v[12:15], v[88:91]
  ds_read_b64_tr_b16 v[62:63], v5 offset:2560
  v_mfma_f32_16x16x32_bf16 v[112:115], v[40:43], v[16:19], v[112:115]
  ds_read_b128 v[24:27], v3 offset:8192
  v_mfma_f32_16x16x32_bf16 v[136:139], v[40:43], v[20:23], v[136:139]
  ds_read_b128 v[28:31], v3 offset:10240
  s_waitcnt lgkmcnt(10)
  v_mfma_f32_16x16x32_bf16 v[68:71], v[44:47], v[8:11], v[68:71]
  ds_read_b128 v[32:35], v3 offset:12288
  v_mfma_f32_16x16x32_bf16 v[92:95], v[44:47], v[12:15], v[92:95]
  ds_read_b128 v[36:39], v3 offset:14336
  v_mfma_f32_16x16x32_bf16 v[116:119], v[44:47], v[16:19], v[116:119]
  v_mfma_f32_16x16x32_bf16 v[140:143], v[44:47], v[20:23], v[140:143]
  s_waitcnt lgkmcnt(10)
  v_mfma_f32_16x16x32_bf16 v[72:75], v[48:51], v[8:11], v[72:75]
  v_mfma_f32_16x16x32_bf16 v[96:99], v[48:51], v[12:15], v[96:99]
  v_mfma_f32_16x16x32_bf16 v[120:123], v[48:51], v[16:19], v[120:123]
  v_mfma_f32_16x16x32_bf16 v[144:147], v[48:51], v[20:23], v[144:147]
  s_waitcnt lgkmcnt(8)
  v_mfma_f32_16x16x32_bf16 v[76:79], v[52:55], v[8:11], v[76:79]
  v_mfma_f32_16x16x32_bf16 v[100:103], v[52:55], v[12:15], v[100:103]
  v_mfma_f32_16x16x32_bf16 v[124:127], v[52:55], v[16:19], v[124:127]
  v_mfma_f32_16x16x32_bf16 v[148:151], v[52:55], v[20:23], v[148:151]
  s_waitcnt lgkmcnt(6)
  v_mfma_f32_16x16x32_bf16 v[80:83], v[8:11], v[56:59], v[80:83]
  v_mfma_f32_16x16x32_bf16 v[104:107], v[12:15], v[56:59], v[104:107]
  v_mfma_f32_16x16x32_bf16 v[128:131], v[16:19], v[56:59], v[128:131]
  v_mfma_f32_16x16x32_bf16 v[152:155], v[20:23], v[56:59], v[152:155]
  s_waitcnt lgkmcnt(4)
  v_mfma_f32_16x16x32_bf16 v[84:87], v[8:11], v[60:63], v[84:87]
  v_mfma_f32_16x16x32_bf16 v[108:111], v[12:15], v[60:63], v[108:111]
  v_mfma_f32_16x16x32_bf16 v[132:135], v[16:19], v[60:63], v[132:135]
  v_mfma_f32_16x16x32_bf16 v[156:159], v[20:23], v[60:63], v[156:159]
  s_waitcnt lgkmcnt(0)
  s_barrier
  v_mfma_f32_16x16x32_bf16 v[160:163], v[40:43], v[24:27], v[160:163]
  v_add_u32 v2, 0x8000, v2
  ds_read_b128 v[8:11], v2 offset:0
  v_mfma_f32_16x16x32_bf16 v[184:187], v[40:43], v[28:31], v[184:187]
  ds_read_b128 v[12:15], v2 offset:2048
  v_mfma_f32_16x16x32_bf16 v[208:211], v[40:43], v[32:35], v[208:211]
  ds_read_b128 v[16:19], v2 offset:4096
  v_mfma_f32_16x16x32_bf16 v[232:235], v[40:43], v[36:39], v[232:235]
  ds_read_b128 v[20:23], v2 offset:6144
  v_mfma_f32_16x16x32_bf16 v[164:167], v[44:47], v[24:27], v[164:167]
  v_add_u32 v4, 0x3000, v4
  ds_read_b64_tr_b16 v[40:41], v4 offset:0
  v_mfma_f32_16x16x32_bf16 v[188:191], v[44:47], v[28:31], v[188:191]
  ds_read_b64_tr_b16 v[42:43], v4 offset:1536
  v_mfma_f32_16x16x32_bf16 v[212:215], v[44:47], v[32:35], v[212:215]
  v_mfma_f32_16x16x32_bf16 v[236:239], v[44:47], v[36:39], v[236:239]
  v_mfma_f32_16x16x32_bf16 v[168:171], v[48:51], v[24:27], v[168:171]
  v_add_u32 v5, 0x3000, v5
  ds_read_b64_tr_b16 v[44:45], v5 offset:0
  v_mfma_f32_16x16x32_bf16 v[192:195], v[48:51], v[28:31], v[192:195]
  ds_read_b64_tr_b16 v[46:47], v5 offset:1536
  v_mfma_f32_16x16x32_bf16 v[216:219], v[48:51], v[32:35], v[216:219]
  v_mfma_f32_16x16x32_bf16 v[240:243], v[48:51], v[36:39], v[240:243]
  v_mfma_f32_16x16x32_bf16 v[172:175], v[52:55], v[24:27], v[172:175]
  ds_read_b64_tr_b16 v[48:49], v4 offset:512
  v_mfma_f32_16x16x32_bf16 v[196:199], v[52:55], v[28:31], v[196:199]
  ds_read_b64_tr_b16 v[50:51], v4 offset:2048
  v_mfma_f32_16x16x32_bf16 v[220:223], v[52:55], v[32:35], v[220:223]
  v_mfma_f32_16x16x32_bf16 v[244:247], v[52:55], v[36:39], v[244:247]
  v_mfma_f32_16x16x32_bf16 v[176:179], v[24:27], v[56:59], v[176:179]
  ds_read_b64_tr_b16 v[52:53], v5 offset:512
  v_mfma_f32_16x16x32_bf16 v[200:203], v[28:31], v[56:59], v[200:203]
  ds_read_b64_tr_b16 v[54:55], v5 offset:2048
  v_mfma_f32_16x16x32_bf16 v[224:227], v[32:35], v[56:59], v[224:227]
  v_mfma_f32_16x16x32_bf16 v[248:251], v[36:39], v[56:59], v[248:251]
  v_mfma_f32_16x16x32_bf16 v[180:183], v[24:27], v[60:63], v[180:183]
  ds_read_b64_tr_b16 v[56:57], v4 offset:1024
  v_mfma_f32_16x16x32_bf16 v[204:207], v[28:31], v[60:63], v[204:207]
  ds_read_b64_tr_b16 v[58:59], v4 offset:2560
  v_mfma_f32_16x16x32_bf16 v[228:231], v[32:35], v[60:63], v[228:231]
  v_mfma_f32_16x16x32_bf16 v[252:255], v[36:39], v[60:63], v[252:255]
L_qkv_kernel_st16:
  s_waitcnt lgkmcnt(8)
  v_mfma_f32_16x16x32_bf16 v[64:67], v[40:43], v[8:11], v[64:67]
  ds_read_b64_tr_b16 v[60:61], v5 offset:1024
  v_mfma_f32_16x16x32_bf16 v[88:91], v[40:43], v[12:15], v[88:91]
  ds_read_b64_tr_b16 v[62:63], v5 offset:2560
  v_mfma_f32_16x16x32_bf16 v[112:115], v[40:43], v[16:19], v[112:115]
  ds_read_b128 v[24:27], v2 offset:8192
  v_mfma_f32_16x16x32_bf16 v[136:139], v[40:43], v[20:23], v[136:139]
  ds_read_b128 v[28:31], v2 offset:10240
  s_waitcnt lgkmcnt(10)
  v_mfma_f32_16x16x32_bf16 v[68:71], v[44:47], v[8:11], v[68:71]
  ds_read_b128 v[32:35], v2 offset:12288
  v_mfma_f32_16x16x32_bf16 v[92:95], v[44:47], v[12:15], v[92:95]
  ds_read_b128 v[36:39], v2 offset:14336
  v_mfma_f32_16x16x32_bf16 v[116:119], v[44:47], v[16:19], v[116:119]
  v_mfma_f32_16x16x32_bf16 v[140:143], v[44:47], v[20:23], v[140:143]
  s_waitcnt lgkmcnt(10)
  v_mfma_f32_16x16x32_bf16 v[72:75], v[48:51], v[8:11], v[72:75]
  v_mfma_f32_16x16x32_bf16 v[96:99], v[48:51], v[12:15], v[96:99]
  v_mfma_f32_16x16x32_bf16 v[120:123], v[48:51], v[16:19], v[120:123]
  v_mfma_f32_16x16x32_bf16 v[144:147], v[48:51], v[20:23], v[144:147]
  s_waitcnt lgkmcnt(8)
  v_mfma_f32_16x16x32_bf16 v[76:79], v[52:55], v[8:11], v[76:79]
  v_mfma_f32_16x16x32_bf16 v[100:103], v[52:55], v[12:15], v[100:103]
  v_mfma_f32_16x16x32_bf16 v[124:127], v[52:55], v[16:19], v[124:127]
  v_mfma_f32_16x16x32_bf16 v[148:151], v[52:55], v[20:23], v[148:151]
  s_waitcnt lgkmcnt(6)
  v_mfma_f32_16x16x32_bf16 v[80:83], v[8:11], v[56:59], v[80:83]
  v_mfma_f32_16x16x32_bf16 v[104:107], v[12:15], v[56:59], v[104:107]
  v_mfma_f32_16x16x32_bf16 v[128:131], v[16:19], v[56:59], v[128:131]
  v_mfma_f32_16x16x32_bf16 v[152:155], v[20:23], v[56:59], v[152:155]
  s_waitcnt lgkmcnt(4)
  v_mfma_f32_16x16x32_bf16 v[84:87], v[8:11], v[60:63], v[84:87]
  v_mfma_f32_16x16x32_bf16 v[108:111], v[12:15], v[60:63], v[108:111]
  v_mfma_f32_16x16x32_bf16 v[132:135], v[16:19], v[60:63], v[132:135]
  v_mfma_f32_16x16x32_bf16 v[156:159], v[20:23], v[60:63], v[156:159]
  s_waitcnt lgkmcnt(0)
  s_barrier
  v_mfma_f32_16x16x32_bf16 v[160:163], v[40:43], v[24:27], v[160:163]
  v_add_u32 v3, 0x8000, v3
  ds_read_b128 v[8:11], v3 offset:0
  v_mfma_f32_16x16x32_bf16 v[184:187], v[40:43], v[28:31], v[184:187]
  ds_read_b128 v[12:15], v3 offset:2048
  v_mfma_f32_16x16x32_bf16 v[208:211], v[40:43], v[32:35], v[208:211]
  ds_read_b128 v[16:19], v3 offset:4096
  v_mfma_f32_16x16x32_bf16 v[232:235], v[40:43], v[36:39], v[232:235]
  ds_read_b128 v[20:23], v3 offset:6144
  v_mfma_f32_16x16x32_bf16 v[164:167], v[44:47], v[24:27], v[164:167]
  v_add_u32 v4, 0x3000, v4
  ds_read_b64_tr_b16 v[40:41], v4 offset:0
  v_mfma_f32_16x16x32_bf16 v[188:191], v[44:47], v[28:31], v[188:191]
  ds_read_b64_tr_b16 v[42:43], v4 offset:1536
  v_mfma_f32_16x16x32_bf16 v[212:215], v[44:47], v[32:35], v[212:215]
  v_mfma_f32_16x16x32_bf16 v[236:239], v[44:47], v[36:39], v[236:239]
  v_mfma_f32_16x16x32_bf16 v[168:171], v[48:51], v[24:27], v[168:171]
  v_add_u32 v5, 0x3000, v5
  ds_read_b64_tr_b16 v[44:45], v5 offset:0
  v_mfma_f32_16x16x32_bf16 v[192:195], v[48:51], v[28:31], v[192:195]
  ds_read_b64_tr_b16 v[46:47], v5 offset:1536
  v_mfma_f32_16x16x32_bf16 v[216:219], v[48:51], v[32:35], v[216:219]
  v_mfma_f32_16x16x32_bf16 v[240:243], v[48:51], v[36:39], v[240:243]
  v_mfma_f32_16x16x32_bf16 v[172:175], v[52:55], v[24:27], v[172:175]
  ds_read_b64_tr_b16 v[48:49], v4 offset:512
  v_mfma_f32_16x16x32_bf16 v[196:199], v[52:55], v[28:31], v[196:199]
  ds_read_b64_tr_b16 v[50:51], v4 offset:2048
  v_mfma_f32_16x16x32_bf16 v[220:223], v[52:55], v[32:35], v[220:223]
  v_mfma_f32_16x16x32_bf16 v[244:247], v[52:55], v[36:39], v[244:247]
  v_mfma_f32_16x16x32_bf16 v[176:179], v[24:27], v[56:59], v[176:179]
  ds_read_b64_tr_b16 v[52:53], v5 offset:512
  v_mfma_f32_16x16x32_bf16 v[200:203], v[28:31], v[56:59], v[200:203]
  ds_read_b64_tr_b16 v[54:55], v5 offset:2048
  v_mfma_f32_16x16x32_bf16 v[224:227], v[32:35], v[56:59], v[224:227]
  v_mfma_f32_16x16x32_bf16 v[248:251], v[36:39], v[56:59], v[248:251]
  v_mfma_f32_16x16x32_bf16 v[180:183], v[24:27], v[60:63], v[180:183]
  ds_read_b64_tr_b16 v[56:57], v4 offset:1024
  v_mfma_f32_16x16x32_bf16 v[204:207], v[28:31], v[60:63], v[204:207]
  ds_read_b64_tr_b16 v[58:59], v4 offset:2560
  v_mfma_f32_16x16x32_bf16 v[228:231], v[32:35], v[60:63], v[228:231]
  v_mfma_f32_16x16x32_bf16 v[252:255], v[36:39], v[60:63], v[252:255]
L_qkv_kernel_st17:
  s_waitcnt lgkmcnt(8)
  v_mfma_f32_16x16x32_bf16 v[64:67], v[40:43], v[8:11], v[64:67]
  ds_read_b64_tr_b16 v[60:61], v5 offset:1024
  v_mfma_f32_16x16x32_bf16 v[88:91], v[40:43], v[12:15], v[88:91]
  ds_read_b64_tr_b16 v[62:63], v5 offset:2560
  v_mfma_f32_16x16x32_bf16 v[112:115], v[40:43], v[16:19], v[112:115]
  ds_read_b128 v[24:27], v3 offset:8192
  v_mfma_f32_16x16x32_bf16 v[136:139], v[40:43], v[20:23], v[136:139]
  ds_read_b128 v[28:31], v3 offset:10240
  s_waitcnt lgkmcnt(10)
  v_mfma_f32_16x16x32_bf16 v[68:71], v[44:47], v[8:11], v[68:71]
  ds_read_b128 v[32:35], v3 offset:12288
  v_mfma_f32_16x16x32_bf16 v[92:95], v[44:47], v[12:15], v[92:95]
  ds_read_b128 v[36:39], v3 offset:14336
  v_mfma_f32_16x16x32_bf16 v[116:119], v[44:47], v[16:19], v[116:119]
  v_mfma_f32_16x16x32_bf16 v[140:143], v[44:47], v[20:23], v[140:143]
  s_waitcnt lgkmcnt(10)
  v_mfma_f32_16x16x32_bf16 v[72:75], v[48:51], v[8:11], v[72:75]
  v_mfma_f32_16x16x32_bf16 v[96:99], v[48:51], v[12:15], v[96:99]
  v_mfma_f32_16x16x32_bf16 v[120:123], v[48:51], v[16:19], v[120:123]
  v_mfma_f32_16x16x32_bf16 v[144:147], v[48:51], v[20:23], v[144:147]
  s_waitcnt lgkmcnt(8)
  v_mfma_f32_16x16x32_bf16 v[76:79], v[52:55], v[8:11], v[76:79]
  v_mfma_f32_16x16x32_bf16 v[100:103], v[52:55], v[12:15], v[100:103]
  v_mfma_f32_16x16x32_bf16 v[124:127], v[52:55], v[16:19], v[124:127]
  v_mfma_f32_16x16x32_bf16 v[148:151], v[52:55], v[20:23], v[148:151]
  s_waitcnt lgkmcnt(6)
  v_mfma_f32_16x16x32_bf16 v[80:83], v[8:11], v[56:59], v[80:83]
  v_mfma_f32_16x16x32_bf16 v[104:107], v[12:15], v[56:59], v[104:107]
  v_mfma_f32_16x16x32_bf16 v[128:131], v[16:19], v[56:59], v[128:131]
  v_mfma_f32_16x16x32_bf16 v[152:155], v[20:23], v[56:59], v[152:155]
  s_waitcnt lgkmcnt(4)
  v_mfma_f32_16x16x32_bf16 v[84:87], v[8:11], v[60:63], v[84:87]
  v_mfma_f32_16x16x32_bf16 v[108:111], v[12:15], v[60:63], v[108:111]
  v_mfma_f32_16x16x32_bf16 v[132:135], v[16:19], v[60:63], v[132:135]
  v_mfma_f32_16x16x32_bf16 v[156:159], v[20:23], v[60:63], v[156:159]
  s_waitcnt lgkmcnt(0)
  s_barrier
  v_mfma_f32_16x16x32_bf16 v[160:163], v[40:43], v[24:27], v[160:163]
  v_add_u32 v2, 0xffff0000, v2
  ds_read_b128 v[8:11], v2 offset:0
  v_mfma_f32_16x16x32_bf16 v[184:187], v[40:43], v[28:31], v[184:187]
  ds_read_b128 v[12:15], v2 offset:2048
  v_mfma_f32_16x16x32_bf16 v[208:211], v[40:43], v[32:35], v[208:211]
  ds_read_b128 v[16:19], v2 offset:4096
  v_mfma_f32_16x16x32_bf16 v[232:235], v[40:43], v[36:39], v[232:235]
  ds_read_b128 v[20:23], v2 offset:6144
  v_mfma_f32_16x16x32_bf16 v[164:167], v[44:47], v[24:27], v[164:167]
  v_add_u32 v4, 0x3000, v4
  ds_read_b64_tr_b16 v[40:41], v4 offset:0
  v_mfma_f32_16x16x32_bf16 v[188:191], v[44:47], v[28:31], v[188:191]
  ds_read_b64_tr_b16 v[42:43], v4 offset:1536
  v_mfma_f32_16x16x32_bf16 v[212:215], v[44:47], v[32:35], v[212:215]
  v_mfma_f32_16x16x32_bf16 v[236:239], v[44:47], v[36:39], v[236:239]
  v_mfma_f32_16x16x32_bf16 v[168:171], v[48:51], v[24:27], v[168:171]
  v_add_u32 v5, 0x3000, v5
  ds_read_b64_tr_b16 v[44:45], v5 offset:0
  v_mfma_f32_16x16x32_bf16 v[192:195], v[48:51], v[28:31], v[192:195]
  ds_read_b64_tr_b16 v[46:47], v5 offset:1536
  v_mfma_f32_16x16x32_bf16 v[216:219], v[48:51], v[32:35], v[216:219]
  v_mfma_f32_16x16x32_bf16 v[240:243], v[48:51], v[36:39], v[240:243]
  v_mfma_f32_16x16x32_bf16 v[172:175], v[52:55], v[24:27], v[172:175]
  ds_read_b64_tr_b16 v[48:49], v4 offset:512
  v_mfma_f32_16x16x32_bf16 v[196:199], v[52:55], v[28:31], v[196:199]
  ds_read_b64_tr_b16 v[50:51], v4 offset:2048
  v_mfma_f32_16x16x32_bf16 v[220:223], v[52:55], v[32:35], v[220:223]
  v_mfma_f32_16x16x32_bf16 v[244:247], v[52:55], v[36:39], v[244:247]
  v_mfma_f32_16x16x32_bf16 v[176:179], v[24:27], v[56:59], v[176:179]
  ds_read_b64_tr_b16 v[52:53], v5 offset:512
  v_mfma_f32_16x16x32_bf16 v[200:203], v[28:31], v[56:59], v[200:203]
  ds_read_b64_tr_b16 v[54:55], v5 offset:2048
  v_mfma_f32_16x16x32_bf16 v[224:227], v[32:35], v[56:59], v[224:227]
  v_mfma_f32_16x16x32_bf16 v[248:251], v[36:39], v[56:59], v[248:251]
  v_mfma_f32_16x16x32_bf16 v[180:183], v[24:27], v[60:63], v[180:183]
  ds_read_b64_tr_b16 v[56:57], v4 offset:1024
  v_mfma_f32_16x16x32_bf16 v[204:207], v[28:31], v[60:63], v[204:207]
  ds_read_b64_tr_b16 v[58:59], v4 offset:2560
  v_mfma_f32_16x16x32_bf16 v[228:231], v[32:35], v[60:63], v[228:231]
  v_mfma_f32_16x16x32_bf16 v[252:255], v[36:39], v[60:63], v[252:255]
L_qkv_kernel_st18:
  s_waitcnt lgkmcnt(8)
  v_mfma_f32_16x16x32_bf16 v[64:67], v[40:43], v[8:11], v[64:67]
  ds_read_b64_tr_b16 v[60:61], v5 offset:1024
  v_mfma_f32_16x16x32_bf16 v[88:91], v[40:43], v[12:15], v[88:91]
  ds_read_b64_tr_b16 v[62:63], v5 offset:2560
  v_mfma_f32_16x16x32_bf16 v[112:115], v[40:43], v[16:19], v[112:115]
  ds_read_b128 v[24:27], v2 offset:8192
  v_mfma_f32_16x16x32_bf16 v[136:139], v[40:43], v[20:23], v[136:139]
  ds_read_b128 v[28:31], v2 offset:10240
  s_waitcnt lgkmcnt(10)
  v_mfma_f32_16x16x32_bf16 v[68:71], v[44:47], v[8:11], v[68:71]
  ds_read_b128 v[32:35], v2 offset:12288
  v_mfma_f32_16x16x32_bf16 v[92:95], v[44:47], v[12:15], v[92:95]
  ds_read_b128 v[36:39], v2 offset:14336
  v_mfma_f32_16x16x32_bf16 v[116:119], v[44:47], v[16:19], v[116:119]
  v_mfma_f32_16x16x32_bf16 v[140:143], v[44:47], v[20:23], v[140:143]
  s_waitcnt lgkmcnt(10)
  v_mfma_f32_16x16x32_bf16 v[72:75], v[48:51], v[8:11], v[72:75]
  v_mfma_f32_16x16x32_bf16 v[96:99], v[48:51], v[12:15], v[96:99]
  v_mfma_f32_16x16x32_bf16 v[120:123], v[48:51], v[16:19], v[120:123]
  v_mfma_f32_16x16x32_bf16 v[144:147], v[48:51], v[20:23], v[144:147]
  s_waitcnt lgkmcnt(8)
  v_mfma_f32_16x16x32_bf16 v[76:79], v[52:55], v[8:11], v[76:79]
  v_mfma_f32_16x16x32_bf16 v[100:103], v[52:55], v[12:15], v[100:103]
  v_mfma_f32_16x16x32_bf16 v[124:127], v[52:55], v[16:19], v[124:127]
  v_mfma_f32_16x16x32_bf16 v[148:151], v[52:55], v[20:23], v[148:151]
  s_waitcnt lgkmcnt(6)
  v_mfma_f32_16x16x32_bf16 v[80:83], v[8:11], v[56:59], v[80:83]
  v_mfma_f32_16x16x32_bf16 v[104:107], v[12:15], v[56:59], v[104:107]
  v_mfma_f32_16x16x32_bf16 v[128:131], v[16:19], v[56:59], v[128:131]
  v_mfma_f32_16x16x32_bf16 v[152:155], v[20:23], v[56:59], v[152:155]
  s_waitcnt lgkmcnt(4)
  v_mfma_f32_16x16x32_bf16 v[84:87], v[8:11], v[60:63], v[84:87]
  v_mfma_f32_16x16x32_bf16 v[108:111], v[12:15], v[60:63], v[108:111]
  v_mfma_f32_16x16x32_bf16 v[132:135], v[16:19], v[60:63], v[132:135]
  v_mfma_f32_16x16x32_bf16 v[156:159], v[20:23], v[60:63], v[156:159]
  s_waitcnt lgkmcnt(0)
  s_barrier
  v_mfma_f32_16x16x32_bf16 v[160:163], v[40:43], v[24:27], v[160:163]
  v_add_u32 v3, 0xffff0000, v3
  ds_read_b128 v[8:11], v3 offset:0
  v_mfma_f32_16x16x32_bf16 v[184:187], v[40:43], v[28:31], v[184:187]
  ds_read_b128 v[12:15], v3 offset:2048
  v_mfma_f32_16x16x32_bf16 v[208:211], v[40:43], v[32:35], v[208:211]
  ds_read_b128 v[16:19], v3 offset:4096
  v_mfma_f32_16x16x32_bf16 v[232:235], v[40:43], v[36:39], v[232:235]
  ds_read_b128 v[20:23], v3 offset:6144
  v_mfma_f32_16x16x32_bf16 v[164:167], v[44:47], v[24:27], v[164:167]
  v_add_u32 v4, 0x3000, v4
  ds_read_b64_tr_b16 v[40:41], v4 offset:0
  v_mfma_f32_16x16x32_bf16 v[188:191], v[44:47], v[28:31], v[188:191]
  ds_read_b64_tr_b16 v[42:43], v4 offset:1536
  v_mfma_f32_16x16x32_bf16 v[212:215], v[44:47], v[32:35], v[212:215]
  v_mfma_f32_16x16x32_bf16 v[236:239], v[44:47], v[36:39], v[236:239]
  v_mfma_f32_16x16x32_bf16 v[168:171], v[48:51], v[24:27], v[168:171]
  v_add_u32 v5, 0x3000, v5
  ds_read_b64_tr_b16 v[44:45], v5 offset:0
  v_mfma_f32_16x16x32_bf16 v[192:195], v[48:51], v[28:31], v[192:195]
  ds_read_b64_tr_b16 v[46:47], v5 offset:1536
  v_mfma_f32_16x16x32_bf16 v[216:219], v[48:51], v[32:35], v[216:219]
  v_mfma_f32_16x16x32_bf16 v[240:243], v[48:51], v[36:39], v[240:243]
  v_mfma_f32_16x16x32_bf16 v[172:175], v[52:55], v[24:27], v[172:175]
  ds_read_b64_tr_b16 v[48:49], v4 offset:512
  v_mfma_f32_16x16x32_bf16 v[196:199], v[52:55], v[28:31], v[196:199]
  ds_read_b64_tr_b16 v[50:51], v4 offset:2048
  v_mfma_f32_16x16x32_bf16 v[220:223], v[52:55], v[32:35], v[220:223]
  v_mfma_f32_16x16x32_bf16 v[244:247], v[52:55], v[36:39], v[244:247]
  v_mfma_f32_16x16x32_bf16 v[176:179], v[24:27], v[56:59], v[176:179]
  ds_read_b64_tr_b16 v[52:53], v5 offset:512
  v_mfma_f32_16x16x32_bf16 v[200:203], v[28:31], v[56:59], v[200:203]
  ds_read_b64_tr_b16 v[54:55], v5 offset:2048
  v_mfma_f32_16x16x32_bf16 v[224:227], v[32:35], v[56:59], v[224:227]
  v_mfma_f32_16x16x32_bf16 v[248:251], v[36:39], v[56:59], v[248:251]
  v_mfma_f32_16x16x32_bf16 v[180:183], v[24:27], v[60:63], v[180:183]
  ds_read_b64_tr_b16 v[56:57], v4 offset:1024
  v_mfma_f32_16x16x32_bf16 v[204:207], v[28:31], v[60:63], v[204:207]
  ds_read_b64_tr_b16 v[58:59], v4 offset:2560
  v_mfma_f32_16x16x32_bf16 v[228:231], v[32:35], v[60:63], v[228:231]
  v_mfma_f32_16x16x32_bf16 v[252:255], v[36:39], v[60:63], v[252:255]
L_qkv_kernel_st19:
  s_waitcnt lgkmcnt(8)
  v_mfma_f32_16x16x32_bf16 v[64:67], v[40:43], v[8:11], v[64:67]
  ds_read_b64_tr_b16 v[60:61], v5 offset:1024
  v_mfma_f32_16x16x32_bf16 v[88:91], v[40:43], v[12:15], v[88:91]
  ds_read_b64_tr_b16 v[62:63], v5 offset:2560
  v_mfma_f32_16x16x32_bf16 v[112:115], v[40:43], v[16:19], v[112:115]
  ds_read_b128 v[24:27], v3 offset:8192
  v_mfma_f32_16x16x32_bf16 v[136:139], v[40:43], v[20:23], v[136:139]
  ds_read_b128 v[28:31], v3 offset:10240
  s_waitcnt lgkmcnt(10)
  v_mfma_f32_16x16x32_bf16 v[68:71], v[44:47], v[8:11], v[68:71]
  ds_read_b128 v[32:35], v3 offset:12288
  v_mfma_f32_16x16x32_bf16 v[92:95], v[44:47], v[12:15], v[92:95]
  ds_read_b128 v[36:39], v3 offset:14336
  v_mfma_f32_16x16x32_bf16 v[116:119], v[44:47], v[16:19], v[116:119]
  v_mfma_f32_16x16x32_bf16 v[140:143], v[44:47], v[20:23], v[140:143]
  s_waitcnt lgkmcnt(10)
  v_mfma_f32_16x16x32_bf16 v[72:75], v[48:51], v[8:11], v[72:75]
  v_mfma_f32_16x16x32_bf16 v[96:99], v[48:51], v[12:15], v[96:99]
  v_mfma_f32_16x16x32_bf16 v[120:123], v[48:51], v[16:19], v[120:123]
  v_mfma_f32_16x16x32_bf16 v[144:147], v[48:51], v[20:23], v[144:147]
  s_waitcnt lgkmcnt(8)
  v_mfma_f32_16x16x32_bf16 v[76:79], v[52:55], v[8:11], v[76:79]
  v_mfma_f32_16x16x32_bf16 v[100:103], v[52:55], v[12:15], v[100:103]
  v_mfma_f32_16x16x32_bf16 v[124:127], v[52:55], v[16:19], v[124:127]
  v_mfma_f32_16x16x32_bf16 v[148:151], v[52:55], v[20:23], v[148:151]
  s_waitcnt lgkmcnt(6)
  v_mfma_f32_16x16x32_bf16 v[80:83], v[8:11], v[56:59], v[80:83]
  v_mfma_f32_16x16x32_bf16 v[104:107], v[12:15], v[56:59], v[104:107]
  v_mfma_f32_16x16x32_bf16 v[128:131], v[16:19], v[56:59], v[128:131]
  v_mfma_f32_16x16x32_bf16 v[152:155], v[20:23], v[56:59], v[152:155]
  s_waitcnt lgkmcnt(4)
  v_mfma_f32_16x16x32_bf16 v[84:87], v[8:11], v[60:63], v[84:87]
  v_mfma_f32_16x16x32_bf16 v[108:111], v[12:15], v[60:63], v[108:111]
  v_mfma_f32_16x16x32_bf16 v[132:135], v[16:19], v[60:63], v[132:135]
  v_mfma_f32_16x16x32_bf16 v[156:159], v[20:23], v[60:63], v[156:159]
  s_waitcnt lgkmcnt(0)
  s_barrier
  v_mfma_f32_16x16x32_bf16 v[160:163], v[40:43], v[24:27], v[160:163]
  v_add_u32 v2, 0x8000, v2
  ds_read_b128 v[8:11], v2 offset:0
  v_mfma_f32_16x16x32_bf16 v[184:187], v[40:43], v[28:31], v[184:187]
  ds_read_b128 v[12:15], v2 offset:2048
  v_mfma_f32_16x16x32_bf16 v[208:211], v[40:43], v[32:35], v[208:211]
  ds_read_b128 v[16:19], v2 offset:4096
  v_mfma_f32_16x16x32_bf16 v[232:235], v[40:43], v[36:39], v[232:235]
  ds_read_b128 v[20:23], v2 offset:6144
  v_mfma_f32_16x16x32_bf16 v[164:167], v[44:47], v[24:27], v[164:167]
  v_add_u32 v4, 0xffff4000, v4
  ds_read_b64_tr_b16 v[40:41], v4 offset:0
  v_mfma_f32_16x16x32_bf16 v[188:191], v[44:47], v[28:31], v[188:191]
  ds_read_b64_tr_b16 v[42:43], v4 offset:1536
  v_mfma_f32_16x16x32_bf16 v[212:215], v[44:47], v[32:35], v[212:215]
  v_mfma_f32_16x16x32_bf16 v[236:239], v[44:47], v[36:39], v[236:239]
  v_mfma_f32_16x16x32_bf16 v[168:171], v[48:51], v[24:27], v[168:171]
  v_add_u32 v5, 0xffff4000, v5
  ds_read_b64_tr_b16 v[44:45], v5 offset:0
  v_mfma_f32_16x16x32_bf16 v[192:195], v[48:51], v[28:31], v[192:195]
  ds_read_b64_tr_b16 v[46:47], v5 offset:1536
  v_mfma_f32_16x16x32_bf16 v[216:219], v[48:51], v[32:35], v[216:219]
  v_mfma_f32_16x16x32_bf16 v[240:243], v[48:51], v[36:39], v[240:243]
  v_mfma_f32_16x16x32_bf16 v[172:175], v[52:55], v[24:27], v[172:175]
  ds_read_b64_tr_b16 v[48:49], v4 offset:512
  v_mfma_f32_16x16x32_bf16 v[196:199], v[52:55], v[28:31], v[196:199]
  ds_read_b64_tr_b16 v[50:51], v4 offset:2048
  v_mfma_f32_16x16x32_bf16 v[220:223], v[52:55], v[32:35], v[220:223]
  v_mfma_f32_16x16x32_bf16 v[244:247], v[52:55], v[36:39], v[244:247]
  v_mfma_f32_16x16x32_bf16 v[176:179], v[24:27], v[56:59], v[176:179]
  ds_read_b64_tr_b16 v[52:53], v5 offset:512
  v_mfma_f32_16x16x32_bf16 v[200:203], v[28:31], v[56:59], v[200:203]
  ds_read_b64_tr_b16 v[54:55], v5 offset:2048
  v_mfma_f32_16x16x32_bf16 v[224:227], v[32:35], v[56:59], v[224:227]
  v_mfma_f32_16x16x32_bf16 v[248:251], v[36:39], v[56:59], v[248:251]
  v_mfma_f32_16x16x32_bf16 v[180:183], v[24:27], v[60:63], v[180:183]
  ds_read_b64_tr_b16 v[56:57], v4 offset:1024
  v_mfma_f32_16x16x32_bf16 v[204:207], v[28:31], v[60:63], v[204:207]
  ds_read_b64_tr_b16 v[58:59], v4 offset:2560
  v_mfma_f32_16x16x32_bf16 v[228:231], v[32:35], v[60:63], v[228:231]
  v_mfma_f32_16x16x32_bf16 v[252:255], v[36:39], v[60:63], v[252:255]
L_qkv_kernel_st20:
  s_waitcnt lgkmcnt(8)
  v_mfma_f32_16x16x32_bf16 v[64:67], v[40:43], v[8:11], v[64:67]
  ds_read_b64_tr_b16 v[60:61], v5 offset:1024
  v_mfma_f32_16x16x32_bf16 v[88:91], v[40:43], v[12:15], v[88:91]
  ds_read_b64_tr_b16 v[62:63], v5 offset:2560
  v_mfma_f32_16x16x32_bf16 v[112:115], v[40:43], v[16:19], v[112:115]
  ds_read_b128 v[24:27], v2 offset:8192
  v_mfma_f32_16x16x32_bf16 v[136:139], v[40:43], v[20:23], v[136:139]
  ds_read_b128 v[28:31], v2 offset:10240
  s_waitcnt lgkmcnt(10)
  v_mfma_f32_16x16x32_bf16 v[68:71], v[44:47], v[8:11], v[68:71]
  ds_read_b128 v[32:35], v2 offset:12288
  v_mfma_f32_16x16x32_bf16 v[92:95], v[44:47], v[12:15], v[92:95]
  ds_read_b128 v[36:39], v2 offset:14336
  v_mfma_f32_16x16x32_bf16 v[116:119], v[44:47], v[16:19], v[116:119]
  v_mfma_f32_16x16x32_bf16 v[140:143], v[44:47], v[20:23], v[140:143]
  s_waitcnt lgkmcnt(10)
  v_mfma_f32_16x16x32_bf16 v[72:75], v[48:51], v[8:11], v[72:75]
  v_mfma_f32_16x16x32_bf16 v[96:99], v[48:51], v[12:15], v[96:99]
  v_mfma_f32_16x16x32_bf16 v[120:123], v[48:51], v[16:19], v[120:123]
  v_mfma_f32_16x16x32_bf16 v[144:147], v[48:51], v[20:23], v[144:147]
  s_waitcnt lgkmcnt(8)
  v_mfma_f32_16x16x32_bf16 v[76:79], v[52:55], v[8:11], v[76:79]
  v_mfma_f32_16x16x32_bf16 v[100:103], v[52:55], v[12:15], v[100:103]
  v_mfma_f32_16x16x32_bf16 v[124:127], v[52:55], v[16:19], v[124:127]
  v_mfma_f32_16x16x32_bf16 v[148:151], v[52:55], v[20:23], v[148:151]
  s_waitcnt lgkmcnt(6)
  v_mfma_f32_16x16x32_bf16 v[80:83], v[8:11], v[56:59], v[80:83]
  v_mfma_f32_16x16x32_bf16 v[104:107], v[12:15], v[56:59], v[104:107]
  v_mfma_f32_16x16x32_bf16 v[128:131], v[16:19], v[56:59], v[128:131]
  v_mfma_f32_16x16x32_bf16 v[152:155], v[20:23], v[56:59], v[152:155]
  s_waitcnt lgkmcnt(4)
  v_mfma_f32_16x16x32_bf16 v[84:87], v[8:11], v[60:63], v[84:87]
  v_mfma_f32_16x16x32_bf16 v[108:111], v[12:15], v[60:63], v[108:111]
  v_mfma_f32_16x16x32_bf16 v[132:135], v[16:19], v[60:63], v[132:135]
  v_mfma_f32_16x16x32_bf16 v[156:159], v[20:23], v[60:63], v[156:159]
  s_waitcnt lgkmcnt(0)
  s_barrier
  v_mfma_f32_16x16x32_bf16 v[160:163], v[40:43], v[24:27], v[160:163]
  v_add_u32 v3, 0x8000, v3
  ds_read_b128 v[8:11], v3 offset:0
  v_mfma_f32_16x16x32_bf16 v[184:187], v[40:43], v[28:31], v[184:187]
  ds_read_b128 v[12:15], v3 offset:2048
  v_mfma_f32_16x16x32_bf16 v[208:211], v[40:43], v[32:35], v[208:211]
  ds_read_b128 v[16:19], v3 offset:4096
  v_mfma_f32_16x16x32_bf16 v[232:235], v[40:43], v[36:39], v[232:235]
  ds_read_b128 v[20:23], v3 offset:6144
  v_mfma_f32_16x16x32_bf16 v[164:167], v[44:47], v[24:27], v[164:167]
  v_add_u32 v4, 0x3000, v4
  ds_read_b64_tr_b16 v[40:41], v4 offset:0
  v_mfma_f32_16x16x32_bf16 v[188:191], v[44:47], v[28:31], v[188:191]
  ds_read_b64_tr_b16 v[42:43], v4 offset:1536
  v_mfma_f32_16x16x32_bf16 v[212:215], v[44:47], v[32:35], v[212:215]
  v_mfma_f32_16x16x32_bf16 v[236:239], v[44:47], v[36:39], v[236:239]
  v_mfma_f32_16x16x32_bf16 v[168:171], v[48:51], v[24:27], v[168:171]
  v_add_u32 v5, 0x3000, v5
  ds_read_b64_tr_b16 v[44:45], v5 offset:0
  v_mfma_f32_16x16x32_bf16 v[192:195], v[48:51], v[28:31], v[192:195]
  ds_read_b64_tr_b16 v[46:47], v5 offset:1536
  v_mfma_f32_16x16x32_bf16 v[216:219], v[48:51], v[32:35], v[216:219]
  v_mfma_f32_16x16x32_bf16 v[240:243], v[48:51], v[36:39], v[240:243]
  v_mfma_f32_16x16x32_bf16 v[172:175], v[52:55], v[24:27], v[172:175]
  ds_read_b64_tr_b16 v[48:49], v4 offset:512
  v_mfma_f32_16x16x32_bf16 v[196:199], v[52:55], v[28:31], v[196:199]
  ds_read_b64_tr_b16 v[50:51], v4 offset:2048
  v_mfma_f32_16x16x32_bf16 v[220:223], v[52:55], v[32:35], v[220:223]
  v_mfma_f32_16x16x32_bf16 v[244:247], v[52:55], v[36:39], v[244:247]
  v_mfma_f32_16x16x32_bf16 v[176:179], v[24:27], v[56:59], v[176:179]
  ds_read_b64_tr_b16 v[52:53], v5 offset:512
  v_mfma_f32_16x16x32_bf16 v[200:203], v[28:31], v[56:59], v[200:203]
  ds_read_b64_tr_b16 v[54:55], v5 offset:2048
  v_mfma_f32_16x16x32_bf16 v[224:227], v[32:35], v[56:59], v[224:227]
  v_mfma_f32_16x16x32_bf16 v[248:251], v[36:39], v[56:59], v[248:251]
  v_mfma_f32_16x16x32_bf16 v[180:183], v[24:27], v[60:63], v[180:183]
  ds_read_b64_tr_b16 v[56:57], v4 offset:1024
  v_mfma_f32_16x16x32_bf16 v[204:207], v[28:31], v[60:63], v[204:207]
  ds_read_b64_tr_b16 v[58:59], v4 offset:2560
  v_mfma_f32_16x16x32_bf16 v[228:231], v[32:35], v[60:63], v[228:231]
  v_mfma_f32_16x16x32_bf16 v[252:255], v[36:39], v[60:63], v[252:255]
L_qkv_kernel_st21:
  s_waitcnt lgkmcnt(8)
  v_mfma_f32_16x16x32_bf16 v[64:67], v[40:43], v[8:11], v[64:67]
  ds_read_b64_tr_b16 v[60:61], v5 offset:1024
  v_mfma_f32_16x16x32_bf16 v[88:91], v[40:43], v[12:15], v[88:91]
  ds_read_b64_tr_b16 v[62:63], v5 offset:2560
  v_mfma_f32_16x16x32_bf16 v[112:115], v[40:43], v[16:19], v[112:115]
  ds_read_b128 v[24:27], v3 offset:8192
  v_mfma_f32_16x16x32_bf16 v[136:139], v[40:43], v[20:23], v[136:139]
  ds_read_b128 v[28:31], v3 offset:10240
  s_waitcnt lgkmcnt(10)
  v_mfma_f32_16x16x32_bf16 v[68:71], v[44:47], v[8:11], v[68:71]
  ds_read_b128 v[32:35], v3 offset:12288
  v_mfma_f32_16x16x32_bf16 v[92:95], v[44:47], v[12:15], v[92:95]
  ds_read_b128 v[36:39], v3 offset:14336
  v_mfma_f32_16x16x32_bf16 v[116:119], v[44:47], v[16:19], v[116:119]
  v_mfma_f32_16x16x32_bf16 v[140:143], v[44:47], v[20:23], v[140:143]
  s_waitcnt lgkmcnt(10)
  v_mfma_f32_16x16x32_bf16 v[72:75], v[48:51], v[8:11], v[72:75]
  v_mfma_f32_16x16x32_bf16 v[96:99], v[48:51], v[12:15], v[96:99]
  v_mfma_f32_16x16x32_bf16 v[120:123], v[48:51], v[16:19], v[120:123]
  v_mfma_f32_16x16x32_bf16 v[144:147], v[48:51], v[20:23], v[144:147]
  s_waitcnt lgkmcnt(8)
  v_mfma_f32_16x16x32_bf16 v[76:79], v[52:55], v[8:11], v[76:79]
  v_mfma_f32_16x16x32_bf16 v[100:103], v[52:55], v[12:15], v[100:103]
  v_mfma_f32_16x16x32_bf16 v[124:127], v[52:55], v[16:19], v[124:127]
  v_mfma_f32_16x16x32_bf16 v[148:151], v[52:55], v[20:23], v[148:151]
  s_waitcnt lgkmcnt(6)
  v_mfma_f32_16x16x32_bf16 v[80:83], v[8:11], v[56:59], v[80:83]
  v_mfma_f32_16x16x32_bf16 v[104:107], v[12:15], v[56:59], v[104:107]
  v_mfma_f32_16x16x32_bf16 v[128:131], v[16:19], v[56:59], v[128:131]
  v_mfma_f32_16x16x32_bf16 v[152:155], v[20:23], v[56:59], v[152:155]
  s_waitcnt lgkmcnt(4)
  v_mfma_f32_16x16x32_bf16 v[84:87], v[8:11], v[60:63], v[84:87]
  v_mfma_f32_16x16x32_bf16 v[108:111], v[12:15], v[60:63], v[108:111]
  v_mfma_f32_16x16x32_bf16 v[132:135], v[16:19], v[60:63], v[132:135]
  v_mfma_f32_16x16x32_bf16 v[156:159], v[20:23], v[60:63], v[156:159]
  s_waitcnt lgkmcnt(0)
  s_barrier
  v_mfma_f32_16x16x32_bf16 v[160:163], v[40:43], v[24:27], v[160:163]
  v_add_u32 v2, 0x8000, v2
  ds_read_b128 v[8:11], v2 offset:0
  v_mfma_f32_16x16x32_bf16 v[184:187], v[40:43], v[28:31], v[184:187]
  ds_read_b128 v[12:15], v2 offset:2048
  v_mfma_f32_16x16x32_bf16 v[208:211], v[40:43], v[32:35], v[208:211]
  ds_read_b128 v[16:19], v2 offset:4096
  v_mfma_f32_16x16x32_bf16 v[232:235], v[40:43], v[36:39], v[232:235]
  ds_read_b128 v[20:23], v2 offset:6144
  v_mfma_f32_16x16x32_bf16 v[164:167], v[44:47], v[24:27], v[164:167]
  v_add_u32 v4, 0x3000, v4
  ds_read_b64_tr_b16 v[40:41], v4 offset:0
  v_mfma_f32_16x16x32_bf16 v[188:191], v[44:47], v[28:31], v[188:191]
  ds_read_b64_tr_b16 v[42:43], v4 offset:1536
  v_mfma_f32_16x16x32_bf16 v[212:215], v[44:47], v[32:35], v[212:215]
  v_mfma_f32_16x16x32_bf16 v[236:239], v[44:47], v[36:39], v[236:239]
  v_mfma_f32_16x16x32_bf16 v[168:171], v[48:51], v[24:27], v[168:171]
  v_add_u32 v5, 0x3000, v5
  ds_read_b64_tr_b16 v[44:45], v5 offset:0
  v_mfma_f32_16x16x32_bf16 v[192:195], v[48:51], v[28:31], v[192:195]
  ds_read_b64_tr_b16 v[46:47], v5 offset:1536
  v_mfma_f32_16x16x32_bf16 v[216:219], v[48:51], v[32:35], v[216:219]
  v_mfma_f32_16x16x32_bf16 v[240:243], v[48:51], v[36:39], v[240:243]
  v_mfma_f32_16x16x32_bf16 v[172:175], v[52:55], v[24:27], v[172:175]
  ds_read_b64_tr_b16 v[48:49], v4 offset:512
  v_mfma_f32_16x16x32_bf16 v[196:199], v[52:55], v[28:31], v[196:199]
  ds_read_b64_tr_b16 v[50:51], v4 offset:2048
  v_mfma_f32_16x16x32_bf16 v[220:223], v[52:55], v[32:35], v[220:223]
  v_mfma_f32_16x16x32_bf16 v[244:247], v[52:55], v[36:39], v[244:247]
  v_mfma_f32_16x16x32_bf16 v[176:179], v[24:27], v[56:59], v[176:179]
  ds_read_b64_tr_b16 v[52:53], v5 offset:512
  v_mfma_f32_16x16x32_bf16 v[200:203], v[28:31], v[56:59], v[200:203]
  ds_read_b64_tr_b16 v[54:55], v5 offset:2048
  v_mfma_f32_16x16x32_bf16 v[224:227], v[32:35], v[56:59], v[224:227]
  v_mfma_f32_16x16x32_bf16 v[248:251], v[36:39], v[56:59], v[248:251]
  v_mfma_f32_16x16x32_bf16 v[180:183], v[24:27], v[60:63], v[180:183]
  ds_read_b64_tr_b16 v[56:57], v4 offset:1024
  v_mfma_f32_16x16x32_bf16 v[204:207], v[28:31], v[60:63], v[204:207]
  ds_read_b64_tr_b16 v[58:59], v4 offset:2560
  v_mfma_f32_16x16x32_bf16 v[228:231], v[32:35], v[60:63], v[228:231]
  v_mfma_f32_16x16x32_bf16 v[252:255], v[36:39], v[60:63], v[252:255]
L_qkv_kernel_st22:
  s_waitcnt lgkmcnt(8)
  v_mfma_f32_16x16x32_bf16 v[64:67], v[40:43], v[8:11], v[64:67]
  ds_read_b64_tr_b16 v[60:61], v5 offset:1024
  v_mfma_f32_16x16x32_bf16 v[88:91], v[40:43], v[12:15], v[88:91]
  ds_read_b64_tr_b16 v[62:63], v5 offset:2560
  v_mfma_f32_16x16x32_bf16 v[112:115], v[40:43], v[16:19], v[112:115]
  ds_read_b128 v[24:27], v2 offset:8192
  v_mfma_f32_16x16x32_bf16 v[136:139], v[40:43], v[20:23], v[136:139]
  ds_read_b128 v[28:31], v2 offset:10240
  s_waitcnt lgkmcnt(10)
  v_mfma_f32_16x16x32_bf16 v[68:71], v[44:47], v[8:11], v[68:71]
  ds_read_b128 v[32:35], v2 offset:12288
  v_mfma_f32_16x16x32_bf16 v[92:95], v[44:47], v[12:15], v[92:95]
  ds_read_b128 v[36:39], v2 offset:14336
  v_mfma_f32_16x16x32_bf16 v[116:119], v[44:47], v[16:19], v[116:119]
  v_mfma_f32_16x16x32_bf16 v[140:143], v[44:47], v[20:23], v[140:143]
  s_waitcnt lgkmcnt(10)
  v_mfma_f32_16x16x32_bf16 v[72:75], v[48:51], v[8:11], v[72:75]
  v_mfma_f32_16x16x32_bf16 v[96:99], v[48:51], v[12:15], v[96:99]
  v_mfma_f32_16x16x32_bf16 v[120:123], v[48:51], v[16:19], v[120:123]
  v_mfma_f32_16x16x32_bf16 v[144:147], v[48:51], v[20:23], v[144:147]
  s_waitcnt lgkmcnt(8)
  v_mfma_f32_16x16x32_bf16 v[76:79], v[52:55], v[8:11], v[76:79]
  v_mfma_f32_16x16x32_bf16 v[100:103], v[52:55], v[12:15], v[100:103]
  v_mfma_f32_16x16x32_bf16 v[124:127], v[52:55], v[16:19], v[124:127]
  v_mfma_f32_16x16x32_bf16 v[148:151], v[52:55], v[20:23], v[148:151]
  s_waitcnt lgkmcnt(6)
  v_mfma_f32_16x16x32_bf16 v[80:83], v[8:11], v[56:59], v[80:83]
  v_mfma_f32_16x16x32_bf16 v[104:107], v[12:15], v[56:59], v[104:107]
  v_mfma_f32_16x16x32_bf16 v[128:131], v[16:19], v[56:59], v[128:131]
  v_mfma_f32_16x16x32_bf16 v[152:155], v[20:23], v[56:59], v[152:155]
  s_waitcnt lgkmcnt(4)
  v_mfma_f32_16x16x32_bf16 v[84:87], v[8:11], v[60:63], v[84:87]
  v_mfma_f32_16x16x32_bf16 v[108:111], v[12:15], v[60:63], v[108:111]
  v_mfma_f32_16x16x32_bf16 v[132:135], v[16:19], v[60:63], v[132:135]
  v_mfma_f32_16x16x32_bf16 v[156:159], v[20:23], v[60:63], v[156:159]
  s_waitcnt lgkmcnt(0)
  s_barrier
  v_mfma_f32_16x16x32_bf16 v[160:163], v[40:43], v[24:27], v[160:163]
  v_add_u32 v3, 0x8000, v3
  ds_read_b128 v[8:11], v3 offset:0
  v_mfma_f32_16x16x32_bf16 v[184:187], v[40:43], v[28:31], v[184:187]
  ds_read_b128 v[12:15], v3 offset:2048
  v_mfma_f32_16x16x32_bf16 v[208:211], v[40:43], v[32:35], v[208:211]
  ds_read_b128 v[16:19], v3 offset:4096
  v_mfma_f32_16x16x32_bf16 v[232:235], v[40:43], v[36:39], v[232:235]
  ds_read_b128 v[20:23], v3 offset:6144
  v_mfma_f32_16x16x32_bf16 v[164:167], v[44:47], v[24:27], v[164:167]
  v_add_u32 v4, 0x3000, v4
  ds_read_b64_tr_b16 v[40:41], v4 offset:0
  v_mfma_f32_16x16x32_bf16 v[188:191], v[44:47], v[28:31], v[188:191]
  ds_read_b64_tr_b16 v[42:43], v4 offset:1536
  v_mfma_f32_16x16x32_bf16 v[212:215], v[44:47], v[32:35], v[212:215]
  v_mfma_f32_16x16x32_bf16 v[236:239], v[44:47], v[36:39], v[236:239]
  v_mfma_f32_16x16x32_bf16 v[168:171], v[48:51], v[24:27], v[168:171]
  v_add_u32 v5, 0x3000, v5
  ds_read_b64_tr_b16 v[44:45], v5 offset:0
  v_mfma_f32_16x16x32_bf16 v[192:195], v[48:51], v[28:31], v[192:195]
  ds_read_b64_tr_b16 v[46:47], v5 offset:1536
  v_mfma_f32_16x16x32_bf16 v[216:219], v[48:51], v[32:35], v[216:219]
  v_mfma_f32_16x16x32_bf16 v[240:243], v[48:51], v[36:39], v[240:243]
  v_mfma_f32_16x16x32_bf16 v[172:175], v[52:55], v[24:27], v[172:175]
  ds_read_b64_tr_b16 v[48:49], v4 offset:512
  v_mfma_f32_16x16x32_bf16 v[196:199], v[52:55], v[28:31], v[196:199]
  ds_read_b64_tr_b16 v[50:51], v4 offset:2048
  v_mfma_f32_16x16x32_bf16 v[220:223], v[52:55], v[32:35], v[220:223]
  v_mfma_f32_16x16x32_bf16 v[244:247], v[52:55], v[36:39], v[244:247]
  v_mfma_f32_16x16x32_bf16 v[176:179], v[24:27], v[56:59], v[176:179]
  ds_read_b64_tr_b16 v[52:53], v5 offset:512
  v_mfma_f32_16x16x32_bf16 v[200:203], v[28:31], v[56:59], v[200:203]
  ds_read_b64_tr_b16 v[54:55], v5 offset:2048
  v_mfma_f32_16x16x32_bf16 v[224:227], v[32:35], v[56:59], v[224:227]
  v_mfma_f32_16x16x32_bf16 v[248:251], v[36:39], v[56:59], v[248:251]
  v_mfma_f32_16x16x32_bf16 v[180:183], v[24:27], v[60:63], v[180:183]
  ds_read_b64_tr_b16 v[56:57], v4 offset:1024
  v_mfma_f32_16x16x32_bf16 v[204:207], v[28:31], v[60:63], v[204:207]
  ds_read_b64_tr_b16 v[58:59], v4 offset:2560
  v_mfma_f32_16x16x32_bf16 v[228:231], v[32:35], v[60:63], v[228:231]
  v_mfma_f32_16x16x32_bf16 v[252:255], v[36:39], v[60:63], v[252:255]
L_qkv_kernel_st23:
  s_waitcnt lgkmcnt(8)
  v_mfma_f32_16x16x32_bf16 v[64:67], v[40:43], v[8:11], v[64:67]
  ds_read_b64_tr_b16 v[60:61], v5 offset:1024
  v_mfma_f32_16x16x32_bf16 v[88:91], v[40:43], v[12:15], v[88:91]
  ds_read_b64_tr_b16 v[62:63], v5 offset:2560
  v_mfma_f32_16x16x32_bf16 v[112:115], v[40:43], v[16:19], v[112:115]
  ds_read_b128 v[24:27], v3 offset:8192
  v_mfma_f32_16x16x32_bf16 v[136:139], v[40:43], v[20:23], v[136:139]
  ds_read_b128 v[28:31], v3 offset:10240
  s_waitcnt lgkmcnt(10)
  v_mfma_f32_16x16x32_bf16 v[68:71], v[44:47], v[8:11], v[68:71]
  ds_read_b128 v[32:35], v3 offset:12288
  v_mfma_f32_16x16x32_bf16 v[92:95], v[44:47], v[12:15], v[92:95]
  ds_read_b128 v[36:39], v3 offset:14336
  v_mfma_f32_16x16x32_bf16 v[116:119], v[44:47], v[16:19], v[116:119]
  v_mfma_f32_16x16x32_bf16 v[140:143], v[44:47], v[20:23], v[140:143]
  s_waitcnt lgkmcnt(10)
  v_mfma_f32_16x16x32_bf16 v[72:75], v[48:51], v[8:11], v[72:75]
  v_mfma_f32_16x16x32_bf16 v[96:99], v[48:51], v[12:15], v[96:99]
  v_mfma_f32_16x16x32_bf16 v[120:123], v[48:51], v[16:19], v[120:123]
  v_mfma_f32_16x16x32_bf16 v[144:147], v[48:51], v[20:23], v[144:147]
  s_waitcnt lgkmcnt(8)
  v_mfma_f32_16x16x32_bf16 v[76:79], v[52:55], v[8:11], v[76:79]
  v_mfma_f32_16x16x32_bf16 v[100:103], v[52:55], v[12:15], v[100:103]
  v_mfma_f32_16x16x32_bf16 v[124:127], v[52:55], v[16:19], v[124:127]
  v_mfma_f32_16x16x32_bf16 v[148:151], v[52:55], v[20:23], v[148:151]
  s_waitcnt lgkmcnt(6)
  v_mfma_f32_16x16x32_bf16 v[80:83], v[8:11], v[56:59], v[80:83]
  v_mfma_f32_16x16x32_bf16 v[104:107], v[12:15], v[56:59], v[104:107]
  v_mfma_f32_16x16x32_bf16 v[128:131], v[16:19], v[56:59], v[128:131]
  v_mfma_f32_16x16x32_bf16 v[152:155], v[20:23], v[56:59], v[152:155]
  s_waitcnt lgkmcnt(4)
  v_mfma_f32_16x16x32_bf16 v[84:87], v[8:11], v[60:63], v[84:87]
  v_mfma_f32_16x16x32_bf16 v[108:111], v[12:15], v[60:63], v[108:111]
  v_mfma_f32_16x16x32_bf16 v[132:135], v[16:19], v[60:63], v[132:135]
  v_mfma_f32_16x16x32_bf16 v[156:159], v[20:23], v[60:63], v[156:159]
  s_waitcnt lgkmcnt(0)
  s_barrier
  v_mfma_f32_16x16x32_bf16 v[160:163], v[40:43], v[24:27], v[160:163]
  v_add_u32 v2, 0xffff0000, v2
  ds_read_b128 v[8:11], v2 offset:0
  v_mfma_f32_16x16x32_bf16 v[184:187], v[40:43], v[28:31], v[184:187]
  ds_read_b128 v[12:15], v2 offset:2048
  v_mfma_f32_16x16x32_bf16 v[208:211], v[40:43], v[32:35], v[208:211]
  ds_read_b128 v[16:19], v2 offset:4096
  v_mfma_f32_16x16x32_bf16 v[232:235], v[40:43], v[36:39], v[232:235]
  ds_read_b128 v[20:23], v2 offset:6144
  v_mfma_f32_16x16x32_bf16 v[164:167], v[44:47], v[24:27], v[164:167]
  v_add_u32 v4, 0x3000, v4
  ds_read_b64_tr_b16 v[40:41], v4 offset:0
  v_mfma_f32_16x16x32_bf16 v[188:191], v[44:47], v[28:31], v[188:191]
  ds_read_b64_tr_b16 v[42:43], v4 offset:1536
  v_mfma_f32_16x16x32_bf16 v[212:215], v[44:47], v[32:35], v[212:215]
  v_mfma_f32_16x16x32_bf16 v[236:239], v[44:47], v[36:39], v[236:239]
  v_mfma_f32_16x16x32_bf16 v[168:171], v[48:51], v[24:27], v[168:171]
  v_add_u32 v5, 0x3000, v5
  ds_read_b64_tr_b16 v[44:45], v5 offset:0
  v_mfma_f32_16x16x32_bf16 v[192:195], v[48:51], v[28:31], v[192:195]
  ds_read_b64_tr_b16 v[46:47], v5 offset:1536
  v_mfma_f32_16x16x32_bf16 v[216:219], v[48:51], v[32:35], v[216:219]
  v_mfma_f32_16x16x32_bf16 v[240:243], v[48:51], v[36:39], v[240:243]
  v_mfma_f32_16x16x32_bf16 v[172:175], v[52:55], v[24:27], v[172:175]
  ds_read_b64_tr_b16 v[48:49], v4 offset:512
  v_mfma_f32_16x16x32_bf16 v[196:199], v[52:55], v[28:31], v[196:199]
  ds_read_b64_tr_b16 v[50:51], v4 offset:2048
  v_mfma_f32_16x16x32_bf16 v[220:223], v[52:55], v[32:35], v[220:223]
  v_mfma_f32_16x16x32_bf16 v[244:247], v[52:55], v[36:39], v[244:247]
  v_mfma_f32_16x16x32_bf16 v[176:179], v[24:27], v[56:59], v[176:179]
  ds_read_b64_tr_b16 v[52:53], v5 offset:512
  v_mfma_f32_16x16x32_bf16 v[200:203], v[28:31], v[56:59], v[200:203]
  ds_read_b64_tr_b16 v[54:55], v5 offset:2048
  v_mfma_f32_16x16x32_bf16 v[224:227], v[32:35], v[56:59], v[224:227]
  v_mfma_f32_16x16x32_bf16 v[248:251], v[36:39], v[56:59], v[248:251]
  v_mfma_f32_16x16x32_bf16 v[180:183], v[24:27], v[60:63], v[180:183]
  ds_read_b64_tr_b16 v[56:57], v4 offset:1024
  v_mfma_f32_16x16x32_bf16 v[204:207], v[28:31], v[60:63], v[204:207]
  ds_read_b64_tr_b16 v[58:59], v4 offset:2560
  v_mfma_f32_16x16x32_bf16 v[228:231], v[32:35], v[60:63], v[228:231]
  v_mfma_f32_16x16x32_bf16 v[252:255], v[36:39], v[60:63], v[252:255]
L_qkv_kernel_st24:
  s_waitcnt lgkmcnt(8)
  v_mfma_f32_16x16x32_bf16 v[64:67], v[40:43], v[8:11], v[64:67]
  ds_read_b64_tr_b16 v[60:61], v5 offset:1024
  v_mfma_f32_16x16x32_bf16 v[88:91], v[40:43], v[12:15], v[88:91]
  ds_read_b64_tr_b16 v[62:63], v5 offset:2560
  v_mfma_f32_16x16x32_bf16 v[112:115], v[40:43], v[16:19], v[112:115]
  ds_read_b128 v[24:27], v2 offset:8192
  v_mfma_f32_16x16x32_bf16 v[136:139], v[40:43], v[20:23], v[136:139]
  ds_read_b128 v[28:31], v2 offset:10240
  s_waitcnt lgkmcnt(10)
  v_mfma_f32_16x16x32_bf16 v[68:71], v[44:47], v[8:11], v[68:71]
  ds_read_b128 v[32:35], v2 offset:12288
  v_mfma_f32_16x16x32_bf16 v[92:95], v[44:47], v[12:15], v[92:95]
  ds_read_b128 v[36:39], v2 offset:14336
  v_mfma_f32_16x16x32_bf16 v[116:119], v[44:47], v[16:19], v[116:119]
  v_mfma_f32_16x16x32_bf16 v[140:143], v[44:47], v[20:23], v[140:143]
  s_waitcnt lgkmcnt(10)
  v_mfma_f32_16x16x32_bf16 v[72:75], v[48:51], v[8:11], v[72:75]
  v_mfma_f32_16x16x32_bf16 v[96:99], v[48:51], v[12:15], v[96:99]
  v_mfma_f32_16x16x32_bf16 v[120:123], v[48:51], v[16:19], v[120:123]
  v_mfma_f32_16x16x32_bf16 v[144:147], v[48:51], v[20:23], v[144:147]
  s_waitcnt lgkmcnt(8)
  v_mfma_f32_16x16x32_bf16 v[76:79], v[52:55], v[8:11], v[76:79]
  v_mfma_f32_16x16x32_bf16 v[100:103], v[52:55], v[12:15], v[100:103]
  v_mfma_f32_16x16x32_bf16 v[124:127], v[52:55], v[16:19], v[124:127]
  v_mfma_f32_16x16x32_bf16 v[148:151], v[52:55], v[20:23], v[148:151]
  s_waitcnt lgkmcnt(6)
  v_mfma_f32_16x16x32_bf16 v[80:83], v[8:11], v[56:59], v[80:83]
  v_mfma_f32_16x16x32_bf16 v[104:107], v[12:15], v[56:59], v[104:107]
  v_mfma_f32_16x16x32_bf16 v[128:131], v[16:19], v[56:59], v[128:131]
  v_mfma_f32_16x16x32_bf16 v[152:155], v[20:23], v[56:59], v[152:155]
  s_waitcnt lgkmcnt(4)
  v_mfma_f32_16x16x32_bf16 v[84:87], v[8:11], v[60:63], v[84:87]
  v_mfma_f32_16x16x32_bf16 v[108:111], v[12:15], v[60:63], v[108:111]
  v_mfma_f32_16x16x32_bf16 v[132:135], v[16:19], v[60:63], v[132:135]
  v_mfma_f32_16x16x32_bf16 v[156:159], v[20:23], v[60:63], v[156:159]
  s_waitcnt lgkmcnt(0)
  s_barrier
  v_mfma_f32_16x16x32_bf16 v[160:163], v[40:43], v[24:27], v[160:163]
  v_add_u32 v3, 0xffff0000, v3
  ds_read_b128 v[8:11], v3 offset:0
  v_mfma_f32_16x16x32_bf16 v[184:187], v[40:43], v[28:31], v[184:187]
  ds_read_b128 v[12:15], v3 offset:2048
  v_mfma_f32_16x16x32_bf16 v[208:211], v[40:43], v[32:35], v[208:211]
  ds_read_b128 v[16:19], v3 offset:4096
  v_mfma_f32_16x16x32_bf16 v[232:235], v[40:43], v[36:39], v[232:235]
  ds_read_b128 v[20:23], v3 offset:6144
  v_mfma_f32_16x16x32_bf16 v[164:167], v[44:47], v[24:27], v[164:167]
  v_add_u32 v4, 0xffff4000, v4
  ds_read_b64_tr_b16 v[40:41], v4 offset:0
  v_mfma_f32_16x16x32_bf16 v[188:191], v[44:47], v[28:31], v[188:191]
  ds_read_b64_tr_b16 v[42:43], v4 offset:1536
  v_mfma_f32_16x16x32_bf16 v[212:215], v[44:47], v[32:35], v[212:215]
  v_mfma_f32_16x16x32_bf16 v[236:239], v[44:47], v[36:39], v[236:239]
  v_mfma_f32_16x16x32_bf16 v[168:171], v[48:51], v[24:27], v[168:171]
  v_add_u32 v5, 0xffff4000, v5
  ds_read_b64_tr_b16 v[44:45], v5 offset:0
  v_mfma_f32_16x16x32_bf16 v[192:195], v[48:51], v[28:31], v[192:195]
  ds_read_b64_tr_b16 v[46:47], v5 offset:1536
  v_mfma_f32_16x16x32_bf16 v[216:219], v[48:51], v[32:35], v[216:219]
  v_mfma_f32_16x16x32_bf16 v[240:243], v[48:51], v[36:39], v[240:243]
  v_mfma_f32_16x16x32_bf16 v[172:175], v[52:55], v[24:27], v[172:175]
  ds_read_b64_tr_b16 v[48:49], v4 offset:512
  v_mfma_f32_16x16x32_bf16 v[196:199], v[52:55], v[28:31], v[196:199]
  ds_read_b64_tr_b16 v[50:51], v4 offset:2048
  v_mfma_f32_16x16x32_bf16 v[220:223], v[52:55], v[32:35], v[220:223]
  v_mfma_f32_16x16x32_bf16 v[244:247], v[52:55], v[36:39], v[244:247]
  v_mfma_f32_16x16x32_bf16 v[176:179], v[24:27], v[56:59], v[176:179]
  ds_read_b64_tr_b16 v[52:53], v5 offset:512
  v_mfma_f32_16x16x32_bf16 v[200:203], v[28:31], v[56:59], v[200:203]
  ds_read_b64_tr_b16 v[54:55], v5 offset:2048
  v_mfma_f32_16x16x32_bf16 v[224:227], v[32:35], v[56:59], v[224:227]
  v_mfma_f32_16x16x32_bf16 v[248:251], v[36:39], v[56:59], v[248:251]
  v_mfma_f32_16x16x32_bf16 v[180:183], v[24:27], v[60:63], v[180:183]
  ds_read_b64_tr_b16 v[56:57], v4 offset:1024
  v_mfma_f32_16x16x32_bf16 v[204:207], v[28:31], v[60:63], v[204:207]
  ds_read_b64_tr_b16 v[58:59], v4 offset:2560
  v_mfma_f32_16x16x32_bf16 v[228:231], v[32:35], v[60:63], v[228:231]
  v_mfma_f32_16x16x32_bf16 v[252:255], v[36:39], v[60:63], v[252:255]
L_qkv_kernel_st25:
  s_waitcnt lgkmcnt(8)
  v_mfma_f32_16x16x32_bf16 v[64:67], v[40:43], v[8:11], v[64:67]
  ds_read_b64_tr_b16 v[60:61], v5 offset:1024
  v_mfma_f32_16x16x32_bf16 v[88:91], v[40:43], v[12:15], v[88:91]
  ds_read_b64_tr_b16 v[62:63], v5 offset:2560
  v_mfma_f32_16x16x32_bf16 v[112:115], v[40:43], v[16:19], v[112:115]
  ds_read_b128 v[24:27], v3 offset:8192
  v_mfma_f32_16x16x32_bf16 v[136:139], v[40:43], v[20:23], v[136:139]
  ds_read_b128 v[28:31], v3 offset:10240
  s_waitcnt lgkmcnt(10)
  v_mfma_f32_16x16x32_bf16 v[68:71], v[44:47], v[8:11], v[68:71]
  ds_read_b128 v[32:35], v3 offset:12288
  v_mfma_f32_16x16x32_bf16 v[92:95], v[44:47], v[12:15], v[92:95]
  ds_read_b128 v[36:39], v3 offset:14336
  v_mfma_f32_16x16x32_bf16 v[116:119], v[44:47], v[16:19], v[116:119]
  v_mfma_f32_16x16x32_bf16 v[140:143], v[44:47], v[20:23], v[140:143]
  s_waitcnt lgkmcnt(10)
  v_mfma_f32_16x16x32_bf16 v[72:75], v[48:51], v[8:11], v[72:75]
  v_mfma_f32_16x16x32_bf16 v[96:99], v[48:51], v[12:15], v[96:99]
  v_mfma_f32_16x16x32_bf16 v[120:123], v[48:51], v[16:19], v[120:123]
  v_mfma_f32_16x16x32_bf16 v[144:147], v[48:51], v[20:23], v[144:147]
  s_waitcnt lgkmcnt(8)
  v_mfma_f32_16x16x32_bf16 v[76:79], v[52:55], v[8:11], v[76:79]
  v_mfma_f32_16x16x32_bf16 v[100:103], v[52:55], v[12:15], v[100:103]
  v_mfma_f32_16x16x32_bf16 v[124:127], v[52:55], v[16:19], v[124:127]
  v_mfma_f32_16x16x32_bf16 v[148:151], v[52:55], v[20:23], v[148:151]
  s_waitcnt lgkmcnt(6)
  v_mfma_f32_16x16x32_bf16 v[80:83], v[8:11], v[56:59], v[80:83]
  v_mfma_f32_16x16x32_bf16 v[104:107], v[12:15], v[56:59], v[104:107]
  v_mfma_f32_16x16x32_bf16 v[128:131], v[16:19], v[56:59], v[128:131]
  v_mfma_f32_16x16x32_bf16 v[152:155], v[20:23], v[56:59], v[152:155]
  s_waitcnt lgkmcnt(4)
  v_mfma_f32_16x16x32_bf16 v[84:87], v[8:11], v[60:63], v[84:87]
  v_mfma_f32_16x16x32_bf16 v[108:111], v[12:15], v[60:63], v[108:111]
  v_mfma_f32_16x16x32_bf16 v[132:135], v[16:19], v[60:63], v[132:135]
  v_mfma_f32_16x16x32_bf16 v[156:159], v[20:23], v[60:63], v[156:159]
  s_waitcnt lgkmcnt(0)
  s_barrier
  v_mfma_f32_16x16x32_bf16 v[160:163], v[40:43], v[24:27], v[160:163]
  v_add_u32 v2, 0x8000, v2
  ds_read_b128 v[8:11], v2 offset:0
  v_mfma_f32_16x16x32_bf16 v[184:187], v[40:43], v[28:31], v[184:187]
  ds_read_b128 v[12:15], v2 offset:2048
  v_mfma_f32_16x16x32_bf16 v[208:211], v[40:43], v[32:35], v[208:211]
  ds_read_b128 v[16:19], v2 offset:4096
  v_mfma_f32_16x16x32_bf16 v[232:235], v[40:43], v[36:39], v[232:235]
  ds_read_b128 v[20:23], v2 offset:6144
  v_mfma_f32_16x16x32_bf16 v[164:167], v[44:47], v[24:27], v[164:167]
  v_add_u32 v4, 0x3000, v4
  ds_read_b64_tr_b16 v[40:41], v4 offset:0
  v_mfma_f32_16x16x32_bf16 v[188:191], v[44:47], v[28:31], v[188:191]
  ds_read_b64_tr_b16 v[42:43], v4 offset:1536
  v_mfma_f32_16x16x32_bf16 v[212:215], v[44:47], v[32:35], v[212:215]
  v_mfma_f32_16x16x32_bf16 v[236:239], v[44:47], v[36:39], v[236:239]
  v_mfma_f32_16x16x32_bf16 v[168:171], v[48:51], v[24:27], v[168:171]
  v_add_u32 v5, 0x3000, v5
  ds_read_b64_tr_b16 v[44:45], v5 offset:0
  v_mfma_f32_16x16x32_bf16 v[192:195], v[48:51], v[28:31], v[192:195]
  ds_read_b64_tr_b16 v[46:47], v5 offset:1536
  v_mfma_f32_16x16x32_bf16 v[216:219], v[48:51], v[32:35], v[216:219]
  v_mfma_f32_16x16x32_bf16 v[240:243], v[48:51], v[36:39], v[240:243]
  v_mfma_f32_16x16x32_bf16 v[172:175], v[52:55], v[24:27], v[172:175]
  ds_read_b64_tr_b16 v[48:49], v4 offset:512
  v_mfma_f32_16x16x32_bf16 v[196:199], v[52:55], v[28:31], v[196:199]
  ds_read_b64_tr_b16 v[50:51], v4 offset:2048
  v_mfma_f32_16x16x32_bf16 v[220:223], v[52:55], v[32:35], v[220:223]
  v_mfma_f32_16x16x32_bf16 v[244:247], v[52:55], v[36:39], v[244:247]
  v_mfma_f32_16x16x32_bf16 v[176:179], v[24:27], v[56:59], v[176:179]
  ds_read_b64_tr_b16 v[52:53], v5 offset:512
  v_mfma_f32_16x16x32_bf16 v[200:203], v[28:31], v[56:59], v[200:203]
  ds_read_b64_tr_b16 v[54:55], v5 offset:2048
  v_mfma_f32_16x16x32_bf16 v[224:227], v[32:35], v[56:59], v[224:227]
  v_mfma_f32_16x16x32_bf16 v[248:251], v[36:39], v[56:59], v[248:251]
  v_mfma_f32_16x16x32_bf16 v[180:183], v[24:27], v[60:63], v[180:183]
  ds_read_b64_tr_b16 v[56:57], v4 offset:1024
  v_mfma_f32_16x16x32_bf16 v[204:207], v[28:31], v[60:63], v[204:207]
  ds_read_b64_tr_b16 v[58:59], v4 offset:2560
  v_mfma_f32_16x16x32_bf16 v[228:231], v[32:35], v[60:63], v[228:231]
  v_mfma_f32_16x16x32_bf16 v[252:255], v[36:39], v[60:63], v[252:255]
L_qkv_kernel_st26:
  s_waitcnt lgkmcnt(8)
  v_mfma_f32_16x16x32_bf16 v[64:67], v[40:43], v[8:11], v[64:67]
  ds_read_b64_tr_b16 v[60:61], v5 offset:1024
  v_mfma_f32_16x16x32_bf16 v[88:91], v[40:43], v[12:15], v[88:91]
  ds_read_b64_tr_b16 v[62:63], v5 offset:2560
  v_mfma_f32_16x16x32_bf16 v[112:115], v[40:43], v[16:19], v[112:115]
  ds_read_b128 v[24:27], v2 offset:8192
  v_mfma_f32_16x16x32_bf16 v[136:139], v[40:43], v[20:23], v[136:139]
  ds_read_b128 v[28:31], v2 offset:10240
  s_waitcnt lgkmcnt(10)
  v_mfma_f32_16x16x32_bf16 v[68:71], v[44:47], v[8:11], v[68:71]
  ds_read_b128 v[32:35], v2 offset:12288
  v_mfma_f32_16x16x32_bf16 v[92:95], v[44:47], v[12:15], v[92:95]
  ds_read_b128 v[36:39], v2 offset:14336
  v_mfma_f32_16x16x32_bf16 v[116:119], v[44:47], v[16:19], v[116:119]
  v_mfma_f32_16x16x32_bf16 v[140:143], v[44:47], v[20:23], v[140:143]
  s_waitcnt lgkmcnt(10)
  v_mfma_f32_16x16x32_bf16 v[72:75], v[48:51], v[8:11], v[72:75]
  v_mfma_f32_16x16x32_bf16 v[96:99], v[48:51], v[12:15], v[96:99]
  v_mfma_f32_16x16x32_bf16 v[120:123], v[48:51], v[16:19], v[120:123]
  v_mfma_f32_16x16x32_bf16 v[144:147], v[48:51], v[20:23], v[144:147]
  s_waitcnt lgkmcnt(8)
  v_mfma_f32_16x16x32_bf16 v[76:79], v[52:55], v[8:11], v[76:79]
  v_mfma_f32_16x16x32_bf16 v[100:103], v[52:55], v[12:15], v[100:103]
  v_mfma_f32_16x16x32_bf16 v[124:127], v[52:55], v[16:19], v[124:127]
  v_mfma_f32_16x16x32_bf16 v[148:151], v[52:55], v[20:23], v[148:151]
  s_waitcnt lgkmcnt(6)
  v_mfma_f32_16x16x32_bf16 v[80:83], v[8:11], v[56:59], v[80:83]
  v_mfma_f32_16x16x32_bf16 v[104:107], v[12:15], v[56:59], v[104:107]
  v_mfma_f32_16x16x32_bf16 v[128:131], v[16:19], v[56:59], v[128:131]
  v_mfma_f32_16x16x32_bf16 v[152:155], v[20:23], v[56:59], v[152:155]
  s_waitcnt lgkmcnt(4)
  v_mfma_f32_16x16x32_bf16 v[84:87], v[8:11], v[60:63], v[84:87]
  v_mfma_f32_16x16x32_bf16 v[108:111], v[12:15], v[60:63], v[108:111]
  v_mfma_f32_16x16x32_bf16 v[132:135], v[16:19], v[60:63], v[132:135]
  v_mfma_f32_16x16x32_bf16 v[156:159], v[20:23], v[60:63], v[156:159]
  s_waitcnt lgkmcnt(0)
  s_barrier
  v_mfma_f32_16x16x32_bf16 v[160:163], v[40:43], v[24:27], v[160:163]
  v_add_u32 v3, 0x8000, v3
  ds_read_b128 v[8:11], v3 offset:0
  v_mfma_f32_16x16x32_bf16 v[184:187], v[40:43], v[28:31], v[184:187]
  ds_read_b128 v[12:15], v3 offset:2048
  v_mfma_f32_16x16x32_bf16 v[208:211], v[40:43], v[32:35], v[208:211]
  ds_read_b128 v[16:19], v3 offset:4096
  v_mfma_f32_16x16x32_bf16 v[232:235], v[40:43], v[36:39], v[232:235]
  ds_read_b128 v[20:23], v3 offset:6144
  v_mfma_f32_16x16x32_bf16 v[164:167], v[44:47], v[24:27], v[164:167]
  v_add_u32 v4, 0x3000, v4
  ds_read_b64_tr_b16 v[40:41], v4 offset:0
  v_mfma_f32_16x16x32_bf16 v[188:191], v[44:47], v[28:31], v[188:191]
  ds_read_b64_tr_b16 v[42:43], v4 offset:1536
  v_mfma_f32_16x16x32_bf16 v[212:215], v[44:47], v[32:35], v[212:215]
  v_mfma_f32_16x16x32_bf16 v[236:239], v[44:47], v[36:39], v[236:239]
  v_mfma_f32_16x16x32_bf16 v[168:171], v[48:51], v[24:27], v[168:171]
  v_add_u32 v5, 0x3000, v5
  ds_read_b64_tr_b16 v[44:45], v5 offset:0
  v_mfma_f32_16x16x32_bf16 v[192:195], v[48:51], v[28:31], v[192:195]
  ds_read_b64_tr_b16 v[46:47], v5 offset:1536
  v_mfma_f32_16x16x32_bf16 v[216:219], v[48:51], v[32:35], v[216:219]
  v_mfma_f32_16x16x32_bf16 v[240:243], v[48:51], v[36:39], v[240:243]
  v_mfma_f32_16x16x32_bf16 v[172:175], v[52:55], v[24:27], v[172:175]
  ds_read_b64_tr_b16 v[48:49], v4 offset:512
  v_mfma_f32_16x16x32_bf16 v[196:199], v[52:55], v[28:31], v[196:199]
  ds_read_b64_tr_b16 v[50:51], v4 offset:2048
  v_mfma_f32_16x16x32_bf16 v[220:223], v[52:55], v[32:35], v[220:223]
  v_mfma_f32_16x16x32_bf16 v[244:247], v[52:55], v[36:39], v[244:247]
  v_mfma_f32_16x16x32_bf16 v[176:179], v[24:27], v[56:59], v[176:179]
  ds_read_b64_tr_b16 v[52:53], v5 offset:512
  v_mfma_f32_16x16x32_bf16 v[200:203], v[28:31], v[56:59], v[200:203]
  ds_read_b64_tr_b16 v[54:55], v5 offset:2048
  v_mfma_f32_16x16x32_bf16 v[224:227], v[32:35], v[56:59], v[224:227]
  v_mfma_f32_16x16x32_bf16 v[248:251], v[36:39], v[56:59], v[248:251]
  v_mfma_f32_16x16x32_bf16 v[180:183], v[24:27], v[60:63], v[180:183]
  ds_read_b64_tr_b16 v[56:57], v4 offset:1024
  v_mfma_f32_16x16x32_bf16 v[204:207], v[28:31], v[60:63], v[204:207]
  ds_read_b64_tr_b16 v[58:59], v4 offset:2560
  v_mfma_f32_16x16x32_bf16 v[228:231], v[32:35], v[60:63], v[228:231]
  v_mfma_f32_16x16x32_bf16 v[252:255], v[36:39], v[60:63], v[252:255]
L_qkv_kernel_st27:
  s_waitcnt lgkmcnt(8)
  v_mfma_f32_16x16x32_bf16 v[64:67], v[40:43], v[8:11], v[64:67]
  ds_read_b64_tr_b16 v[60:61], v5 offset:1024
  v_mfma_f32_16x16x32_bf16 v[88:91], v[40:43], v[12:15], v[88:91]
  ds_read_b64_tr_b16 v[62:63], v5 offset:2560
  v_mfma_f32_16x16x32_bf16 v[112:115], v[40:43], v[16:19], v[112:115]
  ds_read_b128 v[24:27], v3 offset:8192
  v_mfma_f32_16x16x32_bf16 v[136:139], v[40:43], v[20:23], v[136:139]
  ds_read_b128 v[28:31], v3 offset:10240
  s_waitcnt lgkmcnt(10)
  v_mfma_f32_16x16x32_bf16 v[68:71], v[44:47], v[8:11], v[68:71]
  ds_read_b128 v[32:35], v3 offset:12288
  v_mfma_f32_16x16x32_bf16 v[92:95], v[44:47], v[12:15], v[92:95]
  ds_read_b128 v[36:39], v3 offset:14336
  v_mfma_f32_16x16x32_bf16 v[116:119], v[44:47], v[16:19], v[116:119]
  v_mfma_f32_16x16x32_bf16 v[140:143], v[44:47], v[20:23], v[140:143]
  s_waitcnt lgkmcnt(10)
  v_mfma_f32_16x16x32_bf16 v[72:75], v[48:51], v[8:11], v[72:75]
  v_mfma_f32_16x16x32_bf16 v[96:99], v[48:51], v[12:15], v[96:99]
  v_mfma_f32_16x16x32_bf16 v[120:123], v[48:51], v[16:19], v[120:123]
  v_mfma_f32_16x16x32_bf16 v[144:147], v[48:51], v[20:23], v[144:147]
  s_waitcnt lgkmcnt(8)
  v_mfma_f32_16x16x32_bf16 v[76:79], v[52:55], v[8:11], v[76:79]
  v_mfma_f32_16x16x32_bf16 v[100:103], v[52:55], v[12:15], v[100:103]
  v_mfma_f32_16x16x32_bf16 v[124:127], v[52:55], v[16:19], v[124:127]
  v_mfma_f32_16x16x32_bf16 v[148:151], v[52:55], v[20:23], v[148:151]
  s_waitcnt lgkmcnt(6)
  v_mfma_f32_16x16x32_bf16 v[80:83], v[8:11], v[56:59], v[80:83]
  v_mfma_f32_16x16x32_bf16 v[104:107], v[12:15], v[56:59], v[104:107]
  v_mfma_f32_16x16x32_bf16 v[128:131], v[16:19], v[56:59], v[128:131]
  v_mfma_f32_16x16x32_bf16 v[152:155], v[20:23], v[56:59], v[152:155]
  s_waitcnt lgkmcnt(4)
  v_mfma_f32_16x16x32_bf16 v[84:87], v[8:11], v[60:63], v[84:87]
  v_mfma_f32_16x16x32_bf16 v[108:111], v[12:15], v[60:63], v[108:111]
  v_mfma_f32_16x16x32_bf16 v[132:135], v[16:19], v[60:63], v[132:135]
  v_mfma_f32_16x16x32_bf16 v[156:159], v[20:23], v[60:63], v[156:159]
  s_waitcnt lgkmcnt(0)
  s_barrier
  v_mfma_f32_16x16x32_bf16 v[160:163], v[40:43], v[24:27], v[160:163]
  v_add_u32 v2, 0x8000, v2
  ds_read_b128 v[8:11], v2 offset:0
  v_mfma_f32_16x16x32_bf16 v[184:187], v[40:43], v[28:31], v[184:187]
  ds_read_b128 v[12:15], v2 offset:2048
  v_mfma_f32_16x16x32_bf16 v[208:211], v[40:43], v[32:35], v[208:211]
  ds_read_b128 v[16:19], v2 offset:4096
  v_mfma_f32_16x16x32_bf16 v[232:235], v[40:43], v[36:39], v[232:235]
  ds_read_b128 v[20:23], v2 offset:6144
  v_mfma_f32_16x16x32_bf16 v[164:167], v[44:47], v[24:27], v[164:167]
  v_add_u32 v4, 0x3000, v4
  ds_read_b64_tr_b16 v[40:41], v4 offset:0
  v_mfma_f32_16x16x32_bf16 v[188:191], v[44:47], v[28:31], v[188:191]
  ds_read_b64_tr_b16 v[42:43], v4 offset:1536
  v_mfma_f32_16x16x32_bf16 v[212:215], v[44:47], v[32:35], v[212:215]
  v_mfma_f32_16x16x32_bf16 v[236:239], v[44:47], v[36:39], v[236:239]
  v_mfma_f32_16x16x32_bf16 v[168:171], v[48:51], v[24:27], v[168:171]
  v_add_u32 v5, 0x3000, v5
  ds_read_b64_tr_b16 v[44:45], v5 offset:0
  v_mfma_f32_16x16x32_bf16 v[192:195], v[48:51], v[28:31], v[192:195]
  ds_read_b64_tr_b16 v[46:47], v5 offset:1536
  v_mfma_f32_16x16x32_bf16 v[216:219], v[48:51], v[32:35], v[216:219]
  v_mfma_f32_16x16x32_bf16 v[240:243], v[48:51], v[36:39], v[240:243]
  v_mfma_f32_16x16x32_bf16 v[172:175], v[52:55], v[24:27], v[172:175]
  ds_read_b64_tr_b16 v[48:49], v4 offset:512
  v_mfma_f32_16x16x32_bf16 v[196:199], v[52:55], v[28:31], v[196:199]
  ds_read_b64_tr_b16 v[50:51], v4 offset:2048
  v_mfma_f32_16x16x32_bf16 v[220:223], v[52:55], v[32:35], v[220:223]
  v_mfma_f32_16x16x32_bf16 v[244:247], v[52:55], v[36:39], v[244:247]
  v_mfma_f32_16x16x32_bf16 v[176:179], v[24:27], v[56:59], v[176:179]
  ds_read_b64_tr_b16 v[52:53], v5 offset:512
  v_mfma_f32_16x16x32_bf16 v[200:203], v[28:31], v[56:59], v[200:203]
  ds_read_b64_tr_b16 v[54:55], v5 offset:2048
  v_mfma_f32_16x16x32_bf16 v[224:227], v[32:35], v[56:59], v[224:227]
  v_mfma_f32_16x16x32_bf16 v[248:251], v[36:39], v[56:59], v[248:251]
  v_mfma_f32_16x16x32_bf16 v[180:183], v[24:27], v[60:63], v[180:183]
  ds_read_b64_tr_b16 v[56:57], v4 offset:1024
  v_mfma_f32_16x16x32_bf16 v[204:207], v[28:31], v[60:63], v[204:207]
  ds_read_b64_tr_b16 v[58:59], v4 offset:2560
  v_mfma_f32_16x16x32_bf16 v[228:231], v[32:35], v[60:63], v[228:231]
  v_mfma_f32_16x16x32_bf16 v[252:255], v[36:39], v[60:63], v[252:255]
L_qkv_kernel_st28:
  s_waitcnt lgkmcnt(8)
  v_mfma_f32_16x16x32_bf16 v[64:67], v[40:43], v[8:11], v[64:67]
  ds_read_b64_tr_b16 v[60:61], v5 offset:1024
  v_mfma_f32_16x16x32_bf16 v[88:91], v[40:43], v[12:15], v[88:91]
  ds_read_b64_tr_b16 v[62:63], v5 offset:2560
  v_mfma_f32_16x16x32_bf16 v[112:115], v[40:43], v[16:19], v[112:115]
  ds_read_b128 v[24:27], v2 offset:8192
  v_mfma_f32_16x16x32_bf16 v[136:139], v[40:43], v[20:23], v[136:139]
  ds_read_b128 v[28:31], v2 offset:10240
  s_waitcnt lgkmcnt(10)
  v_mfma_f32_16x16x32_bf16 v[68:71], v[44:47], v[8:11], v[68:71]
  ds_read_b128 v[32:35], v2 offset:12288
  v_mfma_f32_16x16x32_bf16 v[92:95], v[44:47], v[12:15], v[92:95]
  ds_read_b128 v[36:39], v2 offset:14336
  v_mfma_f32_16x16x32_bf16 v[116:119], v[44:47], v[16:19], v[116:119]
  v_mfma_f32_16x16x32_bf16 v[140:143], v[44:47], v[20:23], v[140:143]
  s_waitcnt lgkmcnt(10)
  v_mfma_f32_16x16x32_bf16 v[72:75], v[48:51], v[8:11], v[72:75]
  v_mfma_f32_16x16x32_bf16 v[96:99], v[48:51], v[12:15], v[96:99]
  v_mfma_f32_16x16x32_bf16 v[120:123], v[48:51], v[16:19], v[120:123]
  v_mfma_f32_16x16x32_bf16 v[144:147], v[48:51], v[20:23], v[144:147]
  s_waitcnt lgkmcnt(8)
  v_mfma_f32_16x16x32_bf16 v[76:79], v[52:55], v[8:11], v[76:79]
  v_mfma_f32_16x16x32_bf16 v[100:103], v[52:55], v[12:15], v[100:103]
  v_mfma_f32_16x16x32_bf16 v[124:127], v[52:55], v[16:19], v[124:127]
  v_mfma_f32_16x16x32_bf16 v[148:151], v[52:55], v[20:23], v[148:151]
  s_waitcnt lgkmcnt(6)
  v_mfma_f32_16x16x32_bf16 v[80:83], v[8:11], v[56:59], v[80:83]
  v_mfma_f32_16x16x32_bf16 v[104:107], v[12:15], v[56:59], v[104:107]
  v_mfma_f32_16x16x32_bf16 v[128:131], v[16:19], v[56:59], v[128:131]
  v_mfma_f32_16x16x32_bf16 v[152:155], v[20:23], v[56:59], v[152:155]
  s_waitcnt lgkmcnt(4)
  v_mfma_f32_16x16x32_bf16 v[84:87], v[8:11], v[60:63], v[84:87]
  v_mfma_f32_16x16x32_bf16 v[108:111], v[12:15], v[60:63], v[108:111]
  v_mfma_f32_16x16x32_bf16 v[132:135], v[16:19], v[60:63], v[132:135]
  v_mfma_f32_16x16x32_bf16 v[156:159], v[20:23], v[60:63], v[156:159]
  s_waitcnt lgkmcnt(0)
  s_barrier
  v_mfma_f32_16x16x32_bf16 v[160:163], v[40:43], v[24:27], v[160:163]
  v_add_u32 v3, 0x8000, v3
  ds_read_b128 v[8:11], v3 offset:0
  v_mfma_f32_16x16x32_bf16 v[184:187], v[40:43], v[28:31], v[184:187]
  ds_read_b128 v[12:15], v3 offset:2048
  v_mfma_f32_16x16x32_bf16 v[208:211], v[40:43], v[32:35], v[208:211]
  ds_read_b128 v[16:19], v3 offset:4096
  v_mfma_f32_16x16x32_bf16 v[232:235], v[40:43], v[36:39], v[232:235]
  ds_read_b128 v[20:23], v3 offset:6144
  v_mfma_f32_16x16x32_bf16 v[164:167], v[44:47], v[24:27], v[164:167]
  v_add_u32 v4, 0x3000, v4
  ds_read_b64_tr_b16 v[40:41], v4 offset:0
  v_mfma_f32_16x16x32_bf16 v[188:191], v[44:47], v[28:31], v[188:191]
  ds_read_b64_tr_b16 v[42:43], v4 offset:1536
  v_mfma_f32_16x16x32_bf16 v[212:215], v[44:47], v[32:35], v[212:215]
  v_mfma_f32_16x16x32_bf16 v[236:239], v[44:47], v[36:39], v[236:239]
  v_mfma_f32_16x16x32_bf16 v[168:171], v[48:51], v[24:27], v[168:171]
  v_add_u32 v5, 0x3000, v5
  ds_read_b64_tr_b16 v[44:45], v5 offset:0
  v_mfma_f32_16x16x32_bf16 v[192:195], v[48:51], v[28:31], v[192:195]
  ds_read_b64_tr_b16 v[46:47], v5 offset:1536
  v_mfma_f32_16x16x32_bf16 v[216:219], v[48:51], v[32:35], v[216:219]
  v_mfma_f32_16x16x32_bf16 v[240:243], v[48:51], v[36:39], v[240:243]
  v_mfma_f32_16x16x32_bf16 v[172:175], v[52:55], v[24:27], v[172:175]
  ds_read_b64_tr_b16 v[48:49], v4 offset:512
  v_mfma_f32_16x16x32_bf16 v[196:199], v[52:55], v[28:31], v[196:199]
  ds_read_b64_tr_b16 v[50:51], v4 offset:2048
  v_mfma_f32_16x16x32_bf16 v[220:223], v[52:55], v[32:35], v[220:223]
  v_mfma_f32_16x16x32_bf16 v[244:247], v[52:55], v[36:39], v[244:247]
  v_mfma_f32_16x16x32_bf16 v[176:179], v[24:27], v[56:59], v[176:179]
  ds_read_b64_tr_b16 v[52:53], v5 offset:512
  v_mfma_f32_16x16x32_bf16 v[200:203], v[28:31], v[56:59], v[200:203]
  ds_read_b64_tr_b16 v[54:55], v5 offset:2048
  v_mfma_f32_16x16x32_bf16 v[224:227], v[32:35], v[56:59], v[224:227]
  v_mfma_f32_16x16x32_bf16 v[248:251], v[36:39], v[56:59], v[248:251]
  v_mfma_f32_16x16x32_bf16 v[180:183], v[24:27], v[60:63], v[180:183]
  ds_read_b64_tr_b16 v[56:57], v4 offset:1024
  v_mfma_f32_16x16x32_bf16 v[204:207], v[28:31], v[60:63], v[204:207]
  ds_read_b64_tr_b16 v[58:59], v4 offset:2560
  v_mfma_f32_16x16x32_bf16 v[228:231], v[32:35], v[60:63], v[228:231]
  v_mfma_f32_16x16x32_bf16 v[252:255], v[36:39], v[60:63], v[252:255]
L_qkv_kernel_st29:
  s_waitcnt lgkmcnt(8)
  v_mfma_f32_16x16x32_bf16 v[64:67], v[40:43], v[8:11], v[64:67]
  ds_read_b64_tr_b16 v[60:61], v5 offset:1024
  v_mfma_f32_16x16x32_bf16 v[88:91], v[40:43], v[12:15], v[88:91]
  ds_read_b64_tr_b16 v[62:63], v5 offset:2560
  v_mfma_f32_16x16x32_bf16 v[112:115], v[40:43], v[16:19], v[112:115]
  ds_read_b128 v[24:27], v3 offset:8192
  v_mfma_f32_16x16x32_bf16 v[136:139], v[40:43], v[20:23], v[136:139]
  ds_read_b128 v[28:31], v3 offset:10240
  s_waitcnt lgkmcnt(10)
  v_mfma_f32_16x16x32_bf16 v[68:71], v[44:47], v[8:11], v[68:71]
  ds_read_b128 v[32:35], v3 offset:12288
  v_mfma_f32_16x16x32_bf16 v[92:95], v[44:47], v[12:15], v[92:95]
  ds_read_b128 v[36:39], v3 offset:14336
  v_mfma_f32_16x16x32_bf16 v[116:119], v[44:47], v[16:19], v[116:119]
  v_mfma_f32_16x16x32_bf16 v[140:143], v[44:47], v[20:23], v[140:143]
  s_waitcnt lgkmcnt(10)
  v_mfma_f32_16x16x32_bf16 v[72:75], v[48:51], v[8:11], v[72:75]
  v_mfma_f32_16x16x32_bf16 v[96:99], v[48:51], v[12:15], v[96:99]
  v_mfma_f32_16x16x32_bf16 v[120:123], v[48:51], v[16:19], v[120:123]
  v_mfma_f32_16x16x32_bf16 v[144:147], v[48:51], v[20:23], v[144:147]
  s_waitcnt lgkmcnt(8)
  v_mfma_f32_16x16x32_bf16 v[76:79], v[52:55], v[8:11], v[76:79]
  v_mfma_f32_16x16x32_bf16 v[100:103], v[52:55], v[12:15], v[100:103]
  v_mfma_f32_16x16x32_bf16 v[124:127], v[52:55], v[16:19], v[124:127]
  v_mfma_f32_16x16x32_bf16 v[148:151], v[52:55], v[20:23], v[148:151]
  s_waitcnt lgkmcnt(6)
  v_mfma_f32_16x16x32_bf16 v[80:83], v[8:11], v[56:59], v[80:83]
  v_mfma_f32_16x16x32_bf16 v[104:107], v[12:15], v[56:59], v[104:107]
  v_mfma_f32_16x16x32_bf16 v[128:131], v[16:19], v[56:59], v[128:131]
  v_mfma_f32_16x16x32_bf16 v[152:155], v[20:23], v[56:59], v[152:155]
  s_waitcnt lgkmcnt(4)
  v_mfma_f32_16x16x32_bf16 v[84:87], v[8:11], v[60:63], v[84:87]
  v_mfma_f32_16x16x32_bf16 v[108:111], v[12:15], v[60:63], v[108:111]
  v_mfma_f32_16x16x32_bf16 v[132:135], v[16:19], v[60:63], v[132:135]
  v_mfma_f32_16x16x32_bf16 v[156:159], v[20:23], v[60:63], v[156:159]
  s_waitcnt lgkmcnt(0)
  s_barrier
  v_mfma_f32_16x16x32_bf16 v[160:163], v[40:43], v[24:27], v[160:163]
  v_add_u32 v2, 0xffff0000, v2
  ds_read_b128 v[8:11], v2 offset:0
  v_mfma_f32_16x16x32_bf16 v[184:187], v[40:43], v[28:31], v[184:187]
  ds_read_b128 v[12:15], v2 offset:2048
  v_mfma_f32_16x16x32_bf16 v[208:211], v[40:43], v[32:35], v[208:211]
  ds_read_b128 v[16:19], v2 offset:4096
  v_mfma_f32_16x16x32_bf16 v[232:235], v[40:43], v[36:39], v[232:235]
  ds_read_b128 v[20:23], v2 offset:6144
  v_mfma_f32_16x16x32_bf16 v[164:167], v[44:47], v[24:27], v[164:167]
  v_add_u32 v4, 0xffff4000, v4
  ds_read_b64_tr_b16 v[40:41], v4 offset:0
  v_mfma_f32_16x16x32_bf16 v[188:191], v[44:47], v[28:31], v[188:191]
  ds_read_b64_tr_b16 v[42:43], v4 offset:1536
  v_mfma_f32_16x16x32_bf16 v[212:215], v[44:47], v[32:35], v[212:215]
  v_mfma_f32_16x16x32_bf16 v[236:239], v[44:47], v[36:39], v[236:239]
  v_mfma_f32_16x16x32_bf16 v[168:171], v[48:51], v[24:27], v[168:171]
  v_add_u32 v5, 0xffff4000, v5
  ds_read_b64_tr_b16 v[44:45], v5 offset:0
  v_mfma_f32_16x16x32_bf16 v[192:195], v[48:51], v[28:31], v[192:195]
  ds_read_b64_tr_b16 v[46:47], v5 offset:1536
  v_mfma_f32_16x16x32_bf16 v[216:219], v[48:51], v[32:35], v[216:219]
  v_mfma_f32_16x16x32_bf16 v[240:243], v[48:51], v[36:39], v[240:243]
  v_mfma_f32_16x16x32_bf16 v[172:175], v[52:55], v[24:27], v[172:175]
  ds_read_b64_tr_b16 v[48:49], v4 offset:512
  v_mfma_f32_16x16x32_bf16 v[196:199], v[52:55], v[28:31], v[196:199]
  ds_read_b64_tr_b16 v[50:51], v4 offset:2048
  v_mfma_f32_16x16x32_bf16 v[220:223], v[52:55], v[32:35], v[220:223]
  v_mfma_f32_16x16x32_bf16 v[244:247], v[52:55], v[36:39], v[244:247]
  v_mfma_f32_16x16x32_bf16 v[176:179], v[24:27], v[56:59], v[176:179]
  ds_read_b64_tr_b16 v[52:53], v5 offset:512
  v_mfma_f32_16x16x32_bf16 v[200:203], v[28:31], v[56:59], v[200:203]
  ds_read_b64_tr_b16 v[54:55], v5 offset:2048
  v_mfma_f32_16x16x32_bf16 v[224:227], v[32:35], v[56:59], v[224:227]
  v_mfma_f32_16x16x32_bf16 v[248:251], v[36:39], v[56:59], v[248:251]
  v_mfma_f32_16x16x32_bf16 v[180:183], v[24:27], v[60:63], v[180:183]
  ds_read_b64_tr_b16 v[56:57], v4 offset:1024
  v_mfma_f32_16x16x32_bf16 v[204:207], v[28:31], v[60:63], v[204:207]
  ds_read_b64_tr_b16 v[58:59], v4 offset:2560
  v_mfma_f32_16x16x32_bf16 v[228:231], v[32:35], v[60:63], v[228:231]
  v_mfma_f32_16x16x32_bf16 v[252:255], v[36:39], v[60:63], v[252:255]
L_qkv_kernel_st30:
  s_waitcnt lgkmcnt(8)
  v_mfma_f32_16x16x32_bf16 v[64:67], v[40:43], v[8:11], v[64:67]
  ds_read_b64_tr_b16 v[60:61], v5 offset:1024
  v_mfma_f32_16x16x32_bf16 v[88:91], v[40:43], v[12:15], v[88:91]
  ds_read_b64_tr_b16 v[62:63], v5 offset:2560
  v_mfma_f32_16x16x32_bf16 v[112:115], v[40:43], v[16:19], v[112:115]
  ds_read_b128 v[24:27], v2 offset:8192
  v_mfma_f32_16x16x32_bf16 v[136:139], v[40:43], v[20:23], v[136:139]
  ds_read_b128 v[28:31], v2 offset:10240
  s_waitcnt lgkmcnt(10)
  v_mfma_f32_16x16x32_bf16 v[68:71], v[44:47], v[8:11], v[68:71]
  ds_read_b128 v[32:35], v2 offset:12288
  v_mfma_f32_16x16x32_bf16 v[92:95], v[44:47], v[12:15], v[92:95]
  ds_read_b128 v[36:39], v2 offset:14336
  v_mfma_f32_16x16x32_bf16 v[116:119], v[44:47], v[16:19], v[116:119]
  v_mfma_f32_16x16x32_bf16 v[140:143], v[44:47], v[20:23], v[140:143]
  s_waitcnt lgkmcnt(10)
  v_mfma_f32_16x16x32_bf16 v[72:75], v[48:51], v[8:11], v[72:75]
  v_mfma_f32_16x16x32_bf16 v[96:99], v[48:51], v[12:15], v[96:99]
  v_mfma_f32_16x16x32_bf16 v[120:123], v[48:51], v[16:19], v[120:123]
  v_mfma_f32_16x16x32_bf16 v[144:147], v[48:51], v[20:23], v[144:147]
  s_waitcnt lgkmcnt(8)
  v_mfma_f32_16x16x32_bf16 v[76:79], v[52:55], v[8:11], v[76:79]
  v_mfma_f32_16x16x32_bf16 v[100:103], v[52:55], v[12:15], v[100:103]
  v_mfma_f32_16x16x32_bf16 v[124:127], v[52:55], v[16:19], v[124:127]
  v_mfma_f32_16x16x32_bf16 v[148:151], v[52:55], v[20:23], v[148:151]
  s_waitcnt lgkmcnt(6)
  v_mfma_f32_16x16x32_bf16 v[80:83], v[8:11], v[56:59], v[80:83]
  v_mfma_f32_16x16x32_bf16 v[104:107], v[12:15], v[56:59], v[104:107]
  v_mfma_f32_16x16x32_bf16 v[128:131], v[16:19], v[56:59], v[128:131]
  v_mfma_f32_16x16x32_bf16 v[152:155], v[20:23], v[56:59], v[152:155]
  s_waitcnt lgkmcnt(4)
  v_mfma_f32_16x16x32_bf16 v[84:87], v[8:11], v[60:63], v[84:87]
  v_mfma_f32_16x16x32_bf16 v[108:111], v[12:15], v[60:63], v[108:111]
  v_mfma_f32_16x16x32_bf16 v[132:135], v[16:19], v[60:63], v[132:135]
  v_mfma_f32_16x16x32_bf16 v[156:159], v[20:23], v[60:63], v[156:159]
  s_waitcnt lgkmcnt(0)
  s_barrier
  v_mfma_f32_16x16x32_bf16 v[160:163], v[40:43], v[24:27], v[160:163]
  v_add_u32 v3, 0xffff0000, v3
  ds_read_b128 v[8:11], v3 offset:0
  v_mfma_f32_16x16x32_bf16 v[184:187], v[40:43], v[28:31], v[184:187]
  ds_read_b128 v[12:15], v3 offset:2048
  v_mfma_f32_16x16x32_bf16 v[208:211], v[40:43], v[32:35], v[208:211]
  ds_read_b128 v[16:19], v3 offset:4096
  v_mfma_f32_16x16x32_bf16 v[232:235], v[40:43], v[36:39], v[232:235]
  ds_read_b128 v[20:23], v3 offset:6144
  v_mfma_f32_16x16x32_bf16 v[164:167], v[44:47], v[24:27], v[164:167]
  v_add_u32 v4, 0x3000, v4
  ds_read_b64_tr_b16 v[40:41], v4 offset:0
  v_mfma_f32_16x16x32_bf16 v[188:191], v[44:47], v[28:31], v[188:191]
  ds_read_b64_tr_b16 v[42:43], v4 offset:1536
  v_mfma_f32_16x16x32_bf16 v[212:215], v[44:47], v[32:35], v[212:215]
  v_mfma_f32_16x16x32_bf16 v[236:239], v[44:47], v[36:39], v[236:239]
  v_mfma_f32_16x16x32_bf16 v[168:171], v[48:51], v[24:27], v[168:171]
  v_add_u32 v5, 0x3000, v5
  ds_read_b64_tr_b16 v[44:45], v5 offset:0
  v_mfma_f32_16x16x32_bf16 v[192:195], v[48:51], v[28:31], v[192:195]
  ds_read_b64_tr_b16 v[46:47], v5 offset:1536
  v_mfma_f32_16x16x32_bf16 v[216:219], v[48:51], v[32:35], v[216:219]
  v_mfma_f32_16x16x32_bf16 v[240:243], v[48:51], v[36:39], v[240:243]
  v_mfma_f32_16x16x32_bf16 v[172:175], v[52:55], v[24:27], v[172:175]
  ds_read_b64_tr_b16 v[48:49], v4 offset:512
  v_mfma_f32_16x16x32_bf16 v[196:199], v[52:55], v[28:31], v[196:199]
  ds_read_b64_tr_b16 v[50:51], v4 offset:2048
  v_mfma_f32_16x16x32_bf16 v[220:223], v[52:55], v[32:35], v[220:223]
  v_mfma_f32_16x16x32_bf16 v[244:247], v[52:55], v[36:39], v[244:247]
  v_mfma_f32_16x16x32_bf16 v[176:179], v[24:27], v[56:59], v[176:179]
  ds_read_b64_tr_b16 v[52:53], v5 offset:512
  v_mfma_f32_16x16x32_bf16 v[200:203], v[28:31], v[56:59], v[200:203]
  ds_read_b64_tr_b16 v[54:55], v5 offset:2048
  v_mfma_f32_16x16x32_bf16 v[224:227], v[32:35], v[56:59], v[224:227]
  v_mfma_f32_16x16x32_bf16 v[248:251], v[36:39], v[56:59], v[248:251]
  v_mfma_f32_16x16x32_bf16 v[180:183], v[24:27], v[60:63], v[180:183]
  ds_read_b64_tr_b16 v[56:57], v4 offset:1024
  v_mfma_f32_16x16x32_bf16 v[204:207], v[28:31], v[60:63], v[204:207]
  ds_read_b64_tr_b16 v[58:59], v4 offset:2560
  v_mfma_f32_16x16x32_bf16 v[228:231], v[32:35], v[60:63], v[228:231]
  v_mfma_f32_16x16x32_bf16 v[252:255], v[36:39], v[60:63], v[252:255]
L_qkv_kernel_st31:
  s_waitcnt lgkmcnt(8)
  v_mfma_f32_16x16x32_bf16 v[64:67], v[40:43], v[8:11], v[64:67]
  ds_read_b64_tr_b16 v[60:61], v5 offset:1024
  v_mfma_f32_16x16x32_bf16 v[88:91], v[40:43], v[12:15], v[88:91]
  ds_read_b64_tr_b16 v[62:63], v5 offset:2560
  v_mfma_f32_16x16x32_bf16 v[112:115], v[40:43], v[16:19], v[112:115]
  ds_read_b128 v[24:27], v3 offset:8192
  v_mfma_f32_16x16x32_bf16 v[136:139], v[40:43], v[20:23], v[136:139]
  ds_read_b128 v[28:31], v3 offset:10240
  s_waitcnt lgkmcnt(10)
  v_mfma_f32_16x16x32_bf16 v[68:71], v[44:47], v[8:11], v[68:71]
  ds_read_b128 v[32:35], v3 offset:12288
  v_mfma_f32_16x16x32_bf16 v[92:95], v[44:47], v[12:15], v[92:95]
  ds_read_b128 v[36:39], v3 offset:14336
  v_mfma_f32_16x16x32_bf16 v[116:119], v[44:47], v[16:19], v[116:119]
  v_mfma_f32_16x16x32_bf16 v[140:143], v[44:47], v[20:23], v[140:143]
  s_waitcnt lgkmcnt(10)
  v_mfma_f32_16x16x32_bf16 v[72:75], v[48:51], v[8:11], v[72:75]
  v_mfma_f32_16x16x32_bf16 v[96:99], v[48:51], v[12:15], v[96:99]
  v_mfma_f32_16x16x32_bf16 v[120:123], v[48:51], v[16:19], v[120:123]
  v_mfma_f32_16x16x32_bf16 v[144:147], v[48:51], v[20:23], v[144:147]
  s_waitcnt lgkmcnt(8)
  v_mfma_f32_16x16x32_bf16 v[76:79], v[52:55], v[8:11], v[76:79]
  v_mfma_f32_16x16x32_bf16 v[100:103], v[52:55], v[12:15], v[100:103]
  v_mfma_f32_16x16x32_bf16 v[124:127], v[52:55], v[16:19], v[124:127]
  v_mfma_f32_16x16x32_bf16 v[148:151], v[52:55], v[20:23], v[148:151]
  s_waitcnt lgkmcnt(6)
  v_mfma_f32_16x16x32_bf16 v[80:83], v[8:11], v[56:59], v[80:83]
  v_mfma_f32_16x16x32_bf16 v[104:107], v[12:15], v[56:59], v[104:107]
  v_mfma_f32_16x16x32_bf16 v[128:131], v[16:19], v[56:59], v[128:131]
  v_mfma_f32_16x16x32_bf16 v[152:155], v[20:23], v[56:59], v[152:155]
  s_waitcnt lgkmcnt(4)
  v_mfma_f32_16x16x32_bf16 v[84:87], v[8:11], v[60:63], v[84:87]
  v_mfma_f32_16x16x32_bf16 v[108:111], v[12:15], v[60:63], v[108:111]
  v_mfma_f32_16x16x32_bf16 v[132:135], v[16:19], v[60:63], v[132:135]
  v_mfma_f32_16x16x32_bf16 v[156:159], v[20:23], v[60:63], v[156:159]
  s_waitcnt lgkmcnt(0)
  v_mfma_f32_16x16x32_bf16 v[160:163], v[40:43], v[24:27], v[160:163]
  v_mfma_f32_16x16x32_bf16 v[184:187], v[40:43], v[28:31], v[184:187]
  v_mfma_f32_16x16x32_bf16 v[208:211], v[40:43], v[32:35], v[208:211]
  v_mfma_f32_16x16x32_bf16 v[232:235], v[40:43], v[36:39], v[232:235]
  v_mfma_f32_16x16x32_bf16 v[164:167], v[44:47], v[24:27], v[164:167]
  v_mfma_f32_16x16x32_bf16 v[188:191], v[44:47], v[28:31], v[188:191]
  v_mfma_f32_16x16x32_bf16 v[212:215], v[44:47], v[32:35], v[212:215]
  v_mfma_f32_16x16x32_bf16 v[236:239], v[44:47], v[36:39], v[236:239]
  v_mfma_f32_16x16x32_bf16 v[168:171], v[48:51], v[24:27], v[168:171]
  v_mfma_f32_16x16x32_bf16 v[192:195], v[48:51], v[28:31], v[192:195]
  v_mfma_f32_16x16x32_bf16 v[216:219], v[48:51], v[32:35], v[216:219]
  v_mfma_f32_16x16x32_bf16 v[240:243], v[48:51], v[36:39], v[240:243]
  v_mfma_f32_16x16x32_bf16 v[172:175], v[52:55], v[24:27], v[172:175]
  v_mfma_f32_16x16x32_bf16 v[196:199], v[52:55], v[28:31], v[196:199]
  v_mfma_f32_16x16x32_bf16 v[220:223], v[52:55], v[32:35], v[220:223]
  v_mfma_f32_16x16x32_bf16 v[244:247], v[52:55], v[36:39], v[244:247]
  v_mfma_f32_16x16x32_bf16 v[176:179], v[24:27], v[56:59], v[176:179]
  v_mfma_f32_16x16x32_bf16 v[200:203], v[28:31], v[56:59], v[200:203]
  v_mfma_f32_16x16x32_bf16 v[224:227], v[32:35], v[56:59], v[224:227]
  v_mfma_f32_16x16x32_bf16 v[248:251], v[36:39], v[56:59], v[248:251]
  v_mfma_f32_16x16x32_bf16 v[180:183], v[24:27], v[60:63], v[180:183]
  v_mfma_f32_16x16x32_bf16 v[204:207], v[28:31], v[60:63], v[204:207]
  v_mfma_f32_16x16x32_bf16 v[228:231], v[32:35], v[60:63], v[228:231]
  v_mfma_f32_16x16x32_bf16 v[252:255], v[36:39], v[60:63], v[252:255]
L_qkv_kernel_epi:
  s_cmp_eq_u32 s25, 1
  s_cbranch_scc1 L_qkv_kernel_epiB
  s_mul_i32 s48, s25, 12582912
  s_lshl_b32 s49, s24, 1
  s_add_u32 s49, s49, s22
  s_mul_i32 s49, s49, 131072
  s_add_u32 s48, s48, s49
  s_lshl_b32 s49, s23, 3
  s_lshl_b32 s50, s21, 2
  s_add_u32 s49, s49, s50
  s_lshl_b32 s49, s49, 11
  s_add_u32 s48, s48, s49
  v_add_u32 v6, s48, v6
  v_add_u32 v7, s48, v7
  s_mov_b32 s50, 0x3e8293ee
  s_mov_b32 s51, 0x3e8293ee
  s_nop 3
  v_cvt_pk_bf16_f32 v8, v72, v73
  v_cvt_pk_bf16_f32 v9, v74, v75
  v_cvt_pk_bf16_f32 v10, v76, v77
  v_cvt_pk_bf16_f32 v11, v78, v79
  s_mov_b32 s52, 4194304
  buffer_store_dwordx4 v[8:11], v7, s[16:19], s52 offen sc1
  v_cvt_pk_bf16_f32 v20, v96, v97
  v_cvt_pk_bf16_f32 v21, v98, v99
  v_cvt_pk_bf16_f32 v22, v100, v101
  v_cvt_pk_bf16_f32 v23, v102, v103
  s_mov_b32 s52, 4194304
  buffer_store_dwordx4 v[20:23], v7, s[16:19], s52 offen offset:128 sc1
  v_cvt_pk_bf16_f32 v32, v80, v81
  v_cvt_pk_bf16_f32 v33, v82, v83
  v_cvt_pk_bf16_f32 v34, v104, v105
  v_cvt_pk_bf16_f32 v35, v106, v107
  s_mov_b32 s52, 8388608
  buffer_store_dwordx4 v[32:35], v6, s[16:19], s52 offen sc1
  v_cvt_pk_bf16_f32 v44, v84, v85
  v_cvt_pk_bf16_f32 v45, v86, v87
  v_cvt_pk_bf16_f32 v46, v108, v109
  v_cvt_pk_bf16_f32 v47, v110, v111
  s_mov_b32 s52, 8388608
  buffer_store_dwordx4 v[44:47], v6, s[16:19], s52 offen offset:256 sc1
  v_pk_mul_f32 v[64:65], v[64:65], s[50:51]
  v_pk_mul_f32 v[66:67], v[66:67], s[50:51]
  v_pk_mul_f32 v[68:69], v[68:69], s[50:51]
  v_pk_mul_f32 v[70:71], v[70:71], s[50:51]
  v_cvt_pk_bf16_f32 v8, v64, v65
  v_cvt_pk_bf16_f32 v9, v66, v67
  v_cvt_pk_bf16_f32 v10, v68, v69
  v_cvt_pk_bf16_f32 v11, v70, v71
  s_mov_b32 s52, 0
  buffer_store_dwordx4 v[8:11], v6, s[16:19], s52 offen sc1
  v_pk_mul_f32 v[88:89], v[88:89], s[50:51]
  v_pk_mul_f32 v[90:91], v[90:91], s[50:51]
  v_pk_mul_f32 v[92:93], v[92:93], s[50:51]
  v_pk_mul_f32 v[94:95], v[94:95], s[50:51]
  v_cvt_pk_bf16_f32 v20, v88, v89
  v_cvt_pk_bf16_f32 v21, v90, v91
  v_cvt_pk_bf16_f32 v22, v92, v93
  v_cvt_pk_bf16_f32 v23, v94, v95
  s_mov_b32 s52, 0
  buffer_store_dwordx4 v[20:23], v6, s[16:19], s52 offen offset:256 sc1
  v_cvt_pk_bf16_f32 v32, v120, v121
  v_cvt_pk_bf16_f32 v33, v122, v123
  v_cvt_pk_bf16_f32 v34, v124, v125
  v_cvt_pk_bf16_f32 v35, v126, v127
  s_mov_b32 s52, 4196352
  buffer_store_dwordx4 v[32:35], v7, s[16:19], s52 offen sc1
  v_cvt_pk_bf16_f32 v44, v144, v145
  v_cvt_pk_bf16_f32 v45, v146, v147
  v_cvt_pk_bf16_f32 v46, v148, v149
  v_cvt_pk_bf16_f32 v47, v150, v151
  s_mov_b32 s52, 4196352
  buffer_store_dwordx4 v[44:47], v7, s[16:19], s52 offen offset:128 sc1
  v_cvt_pk_bf16_f32 v8, v128, v129
  v_cvt_pk_bf16_f32 v9, v130, v131
  v_cvt_pk_bf16_f32 v10, v152, v153
  v_cvt_pk_bf16_f32 v11, v154, v155
  s_mov_b32 s52, 8390656
  buffer_store_dwordx4 v[8:11], v6, s[16:19], s52 offen sc1
  v_cvt_pk_bf16_f32 v20, v132, v133
  v_cvt_pk_bf16_f32 v21, v134, v135
  v_cvt_pk_bf16_f32 v22, v156, v157
  v_cvt_pk_bf16_f32 v23, v158, v159
  s_mov_b32 s52, 8390656
  buffer_store_dwordx4 v[20:23], v6, s[16:19], s52 offen offset:256 sc1
  v_pk_mul_f32 v[112:113], v[112:113], s[50:51]
  v_pk_mul_f32 v[114:115], v[114:115], s[50:51]
  v_pk_mul_f32 v[116:117], v[116:117], s[50:51]
  v_pk_mul_f32 v[118:119], v[118:119], s[50:51]
  v_cvt_pk_bf16_f32 v32, v112, v113
  v_cvt_pk_bf16_f32 v33, v114, v115
  v_cvt_pk_bf16_f32 v34, v116, v117
  v_cvt_pk_bf16_f32 v35, v118, v119
  s_mov_b32 s52, 2048
  buffer_store_dwordx4 v[32:35], v6, s[16:19], s52 offen sc1
  v_pk_mul_f32 v[136:137], v[136:137], s[50:51]
  v_pk_mul_f32 v[138:139], v[138:139], s[50:51]
  v_pk_mul_f32 v[140:141], v[140:141], s[50:51]
  v_pk_mul_f32 v[142:143], v[142:143], s[50:51]
  v_cvt_pk_bf16_f32 v44, v136, v137
  v_cvt_pk_bf16_f32 v45, v138, v139
  v_cvt_pk_bf16_f32 v46, v140, v141
  v_cvt_pk_bf16_f32 v47, v142, v143
  s_mov_b32 s52, 2048
  buffer_store_dwordx4 v[44:47], v6, s[16:19], s52 offen offset:256 sc1
  v_cvt_pk_bf16_f32 v8, v168, v169
  v_cvt_pk_bf16_f32 v9, v170, v171
  v_cvt_pk_bf16_f32 v10, v172, v173
  v_cvt_pk_bf16_f32 v11, v174, v175
  s_mov_b32 s52, 4198400
  buffer_store_dwordx4 v[8:11], v7, s[16:19], s52 offen sc1
  v_cvt_pk_bf16_f32 v20, v192, v193
  v_cvt_pk_bf16_f32 v21, v194, v195
  v_cvt_pk_bf16_f32 v22, v196, v197
  v_cvt_pk_bf16_f32 v23, v198, v199
  s_mov_b32 s52, 4198400
  buffer_store_dwordx4 v[20:23], v7, s[16:19], s52 offen offset:128 sc1
  v_cvt_pk_bf16_f32 v32, v176, v177
  v_cvt_pk_bf16_f32 v33, v178, v179
  v_cvt_pk_bf16_f32 v34, v200, v201
  v_cvt_pk_bf16_f32 v35, v202, v203
  s_mov_b32 s52, 8392704
  buffer_store_dwordx4 v[32:35], v6, s[16:19], s52 offen sc1
  v_cvt_pk_bf16_f32 v44, v180, v181
  v_cvt_pk_bf16_f32 v45, v182, v183
  v_cvt_pk_bf16_f32 v46, v204, v205
  v_cvt_pk_bf16_f32 v47, v206, v207
  s_mov_b32 s52, 8392704
  buffer_store_dwordx4 v[44:47], v6, s[16:19], s52 offen offset:256 sc1
  v_pk_mul_f32 v[160:161], v[160:161], s[50:51]
  v_pk_mul_f32 v[162:163], v[162:163], s[50:51]
  v_pk_mul_f32 v[164:165], v[164:165], s[50:51]
  v_pk_mul_f32 v[166:167], v[166:167], s[50:51]
  v_cvt_pk_bf16_f32 v8, v160, v161
  v_cvt_pk_bf16_f32 v9, v162, v163
  v_cvt_pk_bf16_f32 v10, v164, v165
  v_cvt_pk_bf16_f32 v11, v166, v167
  s_mov_b32 s52, 4096
  buffer_store_dwordx4 v[8:11], v6, s[16:19], s52 offen sc1
  v_pk_mul_f32 v[184:185], v[184:185], s[50:51]
  v_pk_mul_f32 v[186:187], v[186:187], s[50:51]
  v_pk_mul_f32 v[188:189], v[188:189], s[50:51]
  v_pk_mul_f32 v[190:191], v[190:191], s[50:51]
  v_cvt_pk_bf16_f32 v20, v184, v185
  v_cvt_pk_bf16_f32 v21, v186, v187
  v_cvt_pk_bf16_f32 v22, v188, v189
  v_cvt_pk_bf16_f32 v23, v190, v191
  s_mov_b32 s52, 4096
  buffer_store_dwordx4 v[20:23], v6, s[16:19], s52 offen offset:256 sc1
  v_cvt_pk_bf16_f32 v32, v216, v217
  v_cvt_pk_bf16_f32 v33, v218, v219
  v_cvt_pk_bf16_f32 v34, v220, v221
  v_cvt_pk_bf16_f32 v35, v222, v223
  s_mov_b32 s52, 4200448
  buffer_store_dwordx4 v[32:35], v7, s[16:19], s52 offen sc1
  v_cvt_pk_bf16_f32 v44, v240, v241
  v_cvt_pk_bf16_f32 v45, v242, v243
  v_cvt_pk_bf16_f32 v46, v244, v245
  v_cvt_pk_bf16_f32 v47, v246, v247
  s_mov_b32 s52, 4200448
  buffer_store_dwordx4 v[44:47], v7, s[16:19], s52 offen offset:128 sc1
  v_cvt_pk_bf16_f32 v8, v224, v225
  v_cvt_pk_bf16_f32 v9, v226, v227
  v_cvt_pk_bf16_f32 v10, v248, v249
  v_cvt_pk_bf16_f32 v11, v250, v251
  s_mov_b32 s52, 8394752
  buffer_store_dwordx4 v[8:11], v6, s[16:19], s52 offen sc1
  v_cvt_pk_bf16_f32 v20, v228, v229
  v_cvt_pk_bf16_f32 v21, v230, v231
  v_cvt_pk_bf16_f32 v22, v252, v253
  v_cvt_pk_bf16_f32 v23, v254, v255
  s_mov_b32 s52, 8394752
  buffer_store_dwordx4 v[20:23], v6, s[16:19], s52 offen offset:256 sc1
  v_pk_mul_f32 v[208:209], v[208:209], s[50:51]
  v_pk_mul_f32 v[210:211], v[210:211], s[50:51]
  v_pk_mul_f32 v[212:213], v[212:213], s[50:51]
  v_pk_mul_f32 v[214:215], v[214:215], s[50:51]
  v_cvt_pk_bf16_f32 v32, v208, v209
  v_cvt_pk_bf16_f32 v33, v210, v211
  v_cvt_pk_bf16_f32 v34, v212, v213
  v_cvt_pk_bf16_f32 v35, v214, v215
  s_mov_b32 s52, 6144
  buffer_store_dwordx4 v[32:35], v6, s[16:19], s52 offen sc1
  v_pk_mul_f32 v[232:233], v[232:233], s[50:51]
  v_pk_mul_f32 v[234:235], v[234:235], s[50:51]
  v_pk_mul_f32 v[236:237], v[236:237], s[50:51]
  v_pk_mul_f32 v[238:239], v[238:239], s[50:51]
  v_cvt_pk_bf16_f32 v44, v232, v233
  v_cvt_pk_bf16_f32 v45, v234, v235
  v_cvt_pk_bf16_f32 v46, v236, v237
  v_cvt_pk_bf16_f32 v47, v238, v239
  s_mov_b32 s52, 6144
  buffer_store_dwordx4 v[44:47], v6, s[16:19], s52 offen offset:256 sc1
  s_endpgm
L_qkv_kernel_epiB:
  v_lshlrev_b32 v7, 4, v1
  s_lshl_b32 s52, s22, 11
  s_add_u32 s52, s52, 32768
  v_lshlrev_b32 v61, 3, v1
  v_add_u32 v60, s52, v7
  v_add_u32 v62, s52, v61
  s_mov_b32 s50, 0x3e8293ee
  s_mov_b32 s51, 0x3e8293ee
L_qkv_kernel_d0:
  v_cvt_pk_bf16_f32 v10, v80, v81
  v_cvt_pk_bf16_f32 v11, v82, v83
  v_cvt_pk_bf16_f32 v28, v84, v85
  v_cvt_pk_bf16_f32 v29, v86, v87
  v_cvt_pk_bf16_f32 v12, v104, v105
  v_cvt_pk_bf16_f32 v13, v106, v107
  v_cvt_pk_bf16_f32 v30, v108, v109
  v_cvt_pk_bf16_f32 v31, v110, v111
  v_cvt_pk_bf16_f32 v14, v128, v129
  v_cvt_pk_bf16_f32 v15, v130, v131
  v_cvt_pk_bf16_f32 v32, v132, v133
  v_cvt_pk_bf16_f32 v33, v134, v135
  v_cvt_pk_bf16_f32 v16, v152, v153
  v_cvt_pk_bf16_f32 v17, v154, v155
  v_cvt_pk_bf16_f32 v34, v156, v157
  v_cvt_pk_bf16_f32 v35, v158, v159
  v_cvt_pk_bf16_f32 v18, v176, v177
  v_cvt_pk_bf16_f32 v19, v178, v179
  v_cvt_pk_bf16_f32 v36, v180, v181
  v_cvt_pk_bf16_f32 v37, v182, v183
  v_cvt_pk_bf16_f32 v20, v200, v201
  v_cvt_pk_bf16_f32 v21, v202, v203
  v_cvt_pk_bf16_f32 v38, v204, v205
  v_cvt_pk_bf16_f32 v39, v206, v207
  v_cvt_pk_bf16_f32 v22, v224, v225
  v_cvt_pk_bf16_f32 v23, v226, v227
  v_cvt_pk_bf16_f32 v40, v228, v229
  v_cvt_pk_bf16_f32 v41, v230, v231
  v_cvt_pk_bf16_f32 v24, v248, v249
  v_cvt_pk_bf16_f32 v25, v250, v251
  v_cvt_pk_bf16_f32 v42, v252, v253
  v_cvt_pk_bf16_f32 v43, v254, v255
  v_cvt_pk_bf16_f32 v72, v72, v73
  v_cvt_pk_bf16_f32 v73, v74, v75
  v_cvt_pk_bf16_f32 v74, v76, v77
  v_cvt_pk_bf16_f32 v75, v78, v79
  v_cvt_pk_bf16_f32 v96, v96, v97
  v_cvt_pk_bf16_f32 v97, v98, v99
  v_cvt_pk_bf16_f32 v98, v100, v101
  v_cvt_pk_bf16_f32 v99, v102, v103
  v_cvt_pk_bf16_f32 v120, v120, v121
  v_cvt_pk_bf16_f32 v121, v122, v123
  v_cvt_pk_bf16_f32 v122, v124, v125
  v_cvt_pk_bf16_f32 v123, v126, v127
  v_cvt_pk_bf16_f32 v144, v144, v145
  v_cvt_pk_bf16_f32 v145, v146, v147
  v_cvt_pk_bf16_f32 v146, v148, v149
  v_cvt_pk_bf16_f32 v147, v150, v151
  v_cvt_pk_bf16_f32 v168, v168, v169
  v_cvt_pk_bf16_f32 v169, v170, v171
  v_cvt_pk_bf16_f32 v170, v172, v173
  v_cvt_pk_bf16_f32 v171, v174, v175
  v_cvt_pk_bf16_f32 v192, v192, v193
  v_cvt_pk_bf16_f32 v193, v194, v195
  v_cvt_pk_bf16_f32 v194, v196, v197
  v_cvt_pk_bf16_f32 v195, v198, v199
  v_cvt_pk_bf16_f32 v216, v216, v217
  v_cvt_pk_bf16_f32 v217, v218, v219
  v_cvt_pk_bf16_f32 v218, v220, v221
  v_cvt_pk_bf16_f32 v219, v222, v223
  v_cvt_pk_bf16_f32 v240, v240, v241
  v_cvt_pk_bf16_f32 v241, v242, v243
  v_cvt_pk_bf16_f32 v242, v244, v245
  v_cvt_pk_bf16_f32 v243, v246, v247
  v_cvt_pk_bf16_f32 v64, v64, v65
  v_cvt_pk_bf16_f32 v65, v66, v67
  v_cvt_pk_bf16_f32 v66, v68, v69
  v_cvt_pk_bf16_f32 v67, v70, v71
  v_cvt_pk_bf16_f32 v88, v88, v89
  v_cvt_pk_bf16_f32 v89, v90, v91
  v_cvt_pk_bf16_f32 v90, v92, v93
  v_cvt_pk_bf16_f32 v91, v94, v95
  v_cvt_pk_bf16_f32 v112, v112, v113
  v_cvt_pk_bf16_f32 v113, v114, v115
  v_cvt_pk_bf16_f32 v114, v116, v117
  v_cvt_pk_bf16_f32 v115, v118, v119
  v_cvt_pk_bf16_f32 v136, v136, v137
  v_cvt_pk_bf16_f32 v137, v138, v139
  v_cvt_pk_bf16_f32 v138, v140, v141
  v_cvt_pk_bf16_f32 v139, v142, v143
  v_cvt_pk_bf16_f32 v160, v160, v161
  v_cvt_pk_bf16_f32 v161, v162, v163
  v_cvt_pk_bf16_f32 v162, v164, v165
  v_cvt_pk_bf16_f32 v163, v166, v167
  v_cvt_pk_bf16_f32 v184, v184, v185
  v_cvt_pk_bf16_f32 v185, v186, v187
  v_cvt_pk_bf16_f32 v186, v188, v189
  v_cvt_pk_bf16_f32 v187, v190, v191
  v_cvt_pk_bf16_f32 v208, v208, v209
  v_cvt_pk_bf16_f32 v209, v210, v211
  v_cvt_pk_bf16_f32 v210, v212, v213
  v_cvt_pk_bf16_f32 v211, v214, v215
  v_cvt_pk_bf16_f32 v232, v232, v233
  v_cvt_pk_bf16_f32 v233, v234, v235
  v_cvt_pk_bf16_f32 v234, v236, v237
  v_cvt_pk_bf16_f32 v235, v238, v239
  s_cbranch_execz L_qkv_kernel_dryret
  s_cmp_eq_u32 s21, 0
  s_cbranch_scc0 L_qkv_kernel_bh1
  ds_write_b128 v60, v[240:243]
  ds_write_b64 v62, v[24:25] offset:1024
  ds_write_b64 v62, v[42:43] offset:1536
  buffer_store_dwordx4 v[64:67], v7, s[16:19], s54 offen sc1
  buffer_store_dwordx4 v[72:75], v7, s[16:19], s54 offen offset:1024 sc1
  buffer_store_dwordx2 v[10:11], v61, s[16:19], s54 offen offset:2048 sc1
  buffer_store_dwordx2 v[28:29], v61, s[16:19], s54 offen offset:2560 sc1
  s_branch L_qkv_kernel_bh2
L_qkv_kernel_bh1:
  s_add_u32 s52, s54, 3072
  buffer_store_dwordx4 v[240:243], v7, s[16:19], s52 offen sc1
  buffer_store_dwordx2 v[24:25], v61, s[16:19], s52 offen offset:1024 sc1
  buffer_store_dwordx2 v[42:43], v61, s[16:19], s52 offen offset:1536 sc1
L_qkv_kernel_bh2:
L_qkv_kernel_d1:
  v_mov_b32 v63, 0xff800000
  v_cndmask_b32 v52, v63, 0, s[60:61]
  v_cndmask_b32 v48, v63, 0, s[62:63]
  v_cndmask_b32 v53, v63, 0, s[64:65]
  v_cndmask_b32 v49, v63, 0, s[66:67]
  v_cndmask_b32 v54, v63, 0, s[68:69]
  v_cndmask_b32 v50, v63, 0, s[70:71]
  v_cndmask_b32 v55, v63, 0, s[72:73]
  v_cndmask_b32 v51, v63, 0, s[74:75]
  v_mov_b32 v56, 0x3f803f80
  v_mov_b32 v57, 0x3f803f80
  v_mov_b32 v58, 0x3f803f80
  v_mov_b32 v59, 0x3f803f80
  s_cbranch_execz L_qkv_kernel_dm1
  s_waitcnt lgkmcnt(0)
  s_barrier
  s_cmp_eq_u32 s21, 0
  s_cbranch_scc1 L_qkv_kernel_bnr
  ds_read_b128 v[44:47], v60
  ds_read_b64 v[8:9], v62 offset:1024
  ds_read_b64 v[26:27], v62 offset:1536
L_qkv_kernel_bnr:
  v_mfma_f32_16x16x32_bf16 v[84:87], v[72:75], v[64:67], v[52:55]
  v_mfma_f32_16x16x32_bf16 v[108:111], v[96:99], v[88:91], v[52:55]
  v_mfma_f32_16x16x32_bf16 v[132:135], v[120:123], v[112:115], v[52:55]
  v_mfma_f32_16x16x32_bf16 v[156:159], v[144:147], v[136:139], v[52:55]
  v_mfma_f32_16x16x32_bf16 v[180:183], v[168:171], v[160:163], v[52:55]
  v_mfma_f32_16x16x32_bf16 v[204:207], v[192:195], v[184:187], v[52:55]
  v_mfma_f32_16x16x32_bf16 v[228:231], v[216:219], v[208:211], v[52:55]
  v_mfma_f32_16x16x32_bf16 v[252:255], v[240:243], v[232:235], v[52:55]
  v_mfma_f32_16x16x32_bf16 v[104:107], v[72:75], v[88:91], v[48:51]
  v_mfma_f32_16x16x32_bf16 v[128:131], v[96:99], v[112:115], v[48:51]
  v_mfma_f32_16x16x32_bf16 v[152:155], v[120:123], v[136:139], v[48:51]
  v_mfma_f32_16x16x32_bf16 v[176:179], v[144:147], v[160:163], v[48:51]
  v_mfma_f32_16x16x32_bf16 v[200:203], v[168:171], v[184:187], v[48:51]
  v_mfma_f32_16x16x32_bf16 v[224:227], v[192:195], v[208:211], v[48:51]
  v_mfma_f32_16x16x32_bf16 v[248:251], v[216:219], v[232:235], v[48:51]
  s_waitcnt lgkmcnt(0)
  v_mfma_f32_16x16x32_bf16 v[80:83], v[44:47], v[64:67], v[48:51]
L_qkv_kernel_dm1:
  v_max3_f32 v92, v108, v109, v110
  v_max3_f32 v116, v132, v133, v134
  v_max3_f32 v140, v156, v157, v158
  v_max3_f32 v164, v180, v181, v182
  v_max3_f32 v188, v204, v205, v206
  v_max3_f32 v212, v228, v229, v230
  v_max3_f32 v236, v252, v253, v254
  v_max3_f32 v68, v84, v85, v86
  v_max3_f32 v92, v111, v104, v92
  v_max3_f32 v116, v135, v128, v116
  v_max3_f32 v140, v159, v152, v140
  v_max3_f32 v164, v183, v176, v164
  v_max3_f32 v188, v207, v200, v188
  v_max3_f32 v212, v231, v224, v212
  v_max3_f32 v236, v255, v248, v236
  v_max3_f32 v68, v87, v80, v68
  v_max3_f32 v92, v105, v106, v92
  v_max3_f32 v116, v129, v130, v116
  v_max3_f32 v140, v153, v154, v140
  v_max3_f32 v164, v177, v178, v164
  v_max3_f32 v188, v201, v202, v188
  v_max3_f32 v212, v225, v226, v212
  v_max3_f32 v236, v249, v250, v236
  v_max3_f32 v68, v81, v82, v68
  v_max_f32 v92, v107, v92
  v_max_f32 v116, v131, v116
  v_max_f32 v140, v155, v140
  v_max_f32 v164, v179, v164
  v_max_f32 v188, v203, v188
  v_max_f32 v212, v227, v212
  v_max_f32 v236, v251, v236
  v_max_f32 v68, v83, v68
  v_mov_b32 v93, v92
  v_mov_b32 v117, v116
  v_mov_b32 v141, v140
  v_mov_b32 v165, v164
  v_mov_b32 v189, v188
  v_mov_b32 v213, v212
  v_mov_b32 v237, v236
  v_mov_b32 v69, v68
  v_permlane32_swap_b32 v92, v93
  v_permlane32_swap_b32 v116, v117
  v_permlane32_swap_b32 v140, v141
  v_permlane32_swap_b32 v164, v165
  v_permlane32_swap_b32 v188, v189
  v_permlane32_swap_b32 v212, v213
  v_permlane32_swap_b32 v236, v237
  v_permlane32_swap_b32 v68, v69
  v_max_f32 v92, v92, v93
  v_max_f32 v116, v116, v117
  v_max_f32 v140, v140, v141
  v_max_f32 v164, v164, v165
  v_max_f32 v188, v188, v189
  v_max_f32 v212, v212, v213
  v_max_f32 v236, v236, v237
  v_max_f32 v68, v68, v69
  v_mov_b32 v93, v92
  v_mov_b32 v117, v116
  v_mov_b32 v141, v140
  v_mov_b32 v165, v164
  v_mov_b32 v189, v188
  v_mov_b32 v213, v212
  v_mov_b32 v237, v236
  v_mov_b32 v69, v68
  v_permlane16_swap_b32 v92, v93
  v_permlane16_swap_b32 v116, v117
  v_permlane16_swap_b32 v140, v141
  v_permlane16_swap_b32 v164, v165
  v_permlane16_swap_b32 v188, v189
  v_permlane16_swap_b32 v212, v213
  v_permlane16_swap_b32 v236, v237
  v_permlane16_swap_b32 v68, v69
  v_max_f32 v92, v92, v93
  v_max_f32 v116, v116, v117
  v_max_f32 v140, v140, v141
  v_max_f32 v164, v164, v165
  v_max_f32 v188, v188, v189
  v_max_f32 v212, v212, v213
  v_max_f32 v236, v236, v237
  v_max_f32 v68, v68, v69
  v_mul_f32 v92, s50, v92
  v_mul_f32 v116, s50, v116
  v_mul_f32 v140, s50, v140
  v_mul_f32 v164, s50, v164
  v_mul_f32 v188, s50, v188
  v_mul_f32 v212, s50, v212
  v_mul_f32 v236, s50, v236
  v_mul_f32 v68, s50, v68
  v_pk_fma_f32 v[104:105], v[104:105], s[50:51], v[92:93] op_sel_hi:[1,1,0] neg_lo:[0,0,1] neg_hi:[0,0,1]
  v_pk_fma_f32 v[128:129], v[128:129], s[50:51], v[116:117] op_sel_hi:[1,1,0] neg_lo:[0,0,1] neg_hi:[0,0,1]
  v_pk_fma_f32 v[152:153], v[152:153], s[50:51], v[140:141] op_sel_hi:[1,1,0] neg_lo:[0,0,1] neg_hi:[0,0,1]
  v_pk_fma_f32 v[176:177], v[176:177], s[50:51], v[164:165] op_sel_hi:[1,1,0] neg_lo:[0,0,1] neg_hi:[0,0,1]
  v_pk_fma_f32 v[200:201], v[200:201], s[50:51], v[188:189] op_sel_hi:[1,1,0] neg_lo:[0,0,1] neg_hi:[0,0,1]
  v_pk_fma_f32 v[224:225], v[224:225], s[50:51], v[212:213] op_sel_hi:[1,1,0] neg_lo:[0,0,1] neg_hi:[0,0,1]
  v_pk_fma_f32 v[248:249], v[248:249], s[50:51], v[236:237] op_sel_hi:[1,1,0] neg_lo:[0,0,1] neg_hi:[0,0,1]
  v_pk_fma_f32 v[80:81], v[80:81], s[50:51], v[68:69] op_sel_hi:[1,1,0] neg_lo:[0,0,1] neg_hi:[0,0,1]
  v_pk_fma_f32 v[106:107], v[106:107], s[50:51], v[92:93] op_sel_hi:[1,1,0] neg_lo:[0,0,1] neg_hi:[0,0,1]
  v_pk_fma_f32 v[130:131], v[130:131], s[50:51], v[116:117] op_sel_hi:[1,1,0] neg_lo:[0,0,1] neg_hi:[0,0,1]
  v_pk_fma_f32 v[154:155], v[154:155], s[50:51], v[140:141] op_sel_hi:[1,1,0] neg_lo:[0,0,1] neg_hi:[0,0,1]
  v_pk_fma_f32 v[178:179], v[178:179], s[50:51], v[164:165] op_sel_hi:[1,1,0] neg_lo:[0,0,1] neg_hi:[0,0,1]
  v_pk_fma_f32 v[202:203], v[202:203], s[50:51], v[188:189] op_sel_hi:[1,1,0] neg_lo:[0,0,1] neg_hi:[0,0,1]
  v_pk_fma_f32 v[226:227], v[226:227], s[50:51], v[212:213] op_sel_hi:[1,1,0] neg_lo:[0,0,1] neg_hi:[0,0,1]
  v_pk_fma_f32 v[250:251], v[250:251], s[50:51], v[236:237] op_sel_hi:[1,1,0] neg_lo:[0,0,1] neg_hi:[0,0,1]
  v_pk_fma_f32 v[82:83], v[82:83], s[50:51], v[68:69] op_sel_hi:[1,1,0] neg_lo:[0,0,1] neg_hi:[0,0,1]
  v_pk_fma_f32 v[108:109], v[108:109], s[50:51], v[92:93] op_sel_hi:[1,1,0] neg_lo:[0,0,1] neg_hi:[0,0,1]
  v_pk_fma_f32 v[132:133], v[132:133], s[50:51], v[116:117] op_sel_hi:[1,1,0] neg_lo:[0,0,1] neg_hi:[0,0,1]
  v_pk_fma_f32 v[156:157], v[156:157], s[50:51], v[140:141] op_sel_hi:[1,1,0] neg_lo:[0,0,1] neg_hi:[0,0,1]
  v_pk_fma_f32 v[180:181], v[180:181], s[50:51], v[164:165] op_sel_hi:[1,1,0] neg_lo:[0,0,1] neg_hi:[0,0,1]
  v_pk_fma_f32 v[204:205], v[204:205], s[50:51], v[188:189] op_sel_hi:[1,1,0] neg_lo:[0,0,1] neg_hi:[0,0,1]
  v_pk_fma_f32 v[228:229], v[228:229], s[50:51], v[212:213] op_sel_hi:[1,1,0] neg_lo:[0,0,1] neg_hi:[0,0,1]
  v_pk_fma_f32 v[252:253], v[252:253], s[50:51], v[236:237] op_sel_hi:[1,1,0] neg_lo:[0,0,1] neg_hi:[0,0,1]
  v_pk_fma_f32 v[84:85], v[84:85], s[50:51], v[68:69] op_sel_hi:[1,1,0] neg_lo:[0,0,1] neg_hi:[0,0,1]
  v_pk_fma_f32 v[110:111], v[110:111], s[50:51], v[92:93] op_sel_hi:[1,1,0] neg_lo:[0,0,1] neg_hi:[0,0,1]
  v_pk_fma_f32 v[134:135], v[134:135], s[50:51], v[116:117] op_sel_hi:[1,1,0] neg_lo:[0,0,1] neg_hi:[0,0,1]
  v_pk_fma_f32 v[158:159], v[158:159], s[50:51], v[140:141] op_sel_hi:[1,1,0] neg_lo:[0,0,1] neg_hi:[0,0,1]
  v_pk_fma_f32 v[182:183], v[182:183], s[50:51], v[164:165] op_sel_hi:[1,1,0] neg_lo:[0,0,1] neg_hi:[0,0,1]
  v_pk_fma_f32 v[206:207], v[206:207], s[50:51], v[188:189] op_sel_hi:[1,1,0] neg_lo:[0,0,1] neg_hi:[0,0,1]
  v_pk_fma_f32 v[230:231], v[230:231], s[50:51], v[212:213] op_sel_hi:[1,1,0] neg_lo:[0,0,1] neg_hi:[0,0,1]
  v_pk_fma_f32 v[254:255], v[254:255], s[50:51], v[236:237] op_sel_hi:[1,1,0] neg_lo:[0,0,1] neg_hi:[0,0,1]
  v_pk_fma_f32 v[86:87], v[86:87], s[50:51], v[68:69] op_sel_hi:[1,1,0] neg_lo:[0,0,1] neg_hi:[0,0,1]
  s_cbranch_execz L_qkv_kernel_dryret
L_qkv_kernel_d2:
  v_exp_f32 v104, v104
  v_exp_f32 v128, v128
  v_exp_f32 v152, v152
  v_exp_f32 v176, v176
  v_exp_f32 v200, v200
  v_exp_f32 v224, v224
  v_exp_f32 v248, v248
  v_exp_f32 v80, v80
  v_exp_f32 v105, v105
  v_exp_f32 v129, v129
  v_exp_f32 v153, v153
  v_exp_f32 v177, v177
  v_exp_f32 v201, v201
  v_exp_f32 v225, v225
  v_exp_f32 v249, v249
  v_exp_f32 v81, v81
  v_exp_f32 v106, v106
  v_exp_f32 v130, v130
  v_exp_f32 v154, v154
  v_exp_f32 v178, v178
  v_exp_f32 v202, v202
  v_exp_f32 v226, v226
  v_exp_f32 v250, v250
  v_exp_f32 v82, v82
  v_exp_f32 v107, v107
  v_exp_f32 v131, v131
  v_exp_f32 v155, v155
  v_exp_f32 v179, v179
  v_exp_f32 v203, v203
  v_exp_f32 v227, v227
  v_exp_f32 v251, v251
  v_exp_f32 v83, v83
  v_exp_f32 v108, v108
  v_exp_f32 v132, v132
  v_exp_f32 v156, v156
  v_exp_f32 v180, v180
  v_exp_f32 v204, v204
  v_exp_f32 v228, v228
  v_exp_f32 v252, v252
  v_exp_f32 v84, v84
  v_exp_f32 v109, v109
  v_exp_f32 v133, v133
  v_exp_f32 v157, v157
  v_exp_f32 v181, v181
  v_exp_f32 v205, v205
  v_exp_f32 v229, v229
  v_exp_f32 v253, v253
  v_exp_f32 v85, v85
  v_exp_f32 v110, v110
  v_exp_f32 v134, v134
  v_exp_f32 v158, v158
  v_exp_f32 v182, v182
  v_exp_f32 v206, v206
  v_exp_f32 v230, v230
  v_exp_f32 v254, v254
  v_exp_f32 v86, v86
  v_exp_f32 v111, v111
  v_exp_f32 v135, v135
  v_exp_f32 v159, v159
  v_exp_f32 v183, v183
  v_exp_f32 v207, v207
  v_exp_f32 v231, v231
  v_exp_f32 v255, v255
  v_exp_f32 v87, v87
  v_cvt_pk_bf16_f32 v100, v104, v105
  v_cvt_pk_bf16_f32 v124, v128, v129
  v_cvt_pk_bf16_f32 v148, v152, v153
  v_cvt_pk_bf16_f32 v172, v176, v177
  v_cvt_pk_bf16_f32 v196, v200, v201
  v_cvt_pk_bf16_f32 v220, v224, v225
  v_cvt_pk_bf16_f32 v244, v248, v249
  v_cvt_pk_bf16_f32 v76, v80, v81
  v_cvt_pk_bf16_f32 v101, v106, v107
  v_cvt_pk_bf16_f32 v125, v130, v131
  v_cvt_pk_bf16_f32 v149, v154, v155
  v_cvt_pk_bf16_f32 v173, v178, v179
  v_cvt_pk_bf16_f32 v197, v202, v203
  v_cvt_pk_bf16_f32 v221, v226, v227
  v_cvt_pk_bf16_f32 v245, v250, v251
  v_cvt_pk_bf16_f32 v77, v82, v83
  v_cvt_pk_bf16_f32 v102, v108, v109
  v_cvt_pk_bf16_f32 v126, v132, v133
  v_cvt_pk_bf16_f32 v150, v156, v157
  v_cvt_pk_bf16_f32 v174, v180, v181
  v_cvt_pk_bf16_f32 v198, v204, v205
  v_cvt_pk_bf16_f32 v222, v228, v229
  v_cvt_pk_bf16_f32 v246, v252, v253
  v_cvt_pk_bf16_f32 v78, v84, v85
  v_cvt_pk_bf16_f32 v103, v110, v111
  v_cvt_pk_bf16_f32 v127, v134, v135
  v_cvt_pk_bf16_f32 v151, v158, v159
  v_cvt_pk_bf16_f32 v175, v182, v183
  v_cvt_pk_bf16_f32 v199, v206, v207
  v_cvt_pk_bf16_f32 v223, v230, v231
  v_cvt_pk_bf16_f32 v247, v254, v255
  v_cvt_pk_bf16_f32 v79, v86, v87
  s_cbranch_execz L_qkv_kernel_dm2
  v_mfma_f32_16x16x32_bf16 v[92:95], v[56:59], v[100:103], 0
  v_mfma_f32_16x16x32_bf16 v[116:119], v[56:59], v[124:127], 0
  v_mfma_f32_16x16x32_bf16 v[140:143], v[56:59], v[148:151], 0
  v_mfma_f32_16x16x32_bf16 v[164:167], v[56:59], v[172:175], 0
  v_mfma_f32_16x16x32_bf16 v[188:191], v[56:59], v[196:199], 0
  v_mfma_f32_16x16x32_bf16 v[212:215], v[56:59], v[220:223], 0
  v_mfma_f32_16x16x32_bf16 v[236:239], v[56:59], v[244:247], 0
  v_mfma_f32_16x16x32_bf16 v[68:71], v[56:59], v[76:79], 0
  v_mfma_f32_16x16x32_bf16 v[104:107], v[10:13], v[100:103], 0
  v_mfma_f32_16x16x32_bf16 v[128:131], v[12:15], v[124:127], 0
  v_mfma_f32_16x16x32_bf16 v[152:155], v[14:17], v[148:151], 0
  v_mfma_f32_16x16x32_bf16 v[176:179], v[16:19], v[172:175], 0
  v_mfma_f32_16x16x32_bf16 v[200:203], v[18:21], v[196:199], 0
  v_mfma_f32_16x16x32_bf16 v[224:227], v[20:23], v[220:223], 0
  v_mfma_f32_16x16x32_bf16 v[248:251], v[22:25], v[244:247], 0
  v_mfma_f32_16x16x32_bf16 v[80:83], v[8:11], v[76:79], 0
  v_mfma_f32_16x16x32_bf16 v[108:111], v[28:31], v[100:103], 0
  v_mfma_f32_16x16x32_bf16 v[132:135], v[30:33], v[124:127], 0
  v_mfma_f32_16x16x32_bf16 v[156:159], v[32:35], v[148:151], 0
  v_mfma_f32_16x16x32_bf16 v[180:183], v[34:37], v[172:175], 0
  v_mfma_f32_16x16x32_bf16 v[204:207], v[36:39], v[196:199], 0
  v_mfma_f32_16x16x32_bf16 v[228:231], v[38:41], v[220:223], 0
  v_mfma_f32_16x16x32_bf16 v[252:255], v[40:43], v[244:247], 0
  v_mfma_f32_16x16x32_bf16 v[84:87], v[26:29], v[76:79], 0
L_qkv_kernel_dm2:
  v_rcp_f32 v92, v92
  v_rcp_f32 v116, v116
  v_rcp_f32 v140, v140
  v_rcp_f32 v164, v164
  v_rcp_f32 v188, v188
  v_rcp_f32 v212, v212
  v_rcp_f32 v236, v236
  v_rcp_f32 v68, v68
  s_cbranch_execz L_qkv_kernel_dryret
L_qkv_kernel_d3:
  v_pk_mul_f32 v[104:105], v[104:105], v[92:93] op_sel_hi:[1,0]
  v_pk_mul_f32 v[128:129], v[128:129], v[116:117] op_sel_hi:[1,0]
  v_pk_mul_f32 v[152:153], v[152:153], v[140:141] op_sel_hi:[1,0]
  v_pk_mul_f32 v[176:177], v[176:177], v[164:165] op_sel_hi:[1,0]
  v_pk_mul_f32 v[200:201], v[200:201], v[188:189] op_sel_hi:[1,0]
  v_pk_mul_f32 v[224:225], v[224:225], v[212:213] op_sel_hi:[1,0]
  v_pk_mul_f32 v[248:249], v[248:249], v[236:237] op_sel_hi:[1,0]
  v_pk_mul_f32 v[80:81], v[80:81], v[68:69] op_sel_hi:[1,0]
  v_pk_mul_f32 v[106:107], v[106:107], v[92:93] op_sel_hi:[1,0]
  v_pk_mul_f32 v[130:131], v[130:131], v[116:117] op_sel_hi:[1,0]
  v_pk_mul_f32 v[154:155], v[154:155], v[140:141] op_sel_hi:[1,0]
  v_pk_mul_f32 v[178:179], v[178:179], v[164:165] op_sel_hi:[1,0]
  v_pk_mul_f32 v[202:203], v[202:203], v[188:189] op_sel_hi:[1,0]
  v_pk_mul_f32 v[226:227], v[226:227], v[212:213] op_sel_hi:[1,0]
  v_pk_mul_f32 v[250:251], v[250:251], v[236:237] op_sel_hi:[1,0]
  v_pk_mul_f32 v[82:83], v[82:83], v[68:69] op_sel_hi:[1,0]
  v_pk_mul_f32 v[108:109], v[108:109], v[92:93] op_sel_hi:[1,0]
  v_pk_mul_f32 v[132:133], v[132:133], v[116:117] op_sel_hi:[1,0]
  v_pk_mul_f32 v[156:157], v[156:157], v[140:141] op_sel_hi:[1,0]
  v_pk_mul_f32 v[180:181], v[180:181], v[164:165] op_sel_hi:[1,0]
  v_pk_mul_f32 v[204:205], v[204:205], v[188:189] op_sel_hi:[1,0]
  v_pk_mul_f32 v[228:229], v[228:229], v[212:213] op_sel_hi:[1,0]
  v_pk_mul_f32 v[252:253], v[252:253], v[236:237] op_sel_hi:[1,0]
  v_pk_mul_f32 v[84:85], v[84:85], v[68:69] op_sel_hi:[1,0]
  v_pk_mul_f32 v[110:111], v[110:111], v[92:93] op_sel_hi:[1,0]
  v_pk_mul_f32 v[134:135], v[134:135], v[116:117] op_sel_hi:[1,0]
  v_pk_mul_f32 v[158:159], v[158:159], v[140:141] op_sel_hi:[1,0]
  v_pk_mul_f32 v[182:183], v[182:183], v[164:165] op_sel_hi:[1,0]
  v_pk_mul_f32 v[206:207], v[206:207], v[188:189] op_sel_hi:[1,0]
  v_pk_mul_f32 v[230:231], v[230:231], v[212:213] op_sel_hi:[1,0]
  v_pk_mul_f32 v[254:255], v[254:255], v[236:237] op_sel_hi:[1,0]
  v_pk_mul_f32 v[86:87], v[86:87], v[68:69] op_sel_hi:[1,0]
  v_cvt_pk_bf16_f32 v88, v104, v105
  v_cvt_pk_bf16_f32 v112, v128, v129
  v_cvt_pk_bf16_f32 v136, v152, v153
  v_cvt_pk_bf16_f32 v160, v176, v177
  v_cvt_pk_bf16_f32 v184, v200, v201
  v_cvt_pk_bf16_f32 v208, v224, v225
  v_cvt_pk_bf16_f32 v232, v248, v249
  v_cvt_pk_bf16_f32 v64, v80, v81
  v_cvt_pk_bf16_f32 v89, v106, v107
  v_cvt_pk_bf16_f32 v113, v130, v131
  v_cvt_pk_bf16_f32 v137, v154, v155
  v_cvt_pk_bf16_f32 v161, v178, v179
  v_cvt_pk_bf16_f32 v185, v202, v203
  v_cvt_pk_bf16_f32 v209, v226, v227
  v_cvt_pk_bf16_f32 v233, v250, v251
  v_cvt_pk_bf16_f32 v65, v82, v83
  v_cvt_pk_bf16_f32 v90, v108, v109
  v_cvt_pk_bf16_f32 v114, v132, v133
  v_cvt_pk_bf16_f32 v138, v156, v157
  v_cvt_pk_bf16_f32 v162, v180, v181
  v_cvt_pk_bf16_f32 v186, v204, v205
  v_cvt_pk_bf16_f32 v210, v228, v229
  v_cvt_pk_bf16_f32 v234, v252, v253
  v_cvt_pk_bf16_f32 v66, v84, v85
  v_cvt_pk_bf16_f32 v91, v110, v111
  v_cvt_pk_bf16_f32 v115, v134, v135
  v_cvt_pk_bf16_f32 v139, v158, v159
  v_cvt_pk_bf16_f32 v163, v182, v183
  v_cvt_pk_bf16_f32 v187, v206, v207
  v_cvt_pk_bf16_f32 v211, v230, v231
  v_cvt_pk_bf16_f32 v235, v254, v255
  v_cvt_pk_bf16_f32 v67, v86, v87
  v_permlane32_swap_b32 v88, v90
  v_permlane32_swap_b32 v112, v114
  v_permlane32_swap_b32 v136, v138
  v_permlane32_swap_b32 v160, v162
  v_permlane32_swap_b32 v184, v186
  v_permlane32_swap_b32 v208, v210
  v_permlane32_swap_b32 v232, v234
  v_permlane32_swap_b32 v64, v66
  v_permlane32_swap_b32 v89, v91
  v_permlane32_swap_b32 v113, v115
  v_permlane32_swap_b32 v137, v139
  v_permlane32_swap_b32 v161, v163
  v_permlane32_swap_b32 v185, v187
  v_permlane32_swap_b32 v209, v211
  v_permlane32_swap_b32 v233, v235
  v_permlane32_swap_b32 v65, v67
  s_cbranch_execz L_qkv_kernel_dryret
  s_add_u32 s52, s53, 0
  buffer_store_dwordx4 v[88:91], v6, s[16:19], s52 offen offset:256 sc1
  s_add_u32 s52, s53, 131072
  buffer_store_dwordx4 v[112:115], v6, s[16:19], s52 offen sc1
  s_add_u32 s52, s53, 131072
  buffer_store_dwordx4 v[136:139], v6, s[16:19], s52 offen offset:256 sc1
  s_add_u32 s52, s53, 262144
  buffer_store_dwordx4 v[160:163], v6, s[16:19], s52 offen sc1
  s_add_u32 s52, s53, 262144
  buffer_store_dwordx4 v[184:187], v6, s[16:19], s52 offen offset:256 sc1
  s_add_u32 s52, s53, 393216
  buffer_store_dwordx4 v[208:211], v6, s[16:19], s52 offen sc1
  s_add_u32 s52, s53, 393216
  buffer_store_dwordx4 v[232:235], v6, s[16:19], s52 offen offset:256 sc1
  s_cmp_eq_u32 s21, 0
  s_cbranch_scc1 L_qkv_kernel_bend
  s_add_u32 s52, s53, 0
  buffer_store_dwordx4 v[64:67], v6, s[16:19], s52 offen sc1
L_qkv_kernel_bend:
  s_endpgm
L_qkv_kernel_xl:
  s_sub_u32 s21, s20, 4
  s_lshl_b32 s48, s23, 8
  s_lshl_b32 s49, s21, 7
  s_add_u32 s48, s48, s49
  v_lshrrev_b32 v2, 3, v1
  v_add_u32 v2, s48, v2
  v_lshlrev_b32 v2, 11, v2
  v_and_b32 v3, 7, v1
  v_lshrrev_b32 v4, 4, v1
  v_xor_b32 v3, v3, v4
  v_lshlrev_b32 v3, 4, v3
  v_add_u32 v4, v2, v3
  v_xor_b32 v3, 64, v3
  v_add_u32 v5, v2, v3
  s_lshl_b32 s29, s21, 14
  v_add_u32 v8, 0, v4
  v_add_u32 v9, 15360, v5
  v_add_u32 v10, 30720, v4
  v_add_u32 v11, 46080, v5
  v_add_u32 v12, 65536, v4
  v_add_u32 v13, 80896, v5
  v_add_u32 v14, 96256, v4
  v_add_u32 v15, 111616, v5
  v_add_u32 v16, 131072, v4
  v_add_u32 v17, 146432, v5
  v_add_u32 v18, 161792, v4
  v_add_u32 v19, 177152, v5
  v_add_u32 v20, 196608, v4
  v_add_u32 v21, 211968, v5
  v_add_u32 v22, 227328, v4
  v_add_u32 v23, 242688, v5
  s_lshl_b32 s48, s21, 6
  v_add_u32 v29, s48, v1
  s_lshl_b32 s48, s23, 8
  s_lshr_b32 s49, s2, 6
  s_lshl_b32 s49, s49, 6
  s_add_u32 s48, s48, s49
  v_add_u32 v2, s48, v1
  v_lshlrev_b32 v2, 11, v2
  v_mov_b32 v6, 0x7f000000
  v_cmp_gt_u32 vcc, 64, v1
  s_nop 1
  v_cndmask_b32 v2, v6, v2, vcc
  v_mul_u32_u24 v3, 0x5556, v1
  v_lshrrev_b32 v3, 16, v3
  v_mul_u32_u24 v4, 3, v3
  v_sub_u32 v4, v1, v4
  s_lshl_b32 s48, s23, 3
  v_add_u32 v3, s48, v3
  v_mul_u32_u24 v3, 6144, v3
  v_lshlrev_b32 v4, 11, v4
  s_lshl_b32 s48, s24, 7
  v_add3_u32 v3, v3, v4, s48
  v_cmp_gt_u32 vcc, 24, v1
  s_nop 1
  v_cndmask_b32 v3, v6, v3, vcc
  s_waitcnt lgkmcnt(0)
  s_cmp_eq_u32 s25, 0
  s_cselect_b32 s6, s6, s38
  s_cselect_b32 s7, s7, s39
  s_mov_b32 s8, s4
  s_and_b32 s9, s5, 0xffff
  s_mov_b32 s10, 0x400000
  s_mov_b32 s11, 0x20000
  s_mov_b32 s12, s6
  s_and_b32 s13, s7, 0xffff
  s_mov_b32 s14, 0x600000
  s_mov_b32 s15, 0x20000
  s_mov_b32 s16, s34
  s_and_b32 s17, s35, 0xffff
  s_mov_b32 s18, 0x3000000
  s_mov_b32 s19, 0x20000
  s_cmp_eq_u32 s21, 0
  s_cselect_b32 s52, s8, s12
  s_cselect_b32 s53, s9, s13
  s_cselect_b32 s54, s10, s14
  s_mov_b32 s55, 0x20000
  s_mov_b32 s56, 128
  s_cselect_b32 s56, s56, 393216
  s_cselect_b64 vcc, -1, 0
  v_cndmask_b32 v24, v3, v2, vcc
  s_mul_i32 s57, s56, 0
  buffer_load_dword v25, v24, s[52:55], s57 offen
  s_mul_i32 s57, s56, 1
  buffer_load_dword v25, v24, s[52:55], s57 offen
  s_mul_i32 s57, s56, 2
  buffer_load_dword v25, v24, s[52:55], s57 offen
  s_movk_i32 s28, 0
  s_add_u32 m0, s29, 0
  s_nop 0
  buffer_load_dwordx4 v8, s[8:11], s28 offen lds
  buffer_load_dwordx4 v9, s[8:11], s28 offen offset:1024 lds
  buffer_load_dwordx4 v10, s[8:11], s28 offen offset:2048 lds
  buffer_load_dwordx4 v11, s[8:11], s28 offen offset:3072 lds
  s_add_u32 m0, s29, 4096
  s_nop 0
  buffer_load_dwordx4 v12, s[8:11], s28 offen lds
  buffer_load_dwordx4 v13, s[8:11], s28 offen offset:1024 lds
  buffer_load_dwordx4 v14, s[8:11], s28 offen offset:2048 lds
  buffer_load_dwordx4 v15, s[8:11], s28 offen offset:3072 lds
  s_add_u32 m0, s29, 8192
  s_nop 0
  buffer_load_dwordx4 v16, s[8:11], s28 offen lds
  buffer_load_dwordx4 v17, s[8:11], s28 offen offset:1024 lds
  buffer_load_dwordx4 v18, s[8:11], s28 offen offset:2048 lds
  buffer_load_dwordx4 v19, s[8:11], s28 offen offset:3072 lds
  s_add_u32 m0, s29, 12288
  s_nop 0
  buffer_load_dwordx4 v20, s[8:11], s28 offen lds
  buffer_load_dwordx4 v21, s[8:11], s28 offen offset:1024 lds
  buffer_load_dwordx4 v22, s[8:11], s28 offen offset:2048 lds
  buffer_load_dwordx4 v23, s[8:11], s28 offen offset:3072 lds
  s_mul_i32 s57, s56, 1
  buffer_load_dword v25, v24, s[52:55], s57 offen
  s_movk_i32 s28, 128
  s_add_u32 m0, s29, 32768
  s_nop 0
  buffer_load_dwordx4 v8, s[8:11], s28 offen lds
  buffer_load_dwordx4 v9, s[8:11], s28 offen offset:1024 lds
  buffer_load_dwordx4 v10, s[8:11], s28 offen offset:2048 lds
  buffer_load_dwordx4 v11, s[8:11], s28 offen offset:3072 lds
  s_add_u32 m0, s29, 36864
  s_nop 0
  buffer_load_dwordx4 v12, s[8:11], s28 offen lds
  buffer_load_dwordx4 v13, s[8:11], s28 offen offset:1024 lds
  buffer_load_dwordx4 v14, s[8:11], s28 offen offset:2048 lds
  buffer_load_dwordx4 v15, s[8:11], s28 offen offset:3072 lds
  s_add_u32 m0, s29, 40960
  s_nop 0
  buffer_load_dwordx4 v16, s[8:11], s28 offen lds
  buffer_load_dwordx4 v17, s[8:11], s28 offen offset:1024 lds
  buffer_load_dwordx4 v18, s[8:11], s28 offen offset:2048 lds
  buffer_load_dwordx4 v19, s[8:11], s28 offen offset:3072 lds
  s_add_u32 m0, s29, 45056
  s_nop 0
  buffer_load_dwordx4 v20, s[8:11], s28 offen lds
  buffer_load_dwordx4 v21, s[8:11], s28 offen offset:1024 lds
  buffer_load_dwordx4 v22, s[8:11], s28 offen offset:2048 lds
  buffer_load_dwordx4 v23, s[8:11], s28 offen offset:3072 lds
  s_mul_i32 s57, s56, 2
  buffer_load_dword v25, v24, s[52:55], s57 offen
  s_mov_b32 s43, 2097152
  buffer_load_dword v28, off, s[12:15], s43
  s_mov_b32 s43, 4194304
  buffer_load_dword v28, off, s[12:15], s43
  s_mov_b32 s43, 6291452
  buffer_load_dword v28, off, s[12:15], s43
  s_waitcnt vmcnt(21)
  s_barrier
  s_movk_i32 s28, 256
  s_add_u32 m0, s29, 65536
  s_nop 0
  buffer_load_dwordx4 v8, s[8:11], s28 offen lds
  buffer_load_dwordx4 v9, s[8:11], s28 offen offset:1024 lds
  buffer_load_dwordx4 v10, s[8:11], s28 offen offset:2048 lds
  buffer_load_dwordx4 v11, s[8:11], s28 offen offset:3072 lds
  s_add_u32 m0, s29, 69632
  s_nop 0
  buffer_load_dwordx4 v12, s[8:11], s28 offen lds
  buffer_load_dwordx4 v13, s[8:11], s28 offen offset:1024 lds
  buffer_load_dwordx4 v14, s[8:11], s28 offen offset:2048 lds
  buffer_load_dwordx4 v15, s[8:11], s28 offen offset:3072 lds
  s_add_u32 m0, s29, 73728
  s_nop 0
  buffer_load_dwordx4 v16, s[8:11], s28 offen lds
  buffer_load_dwordx4 v17, s[8:11], s28 offen offset:1024 lds
  buffer_load_dwordx4 v18, s[8:11], s28 offen offset:2048 lds
  buffer_load_dwordx4 v19, s[8:11], s28 offen offset:3072 lds
  s_add_u32 m0, s29, 77824
  s_nop 0
  buffer_load_dwordx4 v20, s[8:11], s28 offen lds
  buffer_load_dwordx4 v21, s[8:11], s28 offen offset:1024 lds
  buffer_load_dwordx4 v22, s[8:11], s28 offen offset:2048 lds
  buffer_load_dwordx4 v23, s[8:11], s28 offen offset:3072 lds
  s_mul_i32 s57, s56, 3
  buffer_load_dword v25, v24, s[52:55], s57 offen
  s_barrier
  s_waitcnt vmcnt(21)
  s_barrier
  s_movk_i32 s28, 384
  s_add_u32 m0, s29, 0
  s_nop 0
  buffer_load_dwordx4 v8, s[8:11], s28 offen lds
  buffer_load_dwordx4 v9, s[8:11], s28 offen offset:1024 lds
  buffer_load_dwordx4 v10, s[8:11], s28 offen offset:2048 lds
  buffer_load_dwordx4 v11, s[8:11], s28 offen offset:3072 lds
  s_add_u32 m0, s29, 4096
  s_nop 0
  buffer_load_dwordx4 v12, s[8:11], s28 offen lds
  buffer_load_dwordx4 v13, s[8:11], s28 offen offset:1024 lds
  buffer_load_dwordx4 v14, s[8:11], s28 offen offset:2048 lds
  buffer_load_dwordx4 v15, s[8:11], s28 offen offset:3072 lds
  s_add_u32 m0, s29, 8192
  s_nop 0
  buffer_load_dwordx4 v16, s[8:11], s28 offen lds
  buffer_load_dwordx4 v17, s[8:11], s28 offen offset:1024 lds
  buffer_load_dwordx4 v18, s[8:11], s28 offen offset:2048 lds
  buffer_load_dwordx4 v19, s[8:11], s28 offen offset:3072 lds
  s_add_u32 m0, s29, 12288
  s_nop 0
  buffer_load_dwordx4 v20, s[8:11], s28 offen lds
  buffer_load_dwordx4 v21, s[8:11], s28 offen offset:1024 lds
  buffer_load_dwordx4 v22, s[8:11], s28 offen offset:2048 lds
  buffer_load_dwordx4 v23, s[8:11], s28 offen offset:3072 lds
  s_mul_i32 s57, s56, 4
  buffer_load_dword v25, v24, s[52:55], s57 offen
  s_barrier
  s_waitcnt vmcnt(18)
  s_barrier
  s_movk_i32 s28, 512
  s_add_u32 m0, s29, 32768
  s_nop 0
  buffer_load_dwordx4 v8, s[8:11], s28 offen lds
  buffer_load_dwordx4 v9, s[8:11], s28 offen offset:1024 lds
  buffer_load_dwordx4 v10, s[8:11], s28 offen offset:2048 lds
  buffer_load_dwordx4 v11, s[8:11], s28 offen offset:3072 lds
  s_add_u32 m0, s29, 36864
  s_nop 0
  buffer_load_dwordx4 v12, s[8:11], s28 offen lds
  buffer_load_dwordx4 v13, s[8:11], s28 offen offset:1024 lds
  buffer_load_dwordx4 v14, s[8:11], s28 offen offset:2048 lds
  buffer_load_dwordx4 v15, s[8:11], s28 offen offset:3072 lds
  s_add_u32 m0, s29, 40960
  s_nop 0
  buffer_load_dwordx4 v16, s[8:11], s28 offen lds
  buffer_load_dwordx4 v17, s[8:11], s28 offen offset:1024 lds
  buffer_load_dwordx4 v18, s[8:11], s28 offen offset:2048 lds
  buffer_load_dwordx4 v19, s[8:11], s28 offen offset:3072 lds
  s_add_u32 m0, s29, 45056
  s_nop 0
  buffer_load_dwordx4 v20, s[8:11], s28 offen lds
  buffer_load_dwordx4 v21, s[8:11], s28 offen offset:1024 lds
  buffer_load_dwordx4 v22, s[8:11], s28 offen offset:2048 lds
  buffer_load_dwordx4 v23, s[8:11], s28 offen offset:3072 lds
  s_mul_i32 s57, s56, 5
  buffer_load_dword v25, v24, s[52:55], s57 offen
  s_barrier
  s_waitcnt vmcnt(18)
  s_barrier
  s_movk_i32 s28, 640
  s_add_u32 m0, s29, 65536
  s_nop 0
  buffer_load_dwordx4 v8, s[8:11], s28 offen lds
  buffer_load_dwordx4 v9, s[8:11], s28 offen offset:1024 lds
  buffer_load_dwordx4 v10, s[8:11], s28 offen offset:2048 lds
  buffer_load_dwordx4 v11, s[8:11], s28 offen offset:3072 lds
  s_add_u32 m0, s29, 69632
  s_nop 0
  buffer_load_dwordx4 v12, s[8:11], s28 offen lds
  buffer_load_dwordx4 v13, s[8:11], s28 offen offset:1024 lds
  buffer_load_dwordx4 v14, s[8:11], s28 offen offset:2048 lds
  buffer_load_dwordx4 v15, s[8:11], s28 offen offset:3072 lds
  s_add_u32 m0, s29, 73728
  s_nop 0
  buffer_load_dwordx4 v16, s[8:11], s28 offen lds
  buffer_load_dwordx4 v17, s[8:11], s28 offen offset:1024 lds
  buffer_load_dwordx4 v18, s[8:11], s28 offen offset:2048 lds
  buffer_load_dwordx4 v19, s[8:11], s28 offen offset:3072 lds
  s_add_u32 m0, s29, 77824
  s_nop 0
  buffer_load_dwordx4 v20, s[8:11], s28 offen lds
  buffer_load_dwordx4 v21, s[8:11], s28 offen offset:1024 lds
  buffer_load_dwordx4 v22, s[8:11], s28 offen offset:2048 lds
  buffer_load_dwordx4 v23, s[8:11], s28 offen offset:3072 lds
  s_mul_i32 s57, s56, 6
  buffer_load_dword v25, v24, s[52:55], s57 offen
  s_barrier
  s_waitcnt vmcnt(18)
  s_barrier
  s_movk_i32 s28, 768
  s_add_u32 m0, s29, 0
  s_nop 0
  buffer_load_dwordx4 v8, s[8:11], s28 offen lds
  buffer_load_dwordx4 v9, s[8:11], s28 offen offset:1024 lds
  buffer_load_dwordx4 v10, s[8:11], s28 offen offset:2048 lds
  buffer_load_dwordx4 v11, s[8:11], s28 offen offset:3072 lds
  s_add_u32 m0, s29, 4096
  s_nop 0
  buffer_load_dwordx4 v12, s[8:11], s28 offen lds
  buffer_load_dwordx4 v13, s[8:11], s28 offen offset:1024 lds
  buffer_load_dwordx4 v14, s[8:11], s28 offen offset:2048 lds
  buffer_load_dwordx4 v15, s[8:11], s28 offen offset:3072 lds
  s_add_u32 m0, s29, 8192
  s_nop 0
  buffer_load_dwordx4 v16, s[8:11], s28 offen lds
  buffer_load_dwordx4 v17, s[8:11], s28 offen offset:1024 lds
  buffer_load_dwordx4 v18, s[8:11], s28 offen offset:2048 lds
  buffer_load_dwordx4 v19, s[8:11], s28 offen offset:3072 lds
  s_add_u32 m0, s29, 12288
  s_nop 0
  buffer_load_dwordx4 v20, s[8:11], s28 offen lds
  buffer_load_dwordx4 v21, s[8:11], s28 offen offset:1024 lds
  buffer_load_dwordx4 v22, s[8:11], s28 offen offset:2048 lds
  buffer_load_dwordx4 v23, s[8:11], s28 offen offset:3072 lds
  s_mul_i32 s57, s56, 7
  buffer_load_dword v25, v24, s[52:55], s57 offen
  s_barrier
  s_waitcnt vmcnt(18)
  s_barrier
  s_movk_i32 s28, 896
  s_add_u32 m0, s29, 32768
  s_nop 0
  buffer_load_dwordx4 v8, s[8:11], s28 offen lds
  buffer_load_dwordx4 v9, s[8:11], s28 offen offset:1024 lds
  buffer_load_dwordx4 v10, s[8:11], s28 offen offset:2048 lds
  buffer_load_dwordx4 v11, s[8:11], s28 offen offset:3072 lds
  s_add_u32 m0, s29, 36864
  s_nop 0
  buffer_load_dwordx4 v12, s[8:11], s28 offen lds
  buffer_load_dwordx4 v13, s[8:11], s28 offen offset:1024 lds
  buffer_load_dwordx4 v14, s[8:11], s28 offen offset:2048 lds
  buffer_load_dwordx4 v15, s[8:11], s28 offen offset:3072 lds
  s_add_u32 m0, s29, 40960
  s_nop 0
  buffer_load_dwordx4 v16, s[8:11], s28 offen lds
  buffer_load_dwordx4 v17, s[8:11], s28 offen offset:1024 lds
  buffer_load_dwordx4 v18, s[8:11], s28 offen offset:2048 lds
  buffer_load_dwordx4 v19, s[8:11], s28 offen offset:3072 lds
  s_add_u32 m0, s29, 45056
  s_nop 0
  buffer_load_dwordx4 v20, s[8:11], s28 offen lds
  buffer_load_dwordx4 v21, s[8:11], s28 offen offset:1024 lds
  buffer_load_dwordx4 v22, s[8:11], s28 offen offset:2048 lds
  buffer_load_dwordx4 v23, s[8:11], s28 offen offset:3072 lds
  s_mul_i32 s57, s56, 8
  buffer_load_dword v25, v24, s[52:55], s57 offen
  s_barrier
  s_waitcnt vmcnt(18)
  s_barrier
  s_movk_i32 s28, 1024
  s_add_u32 m0, s29, 65536
  s_nop 0
  buffer_load_dwordx4 v8, s[8:11], s28 offen lds
  buffer_load_dwordx4 v9, s[8:11], s28 offen offset:1024 lds
  buffer_load_dwordx4 v10, s[8:11], s28 offen offset:2048 lds
  buffer_load_dwordx4 v11, s[8:11], s28 offen offset:3072 lds
  s_add_u32 m0, s29, 69632
  s_nop 0
  buffer_load_dwordx4 v12, s[8:11], s28 offen lds
  buffer_load_dwordx4 v13, s[8:11], s28 offen offset:1024 lds
  buffer_load_dwordx4 v14, s[8:11], s28 offen offset:2048 lds
  buffer_load_dwordx4 v15, s[8:11], s28 offen offset:3072 lds
  s_add_u32 m0, s29, 73728
  s_nop 0
  buffer_load_dwordx4 v16, s[8:11], s28 offen lds
  buffer_load_dwordx4 v17, s[8:11], s28 offen offset:1024 lds
  buffer_load_dwordx4 v18, s[8:11], s28 offen offset:2048 lds
  buffer_load_dwordx4 v19, s[8:11], s28 offen offset:3072 lds
  s_add_u32 m0, s29, 77824
  s_nop 0
  buffer_load_dwordx4 v20, s[8:11], s28 offen lds
  buffer_load_dwordx4 v21, s[8:11], s28 offen offset:1024 lds
  buffer_load_dwordx4 v22, s[8:11], s28 offen offset:2048 lds
  buffer_load_dwordx4 v23, s[8:11], s28 offen offset:3072 lds
  s_mul_i32 s57, s56, 9
  buffer_load_dword v25, v24, s[52:55], s57 offen
  s_barrier
  s_waitcnt vmcnt(18)
  s_barrier
  s_movk_i32 s28, 1152
  s_add_u32 m0, s29, 0
  s_nop 0
  buffer_load_dwordx4 v8, s[8:11], s28 offen lds
  buffer_load_dwordx4 v9, s[8:11], s28 offen offset:1024 lds
  buffer_load_dwordx4 v10, s[8:11], s28 offen offset:2048 lds
  buffer_load_dwordx4 v11, s[8:11], s28 offen offset:3072 lds
  s_add_u32 m0, s29, 4096
  s_nop 0
  buffer_load_dwordx4 v12, s[8:11], s28 offen lds
  buffer_load_dwordx4 v13, s[8:11], s28 offen offset:1024 lds
  buffer_load_dwordx4 v14, s[8:11], s28 offen offset:2048 lds
  buffer_load_dwordx4 v15, s[8:11], s28 offen offset:3072 lds
  s_add_u32 m0, s29, 8192
  s_nop 0
  buffer_load_dwordx4 v16, s[8:11], s28 offen lds
  buffer_load_dwordx4 v17, s[8:11], s28 offen offset:1024 lds
  buffer_load_dwordx4 v18, s[8:11], s28 offen offset:2048 lds
  buffer_load_dwordx4 v19, s[8:11], s28 offen offset:3072 lds
  s_add_u32 m0, s29, 12288
  s_nop 0
  buffer_load_dwordx4 v20, s[8:11], s28 offen lds
  buffer_load_dwordx4 v21, s[8:11], s28 offen offset:1024 lds
  buffer_load_dwordx4 v22, s[8:11], s28 offen offset:2048 lds
  buffer_load_dwordx4 v23, s[8:11], s28 offen offset:3072 lds
  s_mul_i32 s57, s56, 10
  buffer_load_dword v25, v24, s[52:55], s57 offen
  s_barrier
  s_waitcnt vmcnt(18)
  s_barrier
  s_movk_i32 s28, 1280
  s_add_u32 m0, s29, 32768
  s_nop 0
  buffer_load_dwordx4 v8, s[8:11], s28 offen lds
  buffer_load_dwordx4 v9, s[8:11], s28 offen offset:1024 lds
  buffer_load_dwordx4 v10, s[8:11], s28 offen offset:2048 lds
  buffer_load_dwordx4 v11, s[8:11], s28 offen offset:3072 lds
  s_add_u32 m0, s29, 36864
  s_nop 0
  buffer_load_dwordx4 v12, s[8:11], s28 offen lds
  buffer_load_dwordx4 v13, s[8:11], s28 offen offset:1024 lds
  buffer_load_dwordx4 v14, s[8:11], s28 offen offset:2048 lds
  buffer_load_dwordx4 v15, s[8:11], s28 offen offset:3072 lds
  s_add_u32 m0, s29, 40960
  s_nop 0
  buffer_load_dwordx4 v16, s[8:11], s28 offen lds
  buffer_load_dwordx4 v17, s[8:11], s28 offen offset:1024 lds
  buffer_load_dwordx4 v18, s[8:11], s28 offen offset:2048 lds
  buffer_load_dwordx4 v19, s[8:11], s28 offen offset:3072 lds
  s_add_u32 m0, s29, 45056
  s_nop 0
  buffer_load_dwordx4 v20, s[8:11], s28 offen lds
  buffer_load_dwordx4 v21, s[8:11], s28 offen offset:1024 lds
  buffer_load_dwordx4 v22, s[8:11], s28 offen offset:2048 lds
  buffer_load_dwordx4 v23, s[8:11], s28 offen offset:3072 lds
  s_mul_i32 s57, s56, 11
  buffer_load_dword v25, v24, s[52:55], s57 offen
  s_mul_i32 s44, s24, 262144
  s_lshl_b32 s45, s23, 14
  s_add_u32 s44, s44, s45
  s_add_u32 s45, s44, 4194304
  s_add_u32 s46, s44, 8388608
  s_lshl_b32 s47, s23, 20
  s_lshl_b32 s43, s24, 12
  s_add_u32 s47, s47, s43
  s_add_u32 s47, s47, 25231360
  s_mul_i32 s43, s24, 81920
  s_add_u32 s43, s43, 34603008
  s_cmp_eq_u32 s25, 0
  s_cselect_b32 s44, s44, s47
  s_cselect_b32 s45, s45, s43
  s_cselect_b32 s46, s46, 33554432
  buffer_load_dword v28, off, s[16:19], s44
  buffer_load_dword v28, off, s[16:19], s45
  buffer_load_dword v28, off, s[16:19], s46
  s_barrier
  s_waitcnt vmcnt(21)
  s_barrier
  s_movk_i32 s28, 1408
  s_add_u32 m0, s29, 65536
  s_nop 0
  buffer_load_dwordx4 v8, s[8:11], s28 offen lds
  buffer_load_dwordx4 v9, s[8:11], s28 offen offset:1024 lds
  buffer_load_dwordx4 v10, s[8:11], s28 offen offset:2048 lds
  buffer_load_dwordx4 v11, s[8:11], s28 offen offset:3072 lds
  s_add_u32 m0, s29, 69632
  s_nop 0
  buffer_load_dwordx4 v12, s[8:11], s28 offen lds
  buffer_load_dwordx4 v13, s[8:11], s28 offen offset:1024 lds
  buffer_load_dwordx4 v14, s[8:11], s28 offen offset:2048 lds
  buffer_load_dwordx4 v15, s[8:11], s28 offen offset:3072 lds
  s_add_u32 m0, s29, 73728
  s_nop 0
  buffer_load_dwordx4 v16, s[8:11], s28 offen lds
  buffer_load_dwordx4 v17, s[8:11], s28 offen offset:1024 lds
  buffer_load_dwordx4 v18, s[8:11], s28 offen offset:2048 lds
  buffer_load_dwordx4 v19, s[8:11], s28 offen offset:3072 lds
  s_add_u32 m0, s29, 77824
  s_nop 0
  buffer_load_dwordx4 v20, s[8:11], s28 offen lds
  buffer_load_dwordx4 v21, s[8:11], s28 offen offset:1024 lds
  buffer_load_dwordx4 v22, s[8:11], s28 offen offset:2048 lds
  buffer_load_dwordx4 v23, s[8:11], s28 offen offset:3072 lds
  s_mul_i32 s57, s56, 12
  buffer_load_dword v25, v24, s[52:55], s57 offen
  s_barrier
  s_waitcnt vmcnt(21)
  s_barrier
  s_movk_i32 s28, 1536
  s_add_u32 m0, s29, 0
  s_nop 0
  buffer_load_dwordx4 v8, s[8:11], s28 offen lds
  buffer_load_dwordx4 v9, s[8:11], s28 offen offset:1024 lds
  buffer_load_dwordx4 v10, s[8:11], s28 offen offset:2048 lds
  buffer_load_dwordx4 v11, s[8:11], s28 offen offset:3072 lds
  s_add_u32 m0, s29, 4096
  s_nop 0
  buffer_load_dwordx4 v12, s[8:11], s28 offen lds
  buffer_load_dwordx4 v13, s[8:11], s28 offen offset:1024 lds
  buffer_load_dwordx4 v14, s[8:11], s28 offen offset:2048 lds
  buffer_load_dwordx4 v15, s[8:11], s28 offen offset:3072 lds
  s_add_u32 m0, s29, 8192
  s_nop 0
  buffer_load_dwordx4 v16, s[8:11], s28 offen lds
  buffer_load_dwordx4 v17, s[8:11], s28 offen offset:1024 lds
  buffer_load_dwordx4 v18, s[8:11], s28 offen offset:2048 lds
  buffer_load_dwordx4 v19, s[8:11], s28 offen offset:3072 lds
  s_add_u32 m0, s29, 12288
  s_nop 0
  buffer_load_dwordx4 v20, s[8:11], s28 offen lds
  buffer_load_dwordx4 v21, s[8:11], s28 offen offset:1024 lds
  buffer_load_dwordx4 v22, s[8:11], s28 offen offset:2048 lds
  buffer_load_dwordx4 v23, s[8:11], s28 offen offset:3072 lds
  s_mul_i32 s57, s56, 13
  buffer_load_dword v25, v24, s[52:55], s57 offen
  s_barrier
  s_waitcnt vmcnt(18)
  s_barrier
  s_movk_i32 s28, 1664
  s_add_u32 m0, s29, 32768
  s_nop 0
  buffer_load_dwordx4 v8, s[8:11], s28 offen lds
  buffer_load_dwordx4 v9, s[8:11], s28 offen offset:1024 lds
  buffer_load_dwordx4 v10, s[8:11], s28 offen offset:2048 lds
  buffer_load_dwordx4 v11, s[8:11], s28 offen offset:3072 lds
  s_add_u32 m0, s29, 36864
  s_nop 0
  buffer_load_dwordx4 v12, s[8:11], s28 offen lds
  buffer_load_dwordx4 v13, s[8:11], s28 offen offset:1024 lds
  buffer_load_dwordx4 v14, s[8:11], s28 offen offset:2048 lds
  buffer_load_dwordx4 v15, s[8:11], s28 offen offset:3072 lds
  s_add_u32 m0, s29, 40960
  s_nop 0
  buffer_load_dwordx4 v16, s[8:11], s28 offen lds
  buffer_load_dwordx4 v17, s[8:11], s28 offen offset:1024 lds
  buffer_load_dwordx4 v18, s[8:11], s28 offen offset:2048 lds
  buffer_load_dwordx4 v19, s[8:11], s28 offen offset:3072 lds
  s_add_u32 m0, s29, 45056
  s_nop 0
  buffer_load_dwordx4 v20, s[8:11], s28 offen lds
  buffer_load_dwordx4 v21, s[8:11], s28 offen offset:1024 lds
  buffer_load_dwordx4 v22, s[8:11], s28 offen offset:2048 lds
  buffer_load_dwordx4 v23, s[8:11], s28 offen offset:3072 lds
  s_mul_i32 s57, s56, 14
  buffer_load_dword v25, v24, s[52:55], s57 offen
  s_getpc_b64 s[40:41]
L_qkv_kernel_pcx13_0:
  s_sub_u32 s40, s40, L_qkv_kernel_pcx13_0 - L_qkv_kernel_epi
  s_subb_u32 s41, s41, 0
  v_lshlrev_b32 v26, 7, v29
  v_min_u32 v26, L_qkv_kernel_xl - L_qkv_kernel_epi - 4, v26
  v_mov_b32 v27, s41
  v_add_co_u32 v26, vcc, s40, v26
  s_nop 1
  v_addc_co_u32 v27, vcc, 0, v27, vcc
  global_load_dword v28, v[26:27], off
  s_barrier
  s_waitcnt vmcnt(19)
  s_barrier
  s_movk_i32 s28, 1792
  s_add_u32 m0, s29, 65536
  s_nop 0
  buffer_load_dwordx4 v8, s[8:11], s28 offen lds
  buffer_load_dwordx4 v9, s[8:11], s28 offen offset:1024 lds
  buffer_load_dwordx4 v10, s[8:11], s28 offen offset:2048 lds
  buffer_load_dwordx4 v11, s[8:11], s28 offen offset:3072 lds
  s_add_u32 m0, s29, 69632
  s_nop 0
  buffer_load_dwordx4 v12, s[8:11], s28 offen lds
  buffer_load_dwordx4 v13, s[8:11], s28 offen offset:1024 lds
  buffer_load_dwordx4 v14, s[8:11], s28 offen offset:2048 lds
  buffer_load_dwordx4 v15, s[8:11], s28 offen offset:3072 lds
  s_add_u32 m0, s29, 73728
  s_nop 0
  buffer_load_dwordx4 v16, s[8:11], s28 offen lds
  buffer_load_dwordx4 v17, s[8:11], s28 offen offset:1024 lds
  buffer_load_dwordx4 v18, s[8:11], s28 offen offset:2048 lds
  buffer_load_dwordx4 v19, s[8:11], s28 offen offset:3072 lds
  s_add_u32 m0, s29, 77824
  s_nop 0
  buffer_load_dwordx4 v20, s[8:11], s28 offen lds
  buffer_load_dwordx4 v21, s[8:11], s28 offen offset:1024 lds
  buffer_load_dwordx4 v22, s[8:11], s28 offen offset:2048 lds
  buffer_load_dwordx4 v23, s[8:11], s28 offen offset:3072 lds
  s_mul_i32 s57, s56, 15
  buffer_load_dword v25, v24, s[52:55], s57 offen
  s_barrier
  s_waitcnt vmcnt(19)
  s_barrier
  s_movk_i32 s28, 1920
  s_add_u32 m0, s29, 0
  s_nop 0
  buffer_load_dwordx4 v8, s[8:11], s28 offen lds
  buffer_load_dwordx4 v9, s[8:11], s28 offen offset:1024 lds
  buffer_load_dwordx4 v10, s[8:11], s28 offen offset:2048 lds
  buffer_load_dwordx4 v11, s[8:11], s28 offen offset:3072 lds
  s_add_u32 m0, s29, 4096
  s_nop 0
  buffer_load_dwordx4 v12, s[8:11], s28 offen lds
  buffer_load_dwordx4 v13, s[8:11], s28 offen offset:1024 lds
  buffer_load_dwordx4 v14, s[8:11], s28 offen offset:2048 lds
  buffer_load_dwordx4 v15, s[8:11], s28 offen offset:3072 lds
  s_add_u32 m0, s29, 8192
  s_nop 0
  buffer_load_dwordx4 v16, s[8:11], s28 offen lds
  buffer_load_dwordx4 v17, s[8:11], s28 offen offset:1024 lds
  buffer_load_dwordx4 v18, s[8:11], s28 offen offset:2048 lds
  buffer_load_dwordx4 v19, s[8:11], s28 offen offset:3072 lds
  s_add_u32 m0, s29, 12288
  s_nop 0
  buffer_load_dwordx4 v20, s[8:11], s28 offen lds
  buffer_load_dwordx4 v21, s[8:11], s28 offen offset:1024 lds
  buffer_load_dwordx4 v22, s[8:11], s28 offen offset:2048 lds
  buffer_load_dwordx4 v23, s[8:11], s28 offen offset:3072 lds
  s_getpc_b64 s[40:41]
L_qkv_kernel_pcx15_0:
  s_add_u32 s40, s40, att_kernel - L_qkv_kernel_pcx15_0
  s_addc_u32 s41, s41, 0
  v_lshlrev_b32 v26, 7, v29
  v_min_u32 v26, L_att_kernel_t22 - att_kernel - 4, v26
  v_mov_b32 v27, s41
  v_add_co_u32 v26, vcc, s40, v26
  s_nop 1
  v_addc_co_u32 v27, vcc, 0, v27, vcc
  global_load_dword v28, v[26:27], off
  s_getpc_b64 s[40:41]
L_qkv_kernel_pcx15_1:
  s_add_u32 s40, s40, L_att_kernel_t22 - L_qkv_kernel_pcx15_1
  s_addc_u32 s41, s41, 0
  v_lshlrev_b32 v26, 7, v29
  v_min_u32 v26, L_att_kernel_slow - L_att_kernel_t22 - 4, v26
  v_mov_b32 v27, s41
  v_add_co_u32 v26, vcc, s40, v26
  s_nop 1
  v_addc_co_u32 v27, vcc, 0, v27, vcc
  global_load_dword v28, v[26:27], off
  s_barrier
  s_waitcnt vmcnt(19)
  s_barrier
  s_barrier
  s_waitcnt vmcnt(2)
  s_barrier
  s_barrier
  s_endpgm
L_qkv_kernel_wl:
  v_bfe_u32 v2, v1, 3, 2
  v_mul_u32_u24 v3, 6144, v2
  v_bfe_u32 v4, v1, 2, 1
  v_lshrrev_b32 v5, 1, v2
  v_xor_b32 v4, v4, v5
  v_lshlrev_b32 v4, 6, v4
  v_and_b32 v5, 3, v1
  v_lshlrev_b32 v5, 4, v5
  v_add3_u32 v3, v3, v4, v5
  s_lshl_b32 s48, s24, 7
  v_add_u32 v3, s48, v3
  v_lshrrev_b32 v4, 5, v1
  v_lshlrev_b32 v6, 5, v4
  v_xor_b32 v7, 32, v6
  v_mul_u32_u24 v5, 2048, v4
  v_add_u32 v5, 0, v5
  v_add_u32 v8, v5, v3
  v_mul_u32_u24 v5, 20480, v4
  v_add_u32 v5, 3072, v5
  v_add_u32 v9, v5, v3
  v_mul_u32_u24 v5, 2048, v4
  v_add_u32 v5, 24576, v5
  v_add_u32 v10, v5, v3
  v_mul_u32_u24 v5, 2048, v4
  v_add_u32 v5, 46080, v5
  v_add_u32 v11, v5, v3
  v_xor_b32 v11, 32, v11
  v_mul_u32_u24 v5, 20480, v4
  v_add_u32 v5, 53248, v5
  v_add_u32 v12, v5, v3
  v_xor_b32 v12, 32, v12
  v_mul_u32_u24 v5, 2048, v4
  v_add_u32 v5, 74752, v5
  v_add_u32 v13, v5, v3
  v_xor_b32 v13, 32, v13
  v_mul_u32_u24 v5, 2048, v4
  v_add_u32 v5, 96256, v5
  v_add_u32 v14, v5, v3
  v_mul_u32_u24 v5, 20480, v4
  v_add_u32 v5, 99328, v5
  v_add_u32 v15, v5, v3
  v_mul_u32_u24 v5, 2048, v4
  v_add_u32 v5, 124928, v5
  v_add_u32 v16, v5, v3
  v_mul_u32_u24 v5, 2048, v4
  v_add_u32 v5, 146432, v5
  v_add_u32 v17, v5, v3
  v_xor_b32 v17, 32, v17
  v_mul_u32_u24 v5, 20480, v4
  v_add_u32 v5, 149504, v5
  v_add_u32 v18, v5, v3
  v_xor_b32 v18, 32, v18
  v_mul_u32_u24 v5, 2048, v4
  v_add_u32 v5, 171008, v5
  v_add_u32 v19, v5, v3
  v_xor_b32 v19, 32, v19
  s_waitcnt lgkmcnt(0)
  s_cmp_eq_u32 s25, 0
  s_cselect_b32 s6, s6, s38
  s_cselect_b32 s7, s7, s39
  s_mov_b32 s8, s4
  s_and_b32 s9, s5, 0xffff
  s_mov_b32 s10, 0x400000
  s_mov_b32 s11, 0x20000
  s_mov_b32 s12, s6
  s_and_b32 s13, s7, 0xffff
  s_mov_b32 s14, 0x600000
  s_mov_b32 s15, 0x20000
  s_mov_b32 s16, s34
  s_and_b32 s17, s35, 0xffff
  s_mov_b32 s18, 0x3000000
  s_mov_b32 s19, 0x20000
  s_mov_b32 s28, 0
  s_mov_b32 m0, 98304
  s_nop 0
  buffer_load_dwordx4 v8, s[12:15], s28 offen lds
  buffer_load_dwordx4 v9, s[12:15], s28 offen offset:1024 lds
  buffer_load_dwordx4 v10, s[12:15], s28 offen offset:2048 lds
  buffer_load_dwordx4 v11, s[12:15], s28 offen offset:3072 lds
  s_mov_b32 m0, 102400
  s_nop 0
  buffer_load_dwordx4 v12, s[12:15], s28 offen lds
  buffer_load_dwordx4 v13, s[12:15], s28 offen offset:1024 lds
  buffer_load_dwordx4 v14, s[12:15], s28 offen offset:2048 lds
  buffer_load_dwordx4 v15, s[12:15], s28 offen offset:3072 lds
  s_mov_b32 m0, 106496
  s_nop 0
  buffer_load_dwordx4 v16, s[12:15], s28 offen lds
  buffer_load_dwordx4 v17, s[12:15], s28 offen offset:1024 lds
  buffer_load_dwordx4 v18, s[12:15], s28 offen offset:2048 lds
  buffer_load_dwordx4 v19, s[12:15], s28 offen offset:3072 lds
  s_mov_b32 s28, 196608
  s_mov_b32 m0, 110592
  s_nop 0
  buffer_load_dwordx4 v8, s[12:15], s28 offen lds
  buffer_load_dwordx4 v9, s[12:15], s28 offen offset:1024 lds
  buffer_load_dwordx4 v10, s[12:15], s28 offen offset:2048 lds
  buffer_load_dwordx4 v11, s[12:15], s28 offen offset:3072 lds
  s_mov_b32 m0, 114688
  s_nop 0
  buffer_load_dwordx4 v12, s[12:15], s28 offen lds
  buffer_load_dwordx4 v13, s[12:15], s28 offen offset:1024 lds
  buffer_load_dwordx4 v14, s[12:15], s28 offen offset:2048 lds
  buffer_load_dwordx4 v15, s[12:15], s28 offen offset:3072 lds
  s_mov_b32 m0, 118784
  s_nop 0
  buffer_load_dwordx4 v16, s[12:15], s28 offen lds
  buffer_load_dwordx4 v17, s[12:15], s28 offen offset:1024 lds
  buffer_load_dwordx4 v18, s[12:15], s28 offen offset:2048 lds
  buffer_load_dwordx4 v19, s[12:15], s28 offen offset:3072 lds
  s_mov_b32 s28, 393216
  s_mov_b32 m0, 122880
  s_nop 0
  buffer_load_dwordx4 v8, s[12:15], s28 offen lds
  buffer_load_dwordx4 v9, s[12:15], s28 offen offset:1024 lds
  buffer_load_dwordx4 v10, s[12:15], s28 offen offset:2048 lds
  buffer_load_dwordx4 v11, s[12:15], s28 offen offset:3072 lds
  s_mov_b32 m0, 126976
  s_nop 0
  buffer_load_dwordx4 v12, s[12:15], s28 offen lds
  buffer_load_dwordx4 v13, s[12:15], s28 offen offset:1024 lds
  buffer_load_dwordx4 v14, s[12:15], s28 offen offset:2048 lds
  buffer_load_dwordx4 v15, s[12:15], s28 offen offset:3072 lds
  s_mov_b32 m0, 131072
  s_nop 0
  buffer_load_dwordx4 v16, s[12:15], s28 offen lds
  buffer_load_dwordx4 v17, s[12:15], s28 offen offset:1024 lds
  buffer_load_dwordx4 v18, s[12:15], s28 offen offset:2048 lds
  buffer_load_dwordx4 v19, s[12:15], s28 offen offset:3072 lds
  s_mov_b32 s28, 589824
  s_mov_b32 m0, 135168
  s_nop 0
  buffer_load_dwordx4 v8, s[12:15], s28 offen lds
  buffer_load_dwordx4 v9, s[12:15], s28 offen offset:1024 lds
  buffer_load_dwordx4 v10, s[12:15], s28 offen offset:2048 lds
  buffer_load_dwordx4 v11, s[12:15], s28 offen offset:3072 lds
  s_mov_b32 m0, 139264
  s_nop 0
  buffer_load_dwordx4 v12, s[12:15], s28 offen lds
  buffer_load_dwordx4 v13, s[12:15], s28 offen offset:1024 lds
  buffer_load_dwordx4 v14, s[12:15], s28 offen offset:2048 lds
  buffer_load_dwordx4 v15, s[12:15], s28 offen offset:3072 lds
  s_mov_b32 m0, 143360
  s_nop 0
  buffer_load_dwordx4 v16, s[12:15], s28 offen lds
  buffer_load_dwordx4 v17, s[12:15], s28 offen offset:1024 lds
  buffer_load_dwordx4 v18, s[12:15], s28 offen offset:2048 lds
  buffer_load_dwordx4 v19, s[12:15], s28 offen offset:3072 lds
  s_waitcnt vmcnt(36)
  s_barrier
  s_mov_b32 s28, 786432
  s_mov_b32 m0, 147456
  s_nop 0
  buffer_load_dwordx4 v8, s[12:15], s28 offen lds
  buffer_load_dwordx4 v9, s[12:15], s28 offen offset:1024 lds
  buffer_load_dwordx4 v10, s[12:15], s28 offen offset:2048 lds
  buffer_load_dwordx4 v11, s[12:15], s28 offen offset:3072 lds
  s_mov_b32 m0, 151552
  s_nop 0
  buffer_load_dwordx4 v12, s[12:15], s28 offen lds
  buffer_load_dwordx4 v13, s[12:15], s28 offen offset:1024 lds
  buffer_load_dwordx4 v14, s[12:15], s28 offen offset:2048 lds
  buffer_load_dwordx4 v15, s[12:15], s28 offen offset:3072 lds
  s_mov_b32 m0, 155648
  s_nop 0
  buffer_load_dwordx4 v16, s[12:15], s28 offen lds
  buffer_load_dwordx4 v17, s[12:15], s28 offen offset:1024 lds
  buffer_load_dwordx4 v18, s[12:15], s28 offen offset:2048 lds
  buffer_load_dwordx4 v19, s[12:15], s28 offen offset:3072 lds
  s_waitcnt vmcnt(36)
  s_barrier
  s_mov_b32 s28, 983040
  s_mov_b32 m0, 98304
  s_nop 0
  buffer_load_dwordx4 v8, s[12:15], s28 offen lds
  buffer_load_dwordx4 v9, s[12:15], s28 offen offset:1024 lds
  buffer_load_dwordx4 v10, s[12:15], s28 offen offset:2048 lds
  buffer_load_dwordx4 v11, s[12:15], s28 offen offset:3072 lds
  s_mov_b32 m0, 102400
  s_nop 0
  buffer_load_dwordx4 v12, s[12:15], s28 offen lds
  buffer_load_dwordx4 v13, s[12:15], s28 offen offset:1024 lds
  buffer_load_dwordx4 v14, s[12:15], s28 offen offset:2048 lds
  buffer_load_dwordx4 v15, s[12:15], s28 offen offset:3072 lds
  s_mov_b32 m0, 106496
  s_nop 0
  buffer_load_dwordx4 v16, s[12:15], s28 offen lds
  buffer_load_dwordx4 v17, s[12:15], s28 offen offset:1024 lds
  buffer_load_dwordx4 v18, s[12:15], s28 offen offset:2048 lds
  buffer_load_dwordx4 v19, s[12:15], s28 offen offset:3072 lds
  s_waitcnt vmcnt(36)
  s_barrier
  s_mov_b32 s28, 1179648
  s_mov_b32 m0, 110592
  s_nop 0
  buffer_load_dwordx4 v8, s[12:15], s28 offen lds
  buffer_load_dwordx4 v9, s[12:15], s28 offen offset:1024 lds
  buffer_load_dwordx4 v10, s[12:15], s28 offen offset:2048 lds
  buffer_load_dwordx4 v11, s[12:15], s28 offen offset:3072 lds
  s_mov_b32 m0, 114688
  s_nop 0
  buffer_load_dwordx4 v12, s[12:15], s28 offen lds
  buffer_load_dwordx4 v13, s[12:15], s28 offen offset:1024 lds
  buffer_load_dwordx4 v14, s[12:15], s28 offen offset:2048 lds
  buffer_load_dwordx4 v15, s[12:15], s28 offen offset:3072 lds
  s_mov_b32 m0, 118784
  s_nop 0
  buffer_load_dwordx4 v16, s[12:15], s28 offen lds
  buffer_load_dwordx4 v17, s[12:15], s28 offen offset:1024 lds
  buffer_load_dwordx4 v18, s[12:15], s28 offen offset:2048 lds
  buffer_load_dwordx4 v19, s[12:15], s28 offen offset:3072 lds
  s_waitcnt vmcnt(36)
  s_barrier
  s_mov_b32 s28, 1376256
  s_mov_b32 m0, 122880
  s_nop 0
  buffer_load_dwordx4 v8, s[12:15], s28 offen lds
  buffer_load_dwordx4 v9, s[12:15], s28 offen offset:1024 lds
  buffer_load_dwordx4 v10, s[12:15], s28 offen offset:2048 lds
  buffer_load_dwordx4 v11, s[12:15], s28 offen offset:3072 lds
  s_mov_b32 m0, 126976
  s_nop 0
  buffer_load_dwordx4 v12, s[12:15], s28 offen lds
  buffer_load_dwordx4 v13, s[12:15], s28 offen offset:1024 lds
  buffer_load_dwordx4 v14, s[12:15], s28 offen offset:2048 lds
  buffer_load_dwordx4 v15, s[12:15], s28 offen offset:3072 lds
  s_mov_b32 m0, 131072
  s_nop 0
  buffer_load_dwordx4 v16, s[12:15], s28 offen lds
  buffer_load_dwordx4 v17, s[12:15], s28 offen offset:1024 lds
  buffer_load_dwordx4 v18, s[12:15], s28 offen offset:2048 lds
  buffer_load_dwordx4 v19, s[12:15], s28 offen offset:3072 lds
  s_waitcnt vmcnt(36)
  s_barrier
  s_mov_b32 s28, 1572864
  s_mov_b32 m0, 135168
  s_nop 0
  buffer_load_dwordx4 v8, s[12:15], s28 offen lds
  buffer_load_dwordx4 v9, s[12:15], s28 offen offset:1024 lds
  buffer_load_dwordx4 v10, s[12:15], s28 offen offset:2048 lds
  buffer_load_dwordx4 v11, s[12:15], s28 offen offset:3072 lds
  s_mov_b32 m0, 139264
  s_nop 0
  buffer_load_dwordx4 v12, s[12:15], s28 offen lds
  buffer_load_dwordx4 v13, s[12:15], s28 offen offset:1024 lds
  buffer_load_dwordx4 v14, s[12:15], s28 offen offset:2048 lds
  buffer_load_dwordx4 v15, s[12:15], s28 offen offset:3072 lds
  s_mov_b32 m0, 143360
  s_nop 0
  buffer_load_dwordx4 v16, s[12:15], s28 offen lds
  buffer_load_dwordx4 v17, s[12:15], s28 offen offset:1024 lds
  buffer_load_dwordx4 v18, s[12:15], s28 offen offset:2048 lds
  buffer_load_dwordx4 v19, s[12:15], s28 offen offset:3072 lds
  s_waitcnt vmcnt(36)
  s_barrier
  s_mov_b32 s28, 1769472
  s_mov_b32 m0, 147456
  s_nop 0
  buffer_load_dwordx4 v8, s[12:15], s28 offen lds
  buffer_load_dwordx4 v9, s[12:15], s28 offen offset:1024 lds
  buffer_load_dwordx4 v10, s[12:15], s28 offen offset:2048 lds
  buffer_load_dwordx4 v11, s[12:15], s28 offen offset:3072 lds
  s_mov_b32 m0, 151552
  s_nop 0
  buffer_load_dwordx4 v12, s[12:15], s28 offen lds
  buffer_load_dwordx4 v13, s[12:15], s28 offen offset:1024 lds
  buffer_load_dwordx4 v14, s[12:15], s28 offen offset:2048 lds
  buffer_load_dwordx4 v15, s[12:15], s28 offen offset:3072 lds
  s_mov_b32 m0, 155648
  s_nop 0
  buffer_load_dwordx4 v16, s[12:15], s28 offen lds
  buffer_load_dwordx4 v17, s[12:15], s28 offen offset:1024 lds
  buffer_load_dwordx4 v18, s[12:15], s28 offen offset:2048 lds
  buffer_load_dwordx4 v19, s[12:15], s28 offen offset:3072 lds
  s_waitcnt vmcnt(36)
  s_barrier
  s_mov_b32 s28, 1966080
  s_mov_b32 m0, 98304
  s_nop 0
  buffer_load_dwordx4 v8, s[12:15], s28 offen lds
  buffer_load_dwordx4 v9, s[12:15], s28 offen offset:1024 lds
  buffer_load_dwordx4 v10, s[12:15], s28 offen offset:2048 lds
  buffer_load_dwordx4 v11, s[12:15], s28 offen offset:3072 lds
  s_mov_b32 m0, 102400
  s_nop 0
  buffer_load_dwordx4 v12, s[12:15], s28 offen lds
  buffer_load_dwordx4 v13, s[12:15], s28 offen offset:1024 lds
  buffer_load_dwordx4 v14, s[12:15], s28 offen offset:2048 lds
  buffer_load_dwordx4 v15, s[12:15], s28 offen offset:3072 lds
  s_mov_b32 m0, 106496
  s_nop 0
  buffer_load_dwordx4 v16, s[12:15], s28 offen lds
  buffer_load_dwordx4 v17, s[12:15], s28 offen offset:1024 lds
  buffer_load_dwordx4 v18, s[12:15], s28 offen offset:2048 lds
  buffer_load_dwordx4 v19, s[12:15], s28 offen offset:3072 lds
  s_waitcnt vmcnt(36)
  s_barrier
  s_mov_b32 s28, 2162688
  s_mov_b32 m0, 110592
  s_nop 0
  buffer_load_dwordx4 v8, s[12:15], s28 offen lds
  buffer_load_dwordx4 v9, s[12:15], s28 offen offset:1024 lds
  buffer_load_dwordx4 v10, s[12:15], s28 offen offset:2048 lds
  buffer_load_dwordx4 v11, s[12:15], s28 offen offset:3072 lds
  s_mov_b32 m0, 114688
  s_nop 0
  buffer_load_dwordx4 v12, s[12:15], s28 offen lds
  buffer_load_dwordx4 v13, s[12:15], s28 offen offset:1024 lds
  buffer_load_dwordx4 v14, s[12:15], s28 offen offset:2048 lds
  buffer_load_dwordx4 v15, s[12:15], s28 offen offset:3072 lds
  s_mov_b32 m0, 118784
  s_nop 0
  buffer_load_dwordx4 v16, s[12:15], s28 offen lds
  buffer_load_dwordx4 v17, s[12:15], s28 offen offset:1024 lds
  buffer_load_dwordx4 v18, s[12:15], s28 offen offset:2048 lds
  buffer_load_dwordx4 v19, s[12:15], s28 offen offset:3072 lds
  s_waitcnt vmcnt(36)
  s_barrier
  s_mov_b32 s28, 2359296
  s_mov_b32 m0, 122880
  s_nop 0
  buffer_load_dwordx4 v8, s[12:15], s28 offen lds
  buffer_load_dwordx4 v9, s[12:15], s28 offen offset:1024 lds
  buffer_load_dwordx4 v10, s[12:15], s28 offen offset:2048 lds
  buffer_load_dwordx4 v11, s[12:15], s28 offen offset:3072 lds
  s_mov_b32 m0, 126976
  s_nop 0
  buffer_load_dwordx4 v12, s[12:15], s28 offen lds
  buffer_load_dwordx4 v13, s[12:15], s28 offen offset:1024 lds
  buffer_load_dwordx4 v14, s[12:15], s28 offen offset:2048 lds
  buffer_load_dwordx4 v15, s[12:15], s28 offen offset:3072 lds
  s_mov_b32 m0, 131072
  s_nop 0
  buffer_load_dwordx4 v16, s[12:15], s28 offen lds
  buffer_load_dwordx4 v17, s[12:15], s28 offen offset:1024 lds
  buffer_load_dwordx4 v18, s[12:15], s28 offen offset:2048 lds
  buffer_load_dwordx4 v19, s[12:15], s28 offen offset:3072 lds
  s_waitcnt vmcnt(36)
  s_barrier
  s_mov_b32 s28, 2555904
  s_mov_b32 m0, 135168
  s_nop 0
  buffer_load_dwordx4 v8, s[12:15], s28 offen lds
  buffer_load_dwordx4 v9, s[12:15], s28 offen offset:1024 lds
  buffer_load_dwordx4 v10, s[12:15], s28 offen offset:2048 lds
  buffer_load_dwordx4 v11, s[12:15], s28 offen offset:3072 lds
  s_mov_b32 m0, 139264
  s_nop 0
  buffer_load_dwordx4 v12, s[12:15], s28 offen lds
  buffer_load_dwordx4 v13, s[12:15], s28 offen offset:1024 lds
  buffer_load_dwordx4 v14, s[12:15], s28 offen offset:2048 lds
  buffer_load_dwordx4 v15, s[12:15], s28 offen offset:3072 lds
  s_mov_b32 m0, 143360
  s_nop 0
  buffer_load_dwordx4 v16, s[12:15], s28 offen lds
  buffer_load_dwordx4 v17, s[12:15], s28 offen offset:1024 lds
  buffer_load_dwordx4 v18, s[12:15], s28 offen offset:2048 lds
  buffer_load_dwordx4 v19, s[12:15], s28 offen offset:3072 lds
  s_waitcnt vmcnt(36)
  s_barrier
  s_mov_b32 s28, 2752512
  s_mov_b32 m0, 147456
  s_nop 0
  buffer_load_dwordx4 v8, s[12:15], s28 offen lds
  buffer_load_dwordx4 v9, s[12:15], s28 offen offset:1024 lds
  buffer_load_dwordx4 v10, s[12:15], s28 offen offset:2048 lds
  buffer_load_dwordx4 v11, s[12:15], s28 offen offset:3072 lds
  s_mov_b32 m0, 151552
  s_nop 0
  buffer_load_dwordx4 v12, s[12:15], s28 offen lds
  buffer_load_dwordx4 v13, s[12:15], s28 offen offset:1024 lds
  buffer_load_dwordx4 v14, s[12:15], s28 offen offset:2048 lds
  buffer_load_dwordx4 v15, s[12:15], s28 offen offset:3072 lds
  s_mov_b32 m0, 155648
  s_nop 0
  buffer_load_dwordx4 v16, s[12:15], s28 offen lds
  buffer_load_dwordx4 v17, s[12:15], s28 offen offset:1024 lds
  buffer_load_dwordx4 v18, s[12:15], s28 offen offset:2048 lds
  buffer_load_dwordx4 v19, s[12:15], s28 offen offset:3072 lds
  s_waitcnt vmcnt(36)
  s_barrier
  s_mov_b32 s28, 2949120
  s_mov_b32 m0, 98304
  s_nop 0
  buffer_load_dwordx4 v8, s[12:15], s28 offen lds
  buffer_load_dwordx4 v9, s[12:15], s28 offen offset:1024 lds
  buffer_load_dwordx4 v10, s[12:15], s28 offen offset:2048 lds
  buffer_load_dwordx4 v11, s[12:15], s28 offen offset:3072 lds
  s_mov_b32 m0, 102400
  s_nop 0
  buffer_load_dwordx4 v12, s[12:15], s28 offen lds
  buffer_load_dwordx4 v13, s[12:15], s28 offen offset:1024 lds
  buffer_load_dwordx4 v14, s[12:15], s28 offen offset:2048 lds
  buffer_load_dwordx4 v15, s[12:15], s28 offen offset:3072 lds
  s_mov_b32 m0, 106496
  s_nop 0
  buffer_load_dwordx4 v16, s[12:15], s28 offen lds
  buffer_load_dwordx4 v17, s[12:15], s28 offen offset:1024 lds
  buffer_load_dwordx4 v18, s[12:15], s28 offen offset:2048 lds
  buffer_load_dwordx4 v19, s[12:15], s28 offen offset:3072 lds
  s_waitcnt vmcnt(36)
  s_barrier
  s_mov_b32 s28, 3145728
  s_mov_b32 m0, 110592
  s_nop 0
  buffer_load_dwordx4 v8, s[12:15], s28 offen lds
  buffer_load_dwordx4 v9, s[12:15], s28 offen offset:1024 lds
  buffer_load_dwordx4 v10, s[12:15], s28 offen offset:2048 lds
  buffer_load_dwordx4 v11, s[12:15], s28 offen offset:3072 lds
  s_mov_b32 m0, 114688
  s_nop 0
  buffer_load_dwordx4 v12, s[12:15], s28 offen lds
  buffer_load_dwordx4 v13, s[12:15], s28 offen offset:1024 lds
  buffer_load_dwordx4 v14, s[12:15], s28 offen offset:2048 lds
  buffer_load_dwordx4 v15, s[12:15], s28 offen offset:3072 lds
  s_mov_b32 m0, 118784
  s_nop 0
  buffer_load_dwordx4 v16, s[12:15], s28 offen lds
  buffer_load_dwordx4 v17, s[12:15], s28 offen offset:1024 lds
  buffer_load_dwordx4 v18, s[12:15], s28 offen offset:2048 lds
  buffer_load_dwordx4 v19, s[12:15], s28 offen offset:3072 lds
  s_waitcnt vmcnt(36)
  s_barrier
  s_mov_b32 s28, 3342336
  s_mov_b32 m0, 122880
  s_nop 0
  buffer_load_dwordx4 v8, s[12:15], s28 offen lds
  buffer_load_dwordx4 v9, s[12:15], s28 offen offset:1024 lds
  buffer_load_dwordx4 v10, s[12:15], s28 offen offset:2048 lds
  buffer_load_dwordx4 v11, s[12:15], s28 offen offset:3072 lds
  s_mov_b32 m0, 126976
  s_nop 0
  buffer_load_dwordx4 v12, s[12:15], s28 offen lds
  buffer_load_dwordx4 v13, s[12:15], s28 offen offset:1024 lds
  buffer_load_dwordx4 v14, s[12:15], s28 offen offset:2048 lds
  buffer_load_dwordx4 v15, s[12:15], s28 offen offset:3072 lds
  s_mov_b32 m0, 131072
  s_nop 0
  buffer_load_dwordx4 v16, s[12:15], s28 offen lds
  buffer_load_dwordx4 v17, s[12:15], s28 offen offset:1024 lds
  buffer_load_dwordx4 v18, s[12:15], s28 offen offset:2048 lds
  buffer_load_dwordx4 v19, s[12:15], s28 offen offset:3072 lds
  s_waitcnt vmcnt(36)
  s_barrier
  s_mov_b32 s28, 3538944
  s_mov_b32 m0, 135168
  s_nop 0
  buffer_load_dwordx4 v8, s[12:15], s28 offen lds
  buffer_load_dwordx4 v9, s[12:15], s28 offen offset:1024 lds
  buffer_load_dwordx4 v10, s[12:15], s28 offen offset:2048 lds
  buffer_load_dwordx4 v11, s[12:15], s28 offen offset:3072 lds
  s_mov_b32 m0, 139264
  s_nop 0
  buffer_load_dwordx4 v12, s[12:15], s28 offen lds
  buffer_load_dwordx4 v13, s[12:15], s28 offen offset:1024 lds
  buffer_load_dwordx4 v14, s[12:15], s28 offen offset:2048 lds
  buffer_load_dwordx4 v15, s[12:15], s28 offen offset:3072 lds
  s_mov_b32 m0, 143360
  s_nop 0
  buffer_load_dwordx4 v16, s[12:15], s28 offen lds
  buffer_load_dwordx4 v17, s[12:15], s28 offen offset:1024 lds
  buffer_load_dwordx4 v18, s[12:15], s28 offen offset:2048 lds
  buffer_load_dwordx4 v19, s[12:15], s28 offen offset:3072 lds
  s_waitcnt vmcnt(36)
  s_barrier
  s_mov_b32 s28, 3735552
  s_mov_b32 m0, 147456
  s_nop 0
  buffer_load_dwordx4 v8, s[12:15], s28 offen lds
  buffer_load_dwordx4 v9, s[12:15], s28 offen offset:1024 lds
  buffer_load_dwordx4 v10, s[12:15], s28 offen offset:2048 lds
  buffer_load_dwordx4 v11, s[12:15], s28 offen offset:3072 lds
  s_mov_b32 m0, 151552
  s_nop 0
  buffer_load_dwordx4 v12, s[12:15], s28 offen lds
  buffer_load_dwordx4 v13, s[12:15], s28 offen offset:1024 lds
  buffer_load_dwordx4 v14, s[12:15], s28 offen offset:2048 lds
  buffer_load_dwordx4 v15, s[12:15], s28 offen offset:3072 lds
  s_mov_b32 m0, 155648
  s_nop 0
  buffer_load_dwordx4 v16, s[12:15], s28 offen lds
  buffer_load_dwordx4 v17, s[12:15], s28 offen offset:1024 lds
  buffer_load_dwordx4 v18, s[12:15], s28 offen offset:2048 lds
  buffer_load_dwordx4 v19, s[12:15], s28 offen offset:3072 lds
  s_waitcnt vmcnt(36)
  s_barrier
  s_mov_b32 s28, 3932160
  s_mov_b32 m0, 98304
  s_nop 0
  buffer_load_dwordx4 v8, s[12:15], s28 offen lds
  buffer_load_dwordx4 v9, s[12:15], s28 offen offset:1024 lds
  buffer_load_dwordx4 v10, s[12:15], s28 offen offset:2048 lds
  buffer_load_dwordx4 v11, s[12:15], s28 offen offset:3072 lds
  s_mov_b32 m0, 102400
  s_nop 0
  buffer_load_dwordx4 v12, s[12:15], s28 offen lds
  buffer_load_dwordx4 v13, s[12:15], s28 offen offset:1024 lds
  buffer_load_dwordx4 v14, s[12:15], s28 offen offset:2048 lds
  buffer_load_dwordx4 v15, s[12:15], s28 offen offset:3072 lds
  s_mov_b32 m0, 106496
  s_nop 0
  buffer_load_dwordx4 v16, s[12:15], s28 offen lds
  buffer_load_dwordx4 v17, s[12:15], s28 offen offset:1024 lds
  buffer_load_dwordx4 v18, s[12:15], s28 offen offset:2048 lds
  buffer_load_dwordx4 v19, s[12:15], s28 offen offset:3072 lds
  s_waitcnt vmcnt(36)
  s_barrier
  s_mov_b32 s28, 4128768
  s_mov_b32 m0, 110592
  s_nop 0
  buffer_load_dwordx4 v8, s[12:15], s28 offen lds
  buffer_load_dwordx4 v9, s[12:15], s28 offen offset:1024 lds
  buffer_load_dwordx4 v10, s[12:15], s28 offen offset:2048 lds
  buffer_load_dwordx4 v11, s[12:15], s28 offen offset:3072 lds
  s_mov_b32 m0, 114688
  s_nop 0
  buffer_load_dwordx4 v12, s[12:15], s28 offen lds
  buffer_load_dwordx4 v13, s[12:15], s28 offen offset:1024 lds
  buffer_load_dwordx4 v14, s[12:15], s28 offen offset:2048 lds
  buffer_load_dwordx4 v15, s[12:15], s28 offen offset:3072 lds
  s_mov_b32 m0, 118784
  s_nop 0
  buffer_load_dwordx4 v16, s[12:15], s28 offen lds
  buffer_load_dwordx4 v17, s[12:15], s28 offen offset:1024 lds
  buffer_load_dwordx4 v18, s[12:15], s28 offen offset:2048 lds
  buffer_load_dwordx4 v19, s[12:15], s28 offen offset:3072 lds
  s_waitcnt vmcnt(36)
  s_barrier
  s_mov_b32 s28, 4325376
  s_mov_b32 m0, 122880
  s_nop 0
  buffer_load_dwordx4 v8, s[12:15], s28 offen lds
  buffer_load_dwordx4 v9, s[12:15], s28 offen offset:1024 lds
  buffer_load_dwordx4 v10, s[12:15], s28 offen offset:2048 lds
  buffer_load_dwordx4 v11, s[12:15], s28 offen offset:3072 lds
  s_mov_b32 m0, 126976
  s_nop 0
  buffer_load_dwordx4 v12, s[12:15], s28 offen lds
  buffer_load_dwordx4 v13, s[12:15], s28 offen offset:1024 lds
  buffer_load_dwordx4 v14, s[12:15], s28 offen offset:2048 lds
  buffer_load_dwordx4 v15, s[12:15], s28 offen offset:3072 lds
  s_mov_b32 m0, 131072
  s_nop 0
  buffer_load_dwordx4 v16, s[12:15], s28 offen lds
  buffer_load_dwordx4 v17, s[12:15], s28 offen offset:1024 lds
  buffer_load_dwordx4 v18, s[12:15], s28 offen offset:2048 lds
  buffer_load_dwordx4 v19, s[12:15], s28 offen offset:3072 lds
  s_waitcnt vmcnt(36)
  s_barrier
  s_mov_b32 s28, 4521984
  s_mov_b32 m0, 135168
  s_nop 0
  buffer_load_dwordx4 v8, s[12:15], s28 offen lds
  buffer_load_dwordx4 v9, s[12:15], s28 offen offset:1024 lds
  buffer_load_dwordx4 v10, s[12:15], s28 offen offset:2048 lds
  buffer_load_dwordx4 v11, s[12:15], s28 offen offset:3072 lds
  s_mov_b32 m0, 139264
  s_nop 0
  buffer_load_dwordx4 v12, s[12:15], s28 offen lds
  buffer_load_dwordx4 v13, s[12:15], s28 offen offset:1024 lds
  buffer_load_dwordx4 v14, s[12:15], s28 offen offset:2048 lds
  buffer_load_dwordx4 v15, s[12:15], s28 offen offset:3072 lds
  s_mov_b32 m0, 143360
  s_nop 0
  buffer_load_dwordx4 v16, s[12:15], s28 offen lds
  buffer_load_dwordx4 v17, s[12:15], s28 offen offset:1024 lds
  buffer_load_dwordx4 v18, s[12:15], s28 offen offset:2048 lds
  buffer_load_dwordx4 v19, s[12:15], s28 offen offset:3072 lds
  s_waitcnt vmcnt(36)
  s_barrier
  s_mov_b32 s28, 4718592
  s_mov_b32 m0, 147456
  s_nop 0
  buffer_load_dwordx4 v8, s[12:15], s28 offen lds
  buffer_load_dwordx4 v9, s[12:15], s28 offen offset:1024 lds
  buffer_load_dwordx4 v10, s[12:15], s28 offen offset:2048 lds
  buffer_load_dwordx4 v11, s[12:15], s28 offen offset:3072 lds
  s_mov_b32 m0, 151552
  s_nop 0
  buffer_load_dwordx4 v12, s[12:15], s28 offen lds
  buffer_load_dwordx4 v13, s[12:15], s28 offen offset:1024 lds
  buffer_load_dwordx4 v14, s[12:15], s28 offen offset:2048 lds
  buffer_load_dwordx4 v15, s[12:15], s28 offen offset:3072 lds
  s_mov_b32 m0, 155648
  s_nop 0
  buffer_load_dwordx4 v16, s[12:15], s28 offen lds
  buffer_load_dwordx4 v17, s[12:15], s28 offen offset:1024 lds
  buffer_load_dwordx4 v18, s[12:15], s28 offen offset:2048 lds
  buffer_load_dwordx4 v19, s[12:15], s28 offen offset:3072 lds
  s_waitcnt vmcnt(36)
  s_barrier
  s_mov_b32 s28, 4915200
  s_mov_b32 m0, 98304
  s_nop 0
  buffer_load_dwordx4 v8, s[12:15], s28 offen lds
  buffer_load_dwordx4 v9, s[12:15], s28 offen offset:1024 lds
  buffer_load_dwordx4 v10, s[12:15], s28 offen offset:2048 lds
  buffer_load_dwordx4 v11, s[12:15], s28 offen offset:3072 lds
  s_mov_b32 m0, 102400
  s_nop 0
  buffer_load_dwordx4 v12, s[12:15], s28 offen lds
  buffer_load_dwordx4 v13, s[12:15], s28 offen offset:1024 lds
  buffer_load_dwordx4 v14, s[12:15], s28 offen offset:2048 lds
  buffer_load_dwordx4 v15, s[12:15], s28 offen offset:3072 lds
  s_mov_b32 m0, 106496
  s_nop 0
  buffer_load_dwordx4 v16, s[12:15], s28 offen lds
  buffer_load_dwordx4 v17, s[12:15], s28 offen offset:1024 lds
  buffer_load_dwordx4 v18, s[12:15], s28 offen offset:2048 lds
  buffer_load_dwordx4 v19, s[12:15], s28 offen offset:3072 lds
  s_waitcnt vmcnt(36)
  s_barrier
  s_mov_b32 s28, 5111808
  s_mov_b32 m0, 110592
  s_nop 0
  buffer_load_dwordx4 v8, s[12:15], s28 offen lds
  buffer_load_dwordx4 v9, s[12:15], s28 offen offset:1024 lds
  buffer_load_dwordx4 v10, s[12:15], s28 offen offset:2048 lds
  buffer_load_dwordx4 v11, s[12:15], s28 offen offset:3072 lds
  s_mov_b32 m0, 114688
  s_nop 0
  buffer_load_dwordx4 v12, s[12:15], s28 offen lds
  buffer_load_dwordx4 v13, s[12:15], s28 offen offset:1024 lds
  buffer_load_dwordx4 v14, s[12:15], s28 offen offset:2048 lds
  buffer_load_dwordx4 v15, s[12:15], s28 offen offset:3072 lds
  s_mov_b32 m0, 118784
  s_nop 0
  buffer_load_dwordx4 v16, s[12:15], s28 offen lds
  buffer_load_dwordx4 v17, s[12:15], s28 offen offset:1024 lds
  buffer_load_dwordx4 v18, s[12:15], s28 offen offset:2048 lds
  buffer_load_dwordx4 v19, s[12:15], s28 offen offset:3072 lds
  s_waitcnt vmcnt(36)
  s_barrier
  s_mov_b32 s28, 5308416
  s_mov_b32 m0, 122880
  s_nop 0
  buffer_load_dwordx4 v8, s[12:15], s28 offen lds
  buffer_load_dwordx4 v9, s[12:15], s28 offen offset:1024 lds
  buffer_load_dwordx4 v10, s[12:15], s28 offen offset:2048 lds
  buffer_load_dwordx4 v11, s[12:15], s28 offen offset:3072 lds
  s_mov_b32 m0, 126976
  s_nop 0
  buffer_load_dwordx4 v12, s[12:15], s28 offen lds
  buffer_load_dwordx4 v13, s[12:15], s28 offen offset:1024 lds
  buffer_load_dwordx4 v14, s[12:15], s28 offen offset:2048 lds
  buffer_load_dwordx4 v15, s[12:15], s28 offen offset:3072 lds
  s_mov_b32 m0, 131072
  s_nop 0
  buffer_load_dwordx4 v16, s[12:15], s28 offen lds
  buffer_load_dwordx4 v17, s[12:15], s28 offen offset:1024 lds
  buffer_load_dwordx4 v18, s[12:15], s28 offen offset:2048 lds
  buffer_load_dwordx4 v19, s[12:15], s28 offen offset:3072 lds
  s_waitcnt vmcnt(36)
  s_barrier
  s_mov_b32 s28, 5505024
  s_mov_b32 m0, 135168
  s_nop 0
  buffer_load_dwordx4 v8, s[12:15], s28 offen lds
  buffer_load_dwordx4 v9, s[12:15], s28 offen offset:1024 lds
  buffer_load_dwordx4 v10, s[12:15], s28 offen offset:2048 lds
  buffer_load_dwordx4 v11, s[12:15], s28 offen offset:3072 lds
  s_mov_b32 m0, 139264
  s_nop 0
  buffer_load_dwordx4 v12, s[12:15], s28 offen lds
  buffer_load_dwordx4 v13, s[12:15], s28 offen offset:1024 lds
  buffer_load_dwordx4 v14, s[12:15], s28 offen offset:2048 lds
  buffer_load_dwordx4 v15, s[12:15], s28 offen offset:3072 lds
  s_mov_b32 m0, 143360
  s_nop 0
  buffer_load_dwordx4 v16, s[12:15], s28 offen lds
  buffer_load_dwordx4 v17, s[12:15], s28 offen offset:1024 lds
  buffer_load_dwordx4 v18, s[12:15], s28 offen offset:2048 lds
  buffer_load_dwordx4 v19, s[12:15], s28 offen offset:3072 lds
  s_waitcnt vmcnt(36)
  s_barrier
  s_mov_b32 s28, 5701632
  s_mov_b32 m0, 147456
  s_nop 0
  buffer_load_dwordx4 v8, s[12:15], s28 offen lds
  buffer_load_dwordx4 v9, s[12:15], s28 offen offset:1024 lds
  buffer_load_dwordx4 v10, s[12:15], s28 offen offset:2048 lds
  buffer_load_dwordx4 v11, s[12:15], s28 offen offset:3072 lds
  s_mov_b32 m0, 151552
  s_nop 0
  buffer_load_dwordx4 v12, s[12:15], s28 offen lds
  buffer_load_dwordx4 v13, s[12:15], s28 offen offset:1024 lds
  buffer_load_dwordx4 v14, s[12:15], s28 offen offset:2048 lds
  buffer_load_dwordx4 v15, s[12:15], s28 offen offset:3072 lds
  s_mov_b32 m0, 155648
  s_nop 0
  buffer_load_dwordx4 v16, s[12:15], s28 offen lds
  buffer_load_dwordx4 v17, s[12:15], s28 offen offset:1024 lds
  buffer_load_dwordx4 v18, s[12:15], s28 offen offset:2048 lds
  buffer_load_dwordx4 v19, s[12:15], s28 offen offset:3072 lds
  s_waitcnt vmcnt(36)
  s_barrier
  s_mov_b32 s28, 5898240
  s_mov_b32 m0, 98304
  s_nop 0
  buffer_load_dwordx4 v8, s[12:15], s28 offen lds
  buffer_load_dwordx4 v9, s[12:15], s28 offen offset:1024 lds
  buffer_load_dwordx4 v10, s[12:15], s28 offen offset:2048 lds
  buffer_load_dwordx4 v11, s[12:15], s28 offen offset:3072 lds
  s_mov_b32 m0, 102400
  s_nop 0
  buffer_load_dwordx4 v12, s[12:15], s28 offen lds
  buffer_load_dwordx4 v13, s[12:15], s28 offen offset:1024 lds
  buffer_load_dwordx4 v14, s[12:15], s28 offen offset:2048 lds
  buffer_load_dwordx4 v15, s[12:15], s28 offen offset:3072 lds
  s_mov_b32 m0, 106496
  s_nop 0
  buffer_load_dwordx4 v16, s[12:15], s28 offen lds
  buffer_load_dwordx4 v17, s[12:15], s28 offen offset:1024 lds
  buffer_load_dwordx4 v18, s[12:15], s28 offen offset:2048 lds
  buffer_load_dwordx4 v19, s[12:15], s28 offen offset:3072 lds
  s_waitcnt vmcnt(36)
  s_barrier
  s_mov_b32 s28, 6094848
  s_mov_b32 m0, 110592
  s_nop 0
  buffer_load_dwordx4 v8, s[12:15], s28 offen lds
  buffer_load_dwordx4 v9, s[12:15], s28 offen offset:1024 lds
  buffer_load_dwordx4 v10, s[12:15], s28 offen offset:2048 lds
  buffer_load_dwordx4 v11, s[12:15], s28 offen offset:3072 lds
  s_mov_b32 m0, 114688
  s_nop 0
  buffer_load_dwordx4 v12, s[12:15], s28 offen lds
  buffer_load_dwordx4 v13, s[12:15], s28 offen offset:1024 lds
  buffer_load_dwordx4 v14, s[12:15], s28 offen offset:2048 lds
  buffer_load_dwordx4 v15, s[12:15], s28 offen offset:3072 lds
  s_mov_b32 m0, 118784
  s_nop 0
  buffer_load_dwordx4 v16, s[12:15], s28 offen lds
  buffer_load_dwordx4 v17, s[12:15], s28 offen offset:1024 lds
  buffer_load_dwordx4 v18, s[12:15], s28 offen offset:2048 lds
  buffer_load_dwordx4 v19, s[12:15], s28 offen offset:3072 lds
  s_waitcnt vmcnt(36)
  s_barrier
  s_waitcnt vmcnt(24)
  s_barrier
  s_waitcnt vmcnt(12)
  s_barrier
  s_waitcnt vmcnt(0)
  s_barrier
  s_endpgm
L_qkv_kernel_gate:
  s_waitcnt lgkmcnt(0)
  s_cmp_eq_u32 s25, 0
  s_cselect_b32 s6, s6, s38
  s_cselect_b32 s7, s7, s39
  s_mov_b32 s8, s4
  s_and_b32 s9, s5, 0xffff
  s_mov_b32 s10, 0x400000
  s_mov_b32 s11, 0x20000
  s_mov_b32 s12, s6
  s_and_b32 s13, s7, 0xffff
  s_mov_b32 s14, 0x600000
  s_mov_b32 s15, 0x20000
  s_mov_b32 s16, s34
  s_and_b32 s17, s35, 0xffff
  s_mov_b32 s18, 0x3000000
  s_mov_b32 s19, 0x20000
  s_mov_b32 s64, s32
  s_and_b32 s65, s33, 0xffff
  s_mov_b32 s66, 0x800
  s_mov_b32 s67, 0x20000
  s_lshl_b32 s48, s25, 4
  s_add_u32 s48, s48, s24
  v_and_b32 v2, 7, v1
  v_lshlrev_b32 v3, 4, v2
  buffer_load_dwordx4 v[144:147], v3, s[64:67], 0 offen offset:0
  buffer_load_dwordx4 v[148:151], v3, s[64:67], 0 offen offset:128
  buffer_load_dwordx4 v[152:155], v3, s[64:67], 0 offen offset:256
  buffer_load_dwordx4 v[156:159], v3, s[64:67], 0 offen offset:384
  buffer_load_dwordx4 v[160:163], v3, s[64:67], 0 offen offset:512
  buffer_load_dwordx4 v[164:167], v3, s[64:67], 0 offen offset:640
  buffer_load_dwordx4 v[168:171], v3, s[64:67], 0 offen offset:768
  buffer_load_dwordx4 v[172:175], v3, s[64:67], 0 offen offset:896
  buffer_load_dwordx4 v[176:179], v3, s[64:67], 0 offen offset:1024
  buffer_load_dwordx4 v[180:183], v3, s[64:67], 0 offen offset:1152
  buffer_load_dwordx4 v[184:187], v3, s[64:67], 0 offen offset:1280
  buffer_load_dwordx4 v[188:191], v3, s[64:67], 0 offen offset:1408
  buffer_load_dwordx4 v[192:195], v3, s[64:67], 0 offen offset:1536
  buffer_load_dwordx4 v[196:199], v3, s[64:67], 0 offen offset:1664
  buffer_load_dwordx4 v[200:203], v3, s[64:67], 0 offen offset:1792
  buffer_load_dwordx4 v[204:207], v3, s[64:67], 0 offen offset:1920
  v_lshrrev_b32 v4, 3, v1
  s_lshl_b32 s49, s48, 3
  v_add_u32 v5, s49, v4
  v_bfe_u32 v6, v5, 1, 3
  v_xor_b32 v6, v6, v2
  v_lshlrev_b32 v6, 4, v6
  v_lshlrev_b32 v7, 7, v5
  v_add_u32 v6, v6, v7
  s_lshl_b32 s50, s23, 8
  v_add_u32 v5, s50, v5
  v_mov_b32 v8, 0
  v_mov_b32 v15, 0x3f803f80
  s_waitcnt vmcnt(0)
  v_lshlrev_b32 v16, 16, v144
  v_and_b32 v17, 0xffff0000, v144
  v_lshlrev_b32 v18, 16, v145
  v_and_b32 v19, 0xffff0000, v145
  v_lshlrev_b32 v20, 16, v146
  v_and_b32 v21, 0xffff0000, v146
  v_lshlrev_b32 v22, 16, v147
  v_and_b32 v23, 0xffff0000, v147
  v_lshlrev_b32 v24, 16, v148
  v_and_b32 v25, 0xffff0000, v148
  v_lshlrev_b32 v26, 16, v149
  v_and_b32 v27, 0xffff0000, v149
  v_lshlrev_b32 v28, 16, v150
  v_and_b32 v29, 0xffff0000, v150
  v_lshlrev_b32 v30, 16, v151
  v_and_b32 v31, 0xffff0000, v151
  v_lshlrev_b32 v32, 16, v152
  v_and_b32 v33, 0xffff0000, v152
  v_lshlrev_b32 v34, 16, v153
  v_and_b32 v35, 0xffff0000, v153
  v_lshlrev_b32 v36, 16, v154
  v_and_b32 v37, 0xffff0000, v154
  v_lshlrev_b32 v38, 16, v155
  v_and_b32 v39, 0xffff0000, v155
  v_lshlrev_b32 v40, 16, v156
  v_and_b32 v41, 0xffff0000, v156
  v_lshlrev_b32 v42, 16, v157
  v_and_b32 v43, 0xffff0000, v157
  v_lshlrev_b32 v44, 16, v158
  v_and_b32 v45, 0xffff0000, v158
  v_lshlrev_b32 v46, 16, v159
  v_and_b32 v47, 0xffff0000, v159
  v_lshlrev_b32 v48, 16, v160
  v_and_b32 v49, 0xffff0000, v160
  v_lshlrev_b32 v50, 16, v161
  v_and_b32 v51, 0xffff0000, v161
  v_lshlrev_b32 v52, 16, v162
  v_and_b32 v53, 0xffff0000, v162
  v_lshlrev_b32 v54, 16, v163
  v_and_b32 v55, 0xffff0000, v163
  v_lshlrev_b32 v56, 16, v164
  v_and_b32 v57, 0xffff0000, v164
  v_lshlrev_b32 v58, 16, v165
  v_and_b32 v59, 0xffff0000, v165
  v_lshlrev_b32 v60, 16, v166
  v_and_b32 v61, 0xffff0000, v166
  v_lshlrev_b32 v62, 16, v167
  v_and_b32 v63, 0xffff0000, v167
  v_lshlrev_b32 v64, 16, v168
  v_and_b32 v65, 0xffff0000, v168
  v_lshlrev_b32 v66, 16, v169
  v_and_b32 v67, 0xffff0000, v169
  v_lshlrev_b32 v68, 16, v170
  v_and_b32 v69, 0xffff0000, v170
  v_lshlrev_b32 v70, 16, v171
  v_and_b32 v71, 0xffff0000, v171
  v_lshlrev_b32 v72, 16, v172
  v_and_b32 v73, 0xffff0000, v172
  v_lshlrev_b32 v74, 16, v173
  v_and_b32 v75, 0xffff0000, v173
  v_lshlrev_b32 v76, 16, v174
  v_and_b32 v77, 0xffff0000, v174
  v_lshlrev_b32 v78, 16, v175
  v_and_b32 v79, 0xffff0000, v175
  v_lshlrev_b32 v80, 16, v176
  v_and_b32 v81, 0xffff0000, v176
  v_lshlrev_b32 v82, 16, v177
  v_and_b32 v83, 0xffff0000, v177
  v_lshlrev_b32 v84, 16, v178
  v_and_b32 v85, 0xffff0000, v178
  v_lshlrev_b32 v86, 16, v179
  v_and_b32 v87, 0xffff0000, v179
  v_lshlrev_b32 v88, 16, v180
  v_and_b32 v89, 0xffff0000, v180
  v_lshlrev_b32 v90, 16, v181
  v_and_b32 v91, 0xffff0000, v181
  v_lshlrev_b32 v92, 16, v182
  v_and_b32 v93, 0xffff0000, v182
  v_lshlrev_b32 v94, 16, v183
  v_and_b32 v95, 0xffff0000, v183
  v_lshlrev_b32 v96, 16, v184
  v_and_b32 v97, 0xffff0000, v184
  v_lshlrev_b32 v98, 16, v185
  v_and_b32 v99, 0xffff0000, v185
  v_lshlrev_b32 v100, 16, v186
  v_and_b32 v101, 0xffff0000, v186
  v_lshlrev_b32 v102, 16, v187
  v_and_b32 v103, 0xffff0000, v187
  v_lshlrev_b32 v104, 16, v188
  v_and_b32 v105, 0xffff0000, v188
  v_lshlrev_b32 v106, 16, v189
  v_and_b32 v107, 0xffff0000, v189
  v_lshlrev_b32 v108, 16, v190
  v_and_b32 v109, 0xffff0000, v190
  v_lshlrev_b32 v110, 16, v191
  v_and_b32 v111, 0xffff0000, v191
  v_lshlrev_b32 v112, 16, v192
  v_and_b32 v113, 0xffff0000, v192
  v_lshlrev_b32 v114, 16, v193
  v_and_b32 v115, 0xffff0000, v193
  v_lshlrev_b32 v116, 16, v194
  v_and_b32 v117, 0xffff0000, v194
  v_lshlrev_b32 v118, 16, v195
  v_and_b32 v119, 0xffff0000, v195
  v_lshlrev_b32 v120, 16, v196
  v_and_b32 v121, 0xffff0000, v196
  v_lshlrev_b32 v122, 16, v197
  v_and_b32 v123, 0xffff0000, v197
  v_lshlrev_b32 v124, 16, v198
  v_and_b32 v125, 0xffff0000, v198
  v_lshlrev_b32 v126, 16, v199
  v_and_b32 v127, 0xffff0000, v199
  v_lshlrev_b32 v128, 16, v200
  v_and_b32 v129, 0xffff0000, v200
  v_lshlrev_b32 v130, 16, v201
  v_and_b32 v131, 0xffff0000, v201
  v_lshlrev_b32 v132, 16, v202
  v_and_b32 v133, 0xffff0000, v202
  v_lshlrev_b32 v134, 16, v203
  v_and_b32 v135, 0xffff0000, v203
  v_lshlrev_b32 v136, 16, v204
  v_and_b32 v137, 0xffff0000, v204
  v_lshlrev_b32 v138, 16, v205
  v_and_b32 v139, 0xffff0000, v205
  v_lshlrev_b32 v140, 16, v206
  v_and_b32 v141, 0xffff0000, v206
  v_lshlrev_b32 v142, 16, v207
  v_and_b32 v143, 0xffff0000, v207
  v_add_u32 v9, 65536, v6
  s_barrier
  ds_read_b128 v[10:13], v6 offset:0
  s_waitcnt lgkmcnt(0)
  v_lshlrev_b32 v2, 16, v10
  v_and_b32 v3, 0xffff0000, v10
  v_mul_f32 v2, v2, v16
  v_mul_f32 v3, v3, v17
  v_cvt_pk_bf16_f32 v2, v2, v3
  v_dot2_f32_bf16 v8, v2, v15, v8
  v_lshlrev_b32 v2, 16, v11
  v_and_b32 v3, 0xffff0000, v11
  v_mul_f32 v2, v2, v18
  v_mul_f32 v3, v3, v19
  v_cvt_pk_bf16_f32 v2, v2, v3
  v_dot2_f32_bf16 v8, v2, v15, v8
  v_lshlrev_b32 v2, 16, v12
  v_and_b32 v3, 0xffff0000, v12
  v_mul_f32 v2, v2, v20
  v_mul_f32 v3, v3, v21
  v_cvt_pk_bf16_f32 v2, v2, v3
  v_dot2_f32_bf16 v8, v2, v15, v8
  v_lshlrev_b32 v2, 16, v13
  v_and_b32 v3, 0xffff0000, v13
  v_mul_f32 v2, v2, v22
  v_mul_f32 v3, v3, v23
  v_cvt_pk_bf16_f32 v2, v2, v3
  v_dot2_f32_bf16 v8, v2, v15, v8
  s_barrier
  s_barrier
  ds_read_b128 v[10:13], v6 offset:32768
  s_waitcnt lgkmcnt(0)
  v_lshlrev_b32 v2, 16, v10
  v_and_b32 v3, 0xffff0000, v10
  v_mul_f32 v2, v2, v24
  v_mul_f32 v3, v3, v25
  v_cvt_pk_bf16_f32 v2, v2, v3
  v_dot2_f32_bf16 v8, v2, v15, v8
  v_lshlrev_b32 v2, 16, v11
  v_and_b32 v3, 0xffff0000, v11
  v_mul_f32 v2, v2, v26
  v_mul_f32 v3, v3, v27
  v_cvt_pk_bf16_f32 v2, v2, v3
  v_dot2_f32_bf16 v8, v2, v15, v8
  v_lshlrev_b32 v2, 16, v12
  v_and_b32 v3, 0xffff0000, v12
  v_mul_f32 v2, v2, v28
  v_mul_f32 v3, v3, v29
  v_cvt_pk_bf16_f32 v2, v2, v3
  v_dot2_f32_bf16 v8, v2, v15, v8
  v_lshlrev_b32 v2, 16, v13
  v_and_b32 v3, 0xffff0000, v13
  v_mul_f32 v2, v2, v30
  v_mul_f32 v3, v3, v31
  v_cvt_pk_bf16_f32 v2, v2, v3
  v_dot2_f32_bf16 v8, v2, v15, v8
  s_barrier
  s_barrier
  ds_read_b128 v[10:13], v9
  s_waitcnt lgkmcnt(0)
  v_lshlrev_b32 v2, 16, v10
  v_and_b32 v3, 0xffff0000, v10
  v_mul_f32 v2, v2, v32
  v_mul_f32 v3, v3, v33
  v_cvt_pk_bf16_f32 v2, v2, v3
  v_dot2_f32_bf16 v8, v2, v15, v8
  v_lshlrev_b32 v2, 16, v11
  v_and_b32 v3, 0xffff0000, v11
  v_mul_f32 v2, v2, v34
  v_mul_f32 v3, v3, v35
  v_cvt_pk_bf16_f32 v2, v2, v3
  v_dot2_f32_bf16 v8, v2, v15, v8
  v_lshlrev_b32 v2, 16, v12
  v_and_b32 v3, 0xffff0000, v12
  v_mul_f32 v2, v2, v36
  v_mul_f32 v3, v3, v37
  v_cvt_pk_bf16_f32 v2, v2, v3
  v_dot2_f32_bf16 v8, v2, v15, v8
  v_lshlrev_b32 v2, 16, v13
  v_and_b32 v3, 0xffff0000, v13
  v_mul_f32 v2, v2, v38
  v_mul_f32 v3, v3, v39
  v_cvt_pk_bf16_f32 v2, v2, v3
  v_dot2_f32_bf16 v8, v2, v15, v8
  s_barrier
  s_barrier
  ds_read_b128 v[10:13], v6 offset:0
  s_waitcnt lgkmcnt(0)
  v_lshlrev_b32 v2, 16, v10
  v_and_b32 v3, 0xffff0000, v10
  v_mul_f32 v2, v2, v40
  v_mul_f32 v3, v3, v41
  v_cvt_pk_bf16_f32 v2, v2, v3
  v_dot2_f32_bf16 v8, v2, v15, v8
  v_lshlrev_b32 v2, 16, v11
  v_and_b32 v3, 0xffff0000, v11
  v_mul_f32 v2, v2, v42
  v_mul_f32 v3, v3, v43
  v_cvt_pk_bf16_f32 v2, v2, v3
  v_dot2_f32_bf16 v8, v2, v15, v8
  v_lshlrev_b32 v2, 16, v12
  v_and_b32 v3, 0xffff0000, v12
  v_mul_f32 v2, v2, v44
  v_mul_f32 v3, v3, v45
  v_cvt_pk_bf16_f32 v2, v2, v3
  v_dot2_f32_bf16 v8, v2, v15, v8
  v_lshlrev_b32 v2, 16, v13
  v_and_b32 v3, 0xffff0000, v13
  v_mul_f32 v2, v2, v46
  v_mul_f32 v3, v3, v47
  v_cvt_pk_bf16_f32 v2, v2, v3
  v_dot2_f32_bf16 v8, v2, v15, v8
  s_barrier
  s_barrier
  ds_read_b128 v[10:13], v6 offset:32768
  s_waitcnt lgkmcnt(0)
  v_lshlrev_b32 v2, 16, v10
  v_and_b32 v3, 0xffff0000, v10
  v_mul_f32 v2, v2, v48
  v_mul_f32 v3, v3, v49
  v_cvt_pk_bf16_f32 v2, v2, v3
  v_dot2_f32_bf16 v8, v2, v15, v8
  v_lshlrev_b32 v2, 16, v11
  v_and_b32 v3, 0xffff0000, v11
  v_mul_f32 v2, v2, v50
  v_mul_f32 v3, v3, v51
  v_cvt_pk_bf16_f32 v2, v2, v3
  v_dot2_f32_bf16 v8, v2, v15, v8
  v_lshlrev_b32 v2, 16, v12
  v_and_b32 v3, 0xffff0000, v12
  v_mul_f32 v2, v2, v52
  v_mul_f32 v3, v3, v53
  v_cvt_pk_bf16_f32 v2, v2, v3
  v_dot2_f32_bf16 v8, v2, v15, v8
  v_lshlrev_b32 v2, 16, v13
  v_and_b32 v3, 0xffff0000, v13
  v_mul_f32 v2, v2, v54
  v_mul_f32 v3, v3, v55
  v_cvt_pk_bf16_f32 v2, v2, v3
  v_dot2_f32_bf16 v8, v2, v15, v8
  s_barrier
  s_barrier
  ds_read_b128 v[10:13], v9
  s_waitcnt lgkmcnt(0)
  v_lshlrev_b32 v2, 16, v10
  v_and_b32 v3, 0xffff0000, v10
  v_mul_f32 v2, v2, v56
  v_mul_f32 v3, v3, v57
  v_cvt_pk_bf16_f32 v2, v2, v3
  v_dot2_f32_bf16 v8, v2, v15, v8
  v_lshlrev_b32 v2, 16, v11
  v_and_b32 v3, 0xffff0000, v11
  v_mul_f32 v2, v2, v58
  v_mul_f32 v3, v3, v59
  v_cvt_pk_bf16_f32 v2, v2, v3
  v_dot2_f32_bf16 v8, v2, v15, v8
  v_lshlrev_b32 v2, 16, v12
  v_and_b32 v3, 0xffff0000, v12
  v_mul_f32 v2, v2, v60
  v_mul_f32 v3, v3, v61
  v_cvt_pk_bf16_f32 v2, v2, v3
  v_dot2_f32_bf16 v8, v2, v15, v8
  v_lshlrev_b32 v2, 16, v13
  v_and_b32 v3, 0xffff0000, v13
  v_mul_f32 v2, v2, v62
  v_mul_f32 v3, v3, v63
  v_cvt_pk_bf16_f32 v2, v2, v3
  v_dot2_f32_bf16 v8, v2, v15, v8
  s_barrier
  s_barrier
  ds_read_b128 v[10:13], v6 offset:0
  s_waitcnt lgkmcnt(0)
  v_lshlrev_b32 v2, 16, v10
  v_and_b32 v3, 0xffff0000, v10
  v_mul_f32 v2, v2, v64
  v_mul_f32 v3, v3, v65
  v_cvt_pk_bf16_f32 v2, v2, v3
  v_dot2_f32_bf16 v8, v2, v15, v8
  v_lshlrev_b32 v2, 16, v11
  v_and_b32 v3, 0xffff0000, v11
  v_mul_f32 v2, v2, v66
  v_mul_f32 v3, v3, v67
  v_cvt_pk_bf16_f32 v2, v2, v3
  v_dot2_f32_bf16 v8, v2, v15, v8
  v_lshlrev_b32 v2, 16, v12
  v_and_b32 v3, 0xffff0000, v12
  v_mul_f32 v2, v2, v68
  v_mul_f32 v3, v3, v69
  v_cvt_pk_bf16_f32 v2, v2, v3
  v_dot2_f32_bf16 v8, v2, v15, v8
  v_lshlrev_b32 v2, 16, v13
  v_and_b32 v3, 0xffff0000, v13
  v_mul_f32 v2, v2, v70
  v_mul_f32 v3, v3, v71
  v_cvt_pk_bf16_f32 v2, v2, v3
  v_dot2_f32_bf16 v8, v2, v15, v8
  s_barrier
  s_barrier
  ds_read_b128 v[10:13], v6 offset:32768
  s_waitcnt lgkmcnt(0)
  v_lshlrev_b32 v2, 16, v10
  v_and_b32 v3, 0xffff0000, v10
  v_mul_f32 v2, v2, v72
  v_mul_f32 v3, v3, v73
  v_cvt_pk_bf16_f32 v2, v2, v3
  v_dot2_f32_bf16 v8, v2, v15, v8
  v_lshlrev_b32 v2, 16, v11
  v_and_b32 v3, 0xffff0000, v11
  v_mul_f32 v2, v2, v74
  v_mul_f32 v3, v3, v75
  v_cvt_pk_bf16_f32 v2, v2, v3
  v_dot2_f32_bf16 v8, v2, v15, v8
  v_lshlrev_b32 v2, 16, v12
  v_and_b32 v3, 0xffff0000, v12
  v_mul_f32 v2, v2, v76
  v_mul_f32 v3, v3, v77
  v_cvt_pk_bf16_f32 v2, v2, v3
  v_dot2_f32_bf16 v8, v2, v15, v8
  v_lshlrev_b32 v2, 16, v13
  v_and_b32 v3, 0xffff0000, v13
  v_mul_f32 v2, v2, v78
  v_mul_f32 v3, v3, v79
  v_cvt_pk_bf16_f32 v2, v2, v3
  v_dot2_f32_bf16 v8, v2, v15, v8
  s_barrier
  s_barrier
  ds_read_b128 v[10:13], v9
  s_waitcnt lgkmcnt(0)
  v_lshlrev_b32 v2, 16, v10
  v_and_b32 v3, 0xffff0000, v10
  v_mul_f32 v2, v2, v80
  v_mul_f32 v3, v3, v81
  v_cvt_pk_bf16_f32 v2, v2, v3
  v_dot2_f32_bf16 v8, v2, v15, v8
  v_lshlrev_b32 v2, 16, v11
  v_and_b32 v3, 0xffff0000, v11
  v_mul_f32 v2, v2, v82
  v_mul_f32 v3, v3, v83
  v_cvt_pk_bf16_f32 v2, v2, v3
  v_dot2_f32_bf16 v8, v2, v15, v8
  v_lshlrev_b32 v2, 16, v12
  v_and_b32 v3, 0xffff0000, v12
  v_mul_f32 v2, v2, v84
  v_mul_f32 v3, v3, v85
  v_cvt_pk_bf16_f32 v2, v2, v3
  v_dot2_f32_bf16 v8, v2, v15, v8
  v_lshlrev_b32 v2, 16, v13
  v_and_b32 v3, 0xffff0000, v13
  v_mul_f32 v2, v2, v86
  v_mul_f32 v3, v3, v87
  v_cvt_pk_bf16_f32 v2, v2, v3
  v_dot2_f32_bf16 v8, v2, v15, v8
  s_barrier
  s_barrier
  ds_read_b128 v[10:13], v6 offset:0
  s_waitcnt lgkmcnt(0)
  v_lshlrev_b32 v2, 16, v10
  v_and_b32 v3, 0xffff0000, v10
  v_mul_f32 v2, v2, v88
  v_mul_f32 v3, v3, v89
  v_cvt_pk_bf16_f32 v2, v2, v3
  v_dot2_f32_bf16 v8, v2, v15, v8
  v_lshlrev_b32 v2, 16, v11
  v_and_b32 v3, 0xffff0000, v11
  v_mul_f32 v2, v2, v90
  v_mul_f32 v3, v3, v91
  v_cvt_pk_bf16_f32 v2, v2, v3
  v_dot2_f32_bf16 v8, v2, v15, v8
  v_lshlrev_b32 v2, 16, v12
  v_and_b32 v3, 0xffff0000, v12
  v_mul_f32 v2, v2, v92
  v_mul_f32 v3, v3, v93
  v_cvt_pk_bf16_f32 v2, v2, v3
  v_dot2_f32_bf16 v8, v2, v15, v8
  v_lshlrev_b32 v2, 16, v13
  v_and_b32 v3, 0xffff0000, v13
  v_mul_f32 v2, v2, v94
  v_mul_f32 v3, v3, v95
  v_cvt_pk_bf16_f32 v2, v2, v3
  v_dot2_f32_bf16 v8, v2, v15, v8
  s_barrier
  s_barrier
  ds_read_b128 v[10:13], v6 offset:32768
  s_waitcnt lgkmcnt(0)
  v_lshlrev_b32 v2, 16, v10
  v_and_b32 v3, 0xffff0000, v10
  v_mul_f32 v2, v2, v96
  v_mul_f32 v3, v3, v97
  v_cvt_pk_bf16_f32 v2, v2, v3
  v_dot2_f32_bf16 v8, v2, v15, v8
  v_lshlrev_b32 v2, 16, v11
  v_and_b32 v3, 0xffff0000, v11
  v_mul_f32 v2, v2, v98
  v_mul_f32 v3, v3, v99
  v_cvt_pk_bf16_f32 v2, v2, v3
  v_dot2_f32_bf16 v8, v2, v15, v8
  v_lshlrev_b32 v2, 16, v12
  v_and_b32 v3, 0xffff0000, v12
  v_mul_f32 v2, v2, v100
  v_mul_f32 v3, v3, v101
  v_cvt_pk_bf16_f32 v2, v2, v3
  v_dot2_f32_bf16 v8, v2, v15, v8
  v_lshlrev_b32 v2, 16, v13
  v_and_b32 v3, 0xffff0000, v13
  v_mul_f32 v2, v2, v102
  v_mul_f32 v3, v3, v103
  v_cvt_pk_bf16_f32 v2, v2, v3
  v_dot2_f32_bf16 v8, v2, v15, v8
  s_barrier
  s_barrier
  ds_read_b128 v[10:13], v9
  s_waitcnt lgkmcnt(0)
  v_lshlrev_b32 v2, 16, v10
  v_and_b32 v3, 0xffff0000, v10
  v_mul_f32 v2, v2, v104
  v_mul_f32 v3, v3, v105
  v_cvt_pk_bf16_f32 v2, v2, v3
  v_dot2_f32_bf16 v8, v2, v15, v8
  v_lshlrev_b32 v2, 16, v11
  v_and_b32 v3, 0xffff0000, v11
  v_mul_f32 v2, v2, v106
  v_mul_f32 v3, v3, v107
  v_cvt_pk_bf16_f32 v2, v2, v3
  v_dot2_f32_bf16 v8, v2, v15, v8
  v_lshlrev_b32 v2, 16, v12
  v_and_b32 v3, 0xffff0000, v12
  v_mul_f32 v2, v2, v108
  v_mul_f32 v3, v3, v109
  v_cvt_pk_bf16_f32 v2, v2, v3
  v_dot2_f32_bf16 v8, v2, v15, v8
  v_lshlrev_b32 v2, 16, v13
  v_and_b32 v3, 0xffff0000, v13
  v_mul_f32 v2, v2, v110
  v_mul_f32 v3, v3, v111
  v_cvt_pk_bf16_f32 v2, v2, v3
  v_dot2_f32_bf16 v8, v2, v15, v8
  s_barrier
  s_barrier
  ds_read_b128 v[10:13], v6 offset:0
  s_waitcnt lgkmcnt(0)
  v_lshlrev_b32 v2, 16, v10
  v_and_b32 v3, 0xffff0000, v10
  v_mul_f32 v2, v2, v112
  v_mul_f32 v3, v3, v113
  v_cvt_pk_bf16_f32 v2, v2, v3
  v_dot2_f32_bf16 v8, v2, v15, v8
  v_lshlrev_b32 v2, 16, v11
  v_and_b32 v3, 0xffff0000, v11
  v_mul_f32 v2, v2, v114
  v_mul_f32 v3, v3, v115
  v_cvt_pk_bf16_f32 v2, v2, v3
  v_dot2_f32_bf16 v8, v2, v15, v8
  v_lshlrev_b32 v2, 16, v12
  v_and_b32 v3, 0xffff0000, v12
  v_mul_f32 v2, v2, v116
  v_mul_f32 v3, v3, v117
  v_cvt_pk_bf16_f32 v2, v2, v3
  v_dot2_f32_bf16 v8, v2, v15, v8
  v_lshlrev_b32 v2, 16, v13
  v_and_b32 v3, 0xffff0000, v13
  v_mul_f32 v2, v2, v118
  v_mul_f32 v3, v3, v119
  v_cvt_pk_bf16_f32 v2, v2, v3
  v_dot2_f32_bf16 v8, v2, v15, v8
  s_barrier
  s_barrier
  ds_read_b128 v[10:13], v6 offset:32768
  s_waitcnt lgkmcnt(0)
  v_lshlrev_b32 v2, 16, v10
  v_and_b32 v3, 0xffff0000, v10
  v_mul_f32 v2, v2, v120
  v_mul_f32 v3, v3, v121
  v_cvt_pk_bf16_f32 v2, v2, v3
  v_dot2_f32_bf16 v8, v2, v15, v8
  v_lshlrev_b32 v2, 16, v11
  v_and_b32 v3, 0xffff0000, v11
  v_mul_f32 v2, v2, v122
  v_mul_f32 v3, v3, v123
  v_cvt_pk_bf16_f32 v2, v2, v3
  v_dot2_f32_bf16 v8, v2, v15, v8
  v_lshlrev_b32 v2, 16, v12
  v_and_b32 v3, 0xffff0000, v12
  v_mul_f32 v2, v2, v124
  v_mul_f32 v3, v3, v125
  v_cvt_pk_bf16_f32 v2, v2, v3
  v_dot2_f32_bf16 v8, v2, v15, v8
  v_lshlrev_b32 v2, 16, v13
  v_and_b32 v3, 0xffff0000, v13
  v_mul_f32 v2, v2, v126
  v_mul_f32 v3, v3, v127
  v_cvt_pk_bf16_f32 v2, v2, v3
  v_dot2_f32_bf16 v8, v2, v15, v8
  s_barrier
  s_barrier
  ds_read_b128 v[10:13], v9
  s_waitcnt lgkmcnt(0)
  v_lshlrev_b32 v2, 16, v10
  v_and_b32 v3, 0xffff0000, v10
  v_mul_f32 v2, v2, v128
  v_mul_f32 v3, v3, v129
  v_cvt_pk_bf16_f32 v2, v2, v3
  v_dot2_f32_bf16 v8, v2, v15, v8
  v_lshlrev_b32 v2, 16, v11
  v_and_b32 v3, 0xffff0000, v11
  v_mul_f32 v2, v2, v130
  v_mul_f32 v3, v3, v131
  v_cvt_pk_bf16_f32 v2, v2, v3
  v_dot2_f32_bf16 v8, v2, v15, v8
  v_lshlrev_b32 v2, 16, v12
  v_and_b32 v3, 0xffff0000, v12
  v_mul_f32 v2, v2, v132
  v_mul_f32 v3, v3, v133
  v_cvt_pk_bf16_f32 v2, v2, v3
  v_dot2_f32_bf16 v8, v2, v15, v8
  v_lshlrev_b32 v2, 16, v13
  v_and_b32 v3, 0xffff0000, v13
  v_mul_f32 v2, v2, v134
  v_mul_f32 v3, v3, v135
  v_cvt_pk_bf16_f32 v2, v2, v3
  v_dot2_f32_bf16 v8, v2, v15, v8
  s_barrier
  s_barrier
  ds_read_b128 v[10:13], v6 offset:0
  s_waitcnt lgkmcnt(0)
  v_lshlrev_b32 v2, 16, v10
  v_and_b32 v3, 0xffff0000, v10
  v_mul_f32 v2, v2, v136
  v_mul_f32 v3, v3, v137
  v_cvt_pk_bf16_f32 v2, v2, v3
  v_dot2_f32_bf16 v8, v2, v15, v8
  v_lshlrev_b32 v2, 16, v11
  v_and_b32 v3, 0xffff0000, v11
  v_mul_f32 v2, v2, v138
  v_mul_f32 v3, v3, v139
  v_cvt_pk_bf16_f32 v2, v2, v3
  v_dot2_f32_bf16 v8, v2, v15, v8
  v_lshlrev_b32 v2, 16, v12
  v_and_b32 v3, 0xffff0000, v12
  v_mul_f32 v2, v2, v140
  v_mul_f32 v3, v3, v141
  v_cvt_pk_bf16_f32 v2, v2, v3
  v_dot2_f32_bf16 v8, v2, v15, v8
  v_lshlrev_b32 v2, 16, v13
  v_and_b32 v3, 0xffff0000, v13
  v_mul_f32 v2, v2, v142
  v_mul_f32 v3, v3, v143
  v_cvt_pk_bf16_f32 v2, v2, v3
  v_dot2_f32_bf16 v8, v2, v15, v8
  s_barrier
  s_nop 4
  v_add_f32_dpp v8, v8, v8 quad_perm:[1,0,3,2] row_mask:0xf bank_mask:0xf
  s_nop 1
  v_add_f32_dpp v8, v8, v8 quad_perm:[2,3,0,1] row_mask:0xf bank_mask:0xf
  s_nop 1
  v_add_f32_dpp v8, v8, v8 row_half_mirror row_mask:0xf bank_mask:0xf
  s_nop 1
  v_cvt_pk_bf16_f32 v7, v8, v8
  v_lshlrev_b32 v7, 16, v7
  v_mul_f32 v3, 0xbfb8aa3b, v7
  v_exp_f32 v3, v3
  s_nop 0
  v_add_f32 v3, 1.0, v3
  v_rcp_f32 v3, v3
  s_nop 0
  v_cvt_pk_bf16_f32 v3, v3, v3
  v_lshlrev_b32 v3, 16, v3
  v_sub_f32 v4, 1.0, v3
  v_cvt_pk_bf16_f32 v4, v4, v4
  v_lshlrev_b32 v4, 16, v4
  v_lshlrev_b32 v5, 2, v5
  v_mov_b32 v6, 0x7f000000
  v_and_b32 v2, 7, v1
  v_cmp_eq_u32 vcc, 0, v2
  s_nop 1
  v_cndmask_b32 v5, v6, v5, vcc
  s_mov_b32 s48, 33554432
  s_add_u32 s49, s48, 8192
  buffer_store_dword v3, v5, s[16:19], s48 offen sc1
  buffer_store_dword v4, v5, s[16:19], s49 offen sc1
L_qkv_kernel_end:
  s_endpgm
.section .rodata,"a"
.p2align 6
.amdhsa_kernel qkv_kernel
  .amdhsa_next_free_vgpr 256
  .amdhsa_next_free_sgpr 96
  .amdhsa_accum_offset 256
  .amdhsa_group_segment_fixed_size 0
  .amdhsa_kernarg_size 80
  .amdhsa_user_sgpr_count 2
  .amdhsa_user_sgpr_kernarg_segment_ptr 1
  .amdhsa_system_sgpr_workgroup_id_x 1
  .amdhsa_float_denorm_mode_32 3
.end_amdhsa_kernel
.text
.text
.globl att_kernel
.p2align 8
.type att_kernel,@function
att_kernel:
  s_cmp_lt_u32 s2, 256
  s_cbranch_scc1 L_att_kernel_go
  s_endpgm
L_att_kernel_go:
  s_load_dwordx2 s[60:61], s[0:1], 16
  s_load_dwordx2 s[62:63], s[0:1], 40
  s_load_dwordx2 s[4:5], s[0:1], 72
  v_and_b32 v1, 63, v0
  v_lshrrev_b32 v6, 6, v0
  s_and_b32 s20, s2, 7
  v_readfirstlane_b32 s12, v6
  s_lshr_b32 s21, s2, 3
  s_and_b32 s22, s21, 3
  s_lshl_b32 s15, s20, 2
  s_add_u32 s15, s15, s22
  s_lshr_b32 s16, s21, 2
  s_lshr_b32 s13, s12, 2
  s_and_b32 s14, s12, 3
  v_lshlrev_b32 v2, 4, v1
  s_lshl_b32 s20, s15, 17
  s_lshl_b32 s21, s16, 3
  s_lshl_b32 s22, s14, 1
  s_add_u32 s21, s21, s22
  s_add_u32 s33, s21, s13
  s_lshl_b32 s21, s21, 11
  s_add_u32 s32, s20, s21
  s_bfe_u32 s22, s12, 0x10001
  s_add_u32 s22, s22, 1
  s_mul_i32 s22, s22, 4194304
  s_add_u32 s17, s20, s22
  s_lshl_b32 s22, s13, 16
  s_add_u32 s17, s17, s22
  s_and_b32 s22, s12, 1
  s_lshl_b32 s22, s22, 10
  s_add_u32 s17, s17, s22
  s_lshl_b32 s18, s12, 10
  s_lshl_b32 s22, s13, 12
  v_add_u32 v3, s22, v2
  v_add_u32 v4, 0x10000, v3
  s_cmp_eq_u32 s12, 7
  s_cbranch_scc0 L_att_kernel_mk
  v_and_b32 v52, 15, v1
  v_lshrrev_b32 v53, 4, v1
  v_lshlrev_b32 v53, 2, v53
  v_sub_u32 v52, v52, v53
  s_cmp_eq_u32 s16, 0
  s_cselect_b32 s24, 2, 0x80000000
  v_mov_b32 v54, 0xff800000
  v_subrev_u32 v36, 0, v52
  v_subrev_u32 v37, 1, v52
  v_subrev_u32 v38, 2, v52
  v_subrev_u32 v39, 3, v52
  v_and_b32 v36, 0x80000001, v36
  v_and_b32 v37, 0x80000001, v37
  v_and_b32 v38, 0x80000001, v38
  v_and_b32 v39, 0x80000001, v39
  v_cmp_eq_u32 s[40:41], 0, v36
  v_cmp_eq_u32 s[42:43], s24, v36
  v_cmp_eq_u32 s[44:45], 0, v37
  v_cmp_eq_u32 s[46:47], s24, v37
  v_cmp_eq_u32 s[48:49], 0, v38
  v_cmp_eq_u32 s[50:51], s24, v38
  v_cmp_eq_u32 s[52:53], 0, v39
  v_cmp_eq_u32 s[54:55], s24, v39
  v_cndmask_b32 v32, v54, 0, s[40:41]
  v_cndmask_b32 v28, v54, 0, s[42:43]
  v_cndmask_b32 v33, v54, 0, s[44:45]
  v_cndmask_b32 v29, v54, 0, s[46:47]
  v_cndmask_b32 v34, v54, 0, s[48:49]
  v_cndmask_b32 v30, v54, 0, s[50:51]
  v_cndmask_b32 v35, v54, 0, s[52:53]
  v_cndmask_b32 v31, v54, 0, s[54:55]
  v_mov_b32 v56, 0x3f803f80
  v_mov_b32 v57, 0x3f803f80
  v_mov_b32 v58, 0x3f803f80
  v_mov_b32 v59, 0x3f803f80
  s_mov_b32 s26, 0x3e8293ee
  s_mov_b32 s27, 0x3e8293ee
  s_lshl_b32 s28, s16, 20
  s_add_u32 s29, s15, 32
  s_lshl_b32 s29, s29, 11
  s_add_u32 s28, s28, s29
  s_add_u32 s28, s28, 25165824
L_att_kernel_mk:
  s_waitcnt lgkmcnt(0)
  s_mov_b32 s8, s4
  s_and_b32 s9, s5, 0xffff
  s_mov_b32 s10, 0x3000000
  s_mov_b32 s11, 0x20000
  s_lshr_b32 s68, s2, 3
  s_cmp_lt_u32 s68, 16
  s_cselect_b32 s60, s60, s62
  s_cselect_b32 s61, s61, s63
  s_and_b32 s68, s68, 15
  s_lshl_b32 s68, s68, 6
  s_lshl_b32 s69, s12, 3
  s_add_u32 s68, s68, s69
  s_lshl_b32 s68, s68, 11
  s_and_b32 s69, s2, 1
  s_lshl_b32 s69, s69, 10
  s_add_u32 s68, s68, s69
  s_mov_b32 s64, s60
  s_and_b32 s65, s61, 0xffff
  s_mov_b32 s66, 0x200000
  s_mov_b32 s67, 0x20000
  s_cmp_eq_u32 s12, 7
  s_cbranch_scc0 L_att_kernel_m0
  s_mul_i32 s20, s15, 40960
  s_mul_i32 s21, s16, 5120
  s_add_u32 s20, s20, s21
  s_add_u32 s20, s20, 34603008
  s_movk_i32 s21, 1024
  s_cmp_eq_u32 s16, 0
  s_cselect_b32 s21, s21, 4294965248
  s_add_u32 s21, s21, s20
  s_add_u32 s22, s21, 1024
  s_add_u32 s23, s20, 2048
  v_lshlrev_b32 v6, 3, v1
  buffer_load_dwordx4 v[8:11], v2, s[8:11], s20 offen
  buffer_load_dwordx4 v[12:15], v2, s[8:11], s20 offen offset:1024
  buffer_load_dwordx4 v[16:19], v2, s[8:11], s21 offen
  buffer_load_dwordx2 v[20:21], v6, s[8:11], s22 offen
  buffer_load_dwordx2 v[22:23], v6, s[8:11], s23 offen
  buffer_load_dwordx2 v[24:25], v6, s[8:11], s22 offen offset:512
  buffer_load_dwordx2 v[26:27], v6, s[8:11], s23 offen offset:512
L_att_kernel_m0:
  buffer_load_dwordx4 a[0:3], v2, s[8:11], s32 offen offset:0
  buffer_load_dwordx4 a[4:7], v2, s[8:11], s32 offen offset:1024
  buffer_load_dwordx4 a[8:11], v2, s[8:11], s32 offen offset:2048
  buffer_load_dwordx4 a[12:15], v2, s[8:11], s32 offen offset:3072
  s_add_u32 m0, s18, 0
  s_add_u32 s19, s17, 0
  buffer_load_dwordx4 v2, s[8:11], s19 offen lds
  s_add_u32 m0, s18, 8192
  s_add_u32 s19, s17, 2048
  buffer_load_dwordx4 v2, s[8:11], s19 offen lds
  s_add_u32 m0, s18, 16384
  s_add_u32 s19, s17, 4096
  buffer_load_dwordx4 v2, s[8:11], s19 offen lds
  s_add_u32 m0, s18, 24576
  s_add_u32 s19, s17, 6144
  buffer_load_dwordx4 v2, s[8:11], s19 offen lds
  s_cmp_eq_u32 s12, 7
  s_cbranch_scc0 L_att_kernel_m1
  v_and_b32 v60, 15, v1
  v_lshrrev_b32 v61, 4, v1
  v_lshlrev_b32 v60, 4, v60
  v_lshlrev_b32 v61, 9, v61
  v_add_u32 v60, v60, v61
  v_and_b32 v6, 31, v1
  v_lshlrev_b32 v116, 2, v6
  s_lshl_b32 s59, s33, 7
  s_add_u32 s59, s59, 33554432
  v_and_b32 v6, 6, v1
  v_cmp_eq_u32 vcc, 0, v6
  v_cmp_eq_u32 s[20:21], 4, v6
  v_mov_b32 v6, 0x3f803f80
  v_and_b32 v7, 1, v1
  v_mul_u32_u24 v7, 0xa, v7
  v_add_u32 v7, 4, v7
  v_mul_u32_u24 v117, 0x1111, v7
  v_lshl_or_b32 v117, v117, 16, v117
  v_cndmask_b32 v7, 0, v6, vcc
  v_cndmask_b32 v6, 0, v6, s[20:21]
  v_accvgpr_write_b32 a92, v7
  v_accvgpr_write_b32 a93, v7
  v_accvgpr_write_b32 a94, v6
  v_accvgpr_write_b32 a95, v6
  v_accvgpr_write_b32 a80, 0
  v_accvgpr_write_b32 a81, 0
  v_accvgpr_write_b32 a82, 0
  v_accvgpr_write_b32 a83, 0
  v_accvgpr_write_b32 a84, 0
  v_accvgpr_write_b32 a85, 0
  v_accvgpr_write_b32 a86, 0
  v_accvgpr_write_b32 a87, 0
  s_waitcnt vmcnt(0)
  s_barrier
  s_waitcnt vmcnt(0)
  v_mfma_f32_16x16x32_bf16 v[36:39], v[16:19], v[8:11], v[28:31]
  v_mfma_f32_16x16x32_bf16 v[40:43], v[12:15], v[8:11], v[32:35]
  s_nop 7
  v_max3_f32 v52, v36, v37, v38
  v_max3_f32 v53, v40, v41, v42
  v_max3_f32 v52, v39, v43, v52
  v_max_f32 v52, v52, v53
  v_mov_b32 v53, v52
  s_nop 1
  v_permlane32_swap_b32 v52, v53
  v_max_f32 v52, v52, v53
  v_mov_b32 v53, v52
  s_nop 1
  v_permlane16_swap_b32 v52, v53
  v_max_f32 v52, v52, v53
  v_mul_f32 v52, s26, v52
  v_pk_fma_f32 v[36:37], v[36:37], s[26:27], v[52:53] op_sel_hi:[1,1,0] neg_lo:[0,0,1] neg_hi:[0,0,1]
  v_pk_fma_f32 v[38:39], v[38:39], s[26:27], v[52:53] op_sel_hi:[1,1,0] neg_lo:[0,0,1] neg_hi:[0,0,1]
  v_pk_fma_f32 v[40:41], v[40:41], s[26:27], v[52:53] op_sel_hi:[1,1,0] neg_lo:[0,0,1] neg_hi:[0,0,1]
  v_pk_fma_f32 v[42:43], v[42:43], s[26:27], v[52:53] op_sel_hi:[1,1,0] neg_lo:[0,0,1] neg_hi:[0,0,1]
  v_exp_f32 v36, v36
  v_exp_f32 v37, v37
  v_exp_f32 v38, v38
  v_exp_f32 v39, v39
  v_exp_f32 v40, v40
  v_exp_f32 v41, v41
  v_exp_f32 v42, v42
  v_exp_f32 v43, v43
  s_nop 0
  v_cvt_pk_bf16_f32 v44, v36, v37
  v_cvt_pk_bf16_f32 v45, v38, v39
  v_cvt_pk_bf16_f32 v46, v40, v41
  v_cvt_pk_bf16_f32 v47, v42, v43
  s_nop 1
  v_mfma_f32_16x16x32_bf16 v[48:51], v[56:59], v[44:47], 0
  v_mfma_f32_16x16x32_bf16 v[36:39], v[20:23], v[44:47], 0
  v_mfma_f32_16x16x32_bf16 v[40:43], v[24:27], v[44:47], 0
  s_nop 7
  v_rcp_f32 v48, v48
  s_nop 1
  v_pk_mul_f32 v[36:37], v[36:37], v[48:49] op_sel_hi:[1,0]
  v_pk_mul_f32 v[38:39], v[38:39], v[48:49] op_sel_hi:[1,0]
  v_pk_mul_f32 v[40:41], v[40:41], v[48:49] op_sel_hi:[1,0]
  v_pk_mul_f32 v[42:43], v[42:43], v[48:49] op_sel_hi:[1,0]
  v_cvt_pk_bf16_f32 v44, v36, v37
  v_cvt_pk_bf16_f32 v45, v38, v39
  v_cvt_pk_bf16_f32 v46, v40, v41
  v_cvt_pk_bf16_f32 v47, v42, v43
  s_nop 1
  v_permlane32_swap_b32 v44, v46
  v_permlane32_swap_b32 v45, v47
  s_waitcnt vmcnt(0)
  buffer_store_dwordx4 v[44:47], v60, s[8:11], s28 offen sc1
  s_branch L_att_kernel_m2
L_att_kernel_m1:
  v_and_b32 v6, 31, v1
  v_lshlrev_b32 v116, 2, v6
  s_lshl_b32 s59, s33, 7
  s_add_u32 s59, s59, 33554432
  v_and_b32 v6, 6, v1
  v_cmp_eq_u32 vcc, 0, v6
  v_cmp_eq_u32 s[20:21], 4, v6
  v_mov_b32 v6, 0x3f803f80
  v_and_b32 v7, 1, v1
  v_mul_u32_u24 v7, 0xa, v7
  v_add_u32 v7, 4, v7
  v_mul_u32_u24 v117, 0x1111, v7
  v_lshl_or_b32 v117, v117, 16, v117
  v_cndmask_b32 v7, 0, v6, vcc
  v_cndmask_b32 v6, 0, v6, s[20:21]
  v_accvgpr_write_b32 a92, v7
  v_accvgpr_write_b32 a93, v7
  v_accvgpr_write_b32 a94, v6
  v_accvgpr_write_b32 a95, v6
  v_accvgpr_write_b32 a80, 0
  v_accvgpr_write_b32 a81, 0
  v_accvgpr_write_b32 a82, 0
  v_accvgpr_write_b32 a83, 0
  v_accvgpr_write_b32 a84, 0
  v_accvgpr_write_b32 a85, 0
  v_accvgpr_write_b32 a86, 0
  v_accvgpr_write_b32 a87, 0
  s_waitcnt vmcnt(0)
  s_barrier
L_att_kernel_m2:
  ds_read_b128 a[16:19], v3 offset:0
  ds_read_b128 a[20:23], v3 offset:1024
  s_waitcnt lgkmcnt(0)
  v_mfma_f32_32x32x16_bf16 v[8:23], a[16:19], a[0:3], 0
  v_mfma_f32_32x32x16_bf16 v[8:23], a[20:23], a[4:7], v[8:23]
  s_nop 7
  s_nop 3
L_att_kernel_t0:
  ds_read_b128 a[24:27], v3 offset:8192
  v_exp_f32 v8, v8
  v_exp_f32 v9, v9
  v_exp_f32 v10, v10
  v_mfma_f32_32x32x16_bf16 v[24:39], a[16:19], a[8:11], 0
  ds_read_b128 a[28:31], v3 offset:9216
  v_exp_f32 v11, v11
  v_exp_f32 v12, v12
  v_exp_f32 v13, v13
  v_cvt_pk_bf16_f32 v40, v8, v9
  v_cvt_pk_bf16_f32 v41, v10, v11
  ds_read_b128 a[32:35], v3 offset:2048
  v_exp_f32 v14, v14
  v_exp_f32 v15, v15
  v_exp_f32 v16, v16
  v_cvt_pk_bf16_f32 v42, v12, v13
  v_cvt_pk_bf16_f32 v43, v14, v15
  v_mfma_f32_32x32x16_bf16 v[24:39], a[20:23], a[12:15], v[24:39]
  ds_read_b128 a[36:39], v3 offset:3072
  v_exp_f32 v17, v17
  v_exp_f32 v18, v18
  v_exp_f32 v19, v19
  v_cvt_pk_bf16_f32 v44, v16, v17
  v_cvt_pk_bf16_f32 v45, v18, v19
  s_add_u32 m0, s18, 32768
  s_add_u32 s19, s17, 8192
  buffer_load_dwordx4 v2, s[8:11], s19 offen lds
  v_exp_f32 v20, v20
  v_exp_f32 v21, v21
  v_exp_f32 v22, v22
  v_exp_f32 v23, v23
  s_add_u32 m0, s18, 40960
  s_add_u32 s19, s17, 10240
  buffer_load_dwordx4 v2, s[8:11], s19 offen lds
  s_waitcnt lgkmcnt(0)
  v_mfma_f32_32x32x16_bf16 a[48:63], a[32:35], v[40:43], 0
  v_cvt_pk_bf16_f32 v46, v20, v21
  v_cvt_pk_bf16_f32 v47, v22, v23
  v_exp_f32 v24, v24
  v_exp_f32 v25, v25
  v_exp_f32 v26, v26
  v_mfma_f32_32x32x16_bf16 v[8:23], a[24:27], a[0:3], 0
  s_add_u32 m0, s18, 49152
  s_add_u32 s19, s17, 12288
  buffer_load_dwordx4 v2, s[8:11], s19 offen lds
  v_exp_f32 v27, v27
  v_exp_f32 v28, v28
  v_exp_f32 v29, v29
  v_cvt_pk_bf16_f32 v48, v24, v25
  v_cvt_pk_bf16_f32 v49, v26, v27
  v_smfmac_f32_16x16x64_bf16 a[80:83], a[92:95], v[40:47], v117
  v_exp_f32 v30, v30
  v_exp_f32 v31, v31
  v_exp_f32 v32, v32
  v_cvt_pk_bf16_f32 v50, v28, v29
  v_cvt_pk_bf16_f32 v51, v30, v31
  v_mfma_f32_32x32x16_bf16 v[8:23], a[28:31], a[4:7], v[8:23]
  s_add_u32 m0, s18, 57344
  s_add_u32 s19, s17, 14336
  buffer_load_dwordx4 v2, s[8:11], s19 offen lds
  v_exp_f32 v33, v33
  v_exp_f32 v34, v34
  v_exp_f32 v35, v35
  v_cvt_pk_bf16_f32 v52, v32, v33
  v_cvt_pk_bf16_f32 v53, v34, v35
  v_mfma_f32_32x32x16_bf16 a[48:63], a[36:39], v[44:47], a[48:63]
  v_exp_f32 v36, v36
  v_exp_f32 v37, v37
  v_exp_f32 v38, v38
  v_exp_f32 v39, v39
L_att_kernel_t1:
  v_mfma_f32_32x32x16_bf16 a[64:79], a[32:35], v[48:51], 0
  ds_read_b128 a[16:19], v3 offset:16384
  v_cvt_pk_bf16_f32 v54, v36, v37
  v_cvt_pk_bf16_f32 v55, v38, v39
  v_exp_f32 v8, v8
  v_exp_f32 v9, v9
  v_exp_f32 v10, v10
  v_mfma_f32_32x32x16_bf16 v[24:39], a[24:27], a[8:11], 0
  ds_read_b128 a[20:23], v3 offset:17408
  v_exp_f32 v11, v11
  v_exp_f32 v12, v12
  v_exp_f32 v13, v13
  v_cvt_pk_bf16_f32 v40, v8, v9
  v_cvt_pk_bf16_f32 v41, v10, v11
  v_smfmac_f32_16x16x64_bf16 a[84:87], a[92:95], v[48:55], v117
  ds_read_b128 a[40:43], v3 offset:10240
  v_exp_f32 v14, v14
  v_exp_f32 v15, v15
  v_exp_f32 v16, v16
  v_cvt_pk_bf16_f32 v42, v12, v13
  v_cvt_pk_bf16_f32 v43, v14, v15
  v_mfma_f32_32x32x16_bf16 v[24:39], a[28:31], a[12:15], v[24:39]
  ds_read_b128 a[44:47], v3 offset:11264
  v_exp_f32 v17, v17
  v_exp_f32 v18, v18
  v_exp_f32 v19, v19
  v_cvt_pk_bf16_f32 v44, v16, v17
  v_cvt_pk_bf16_f32 v45, v18, v19
  v_mfma_f32_32x32x16_bf16 a[64:79], a[36:39], v[52:55], a[64:79]
  s_add_u32 m0, s18, 65536
  s_add_u32 s19, s17, 16384
  buffer_load_dwordx4 v2, s[8:11], s19 offen lds
  v_exp_f32 v20, v20
  v_exp_f32 v21, v21
  v_exp_f32 v22, v22
  v_exp_f32 v23, v23
  s_add_u32 m0, s18, 73728
  s_add_u32 s19, s17, 18432
  buffer_load_dwordx4 v2, s[8:11], s19 offen lds
  s_waitcnt lgkmcnt(0)
  v_mfma_f32_32x32x16_bf16 a[48:63], a[40:43], v[40:43], a[48:63]
  v_cvt_pk_bf16_f32 v46, v20, v21
  v_cvt_pk_bf16_f32 v47, v22, v23
  v_exp_f32 v24, v24
  v_exp_f32 v25, v25
  v_exp_f32 v26, v26
  v_mfma_f32_32x32x16_bf16 v[8:23], a[16:19], a[0:3], 0
  s_add_u32 m0, s18, 81920
  s_add_u32 s19, s17, 20480
  buffer_load_dwordx4 v2, s[8:11], s19 offen lds
  v_exp_f32 v27, v27
  v_exp_f32 v28, v28
  v_exp_f32 v29, v29
  v_cvt_pk_bf16_f32 v48, v24, v25
  v_cvt_pk_bf16_f32 v49, v26, v27
  v_smfmac_f32_16x16x64_bf16 a[80:83], a[92:95], v[40:47], v117
  v_exp_f32 v30, v30
  v_exp_f32 v31, v31
  v_exp_f32 v32, v32
  v_cvt_pk_bf16_f32 v50, v28, v29
  v_cvt_pk_bf16_f32 v51, v30, v31
  v_mfma_f32_32x32x16_bf16 v[8:23], a[20:23], a[4:7], v[8:23]
  s_add_u32 m0, s18, 90112
  s_add_u32 s19, s17, 22528
  buffer_load_dwordx4 v2, s[8:11], s19 offen lds
  v_exp_f32 v33, v33
  v_exp_f32 v34, v34
  v_exp_f32 v35, v35
  v_cvt_pk_bf16_f32 v52, v32, v33
  v_cvt_pk_bf16_f32 v53, v34, v35
  v_mfma_f32_32x32x16_bf16 a[48:63], a[44:47], v[44:47], a[48:63]
  v_exp_f32 v36, v36
  v_exp_f32 v37, v37
  v_exp_f32 v38, v38
  v_exp_f32 v39, v39
L_att_kernel_t2:
  v_mfma_f32_32x32x16_bf16 a[64:79], a[40:43], v[48:51], a[64:79]
  ds_read_b128 a[24:27], v3 offset:24576
  v_cvt_pk_bf16_f32 v54, v36, v37
  v_cvt_pk_bf16_f32 v55, v38, v39
  v_exp_f32 v8, v8
  v_exp_f32 v9, v9
  v_exp_f32 v10, v10
  v_mfma_f32_32x32x16_bf16 v[24:39], a[16:19], a[8:11], 0
  ds_read_b128 a[28:31], v3 offset:25600
  v_exp_f32 v11, v11
  v_exp_f32 v12, v12
  v_exp_f32 v13, v13
  v_cvt_pk_bf16_f32 v40, v8, v9
  v_cvt_pk_bf16_f32 v41, v10, v11
  v_smfmac_f32_16x16x64_bf16 a[84:87], a[92:95], v[48:55], v117
  ds_read_b128 a[32:35], v3 offset:18432
  v_exp_f32 v14, v14
  v_exp_f32 v15, v15
  v_exp_f32 v16, v16
  v_cvt_pk_bf16_f32 v42, v12, v13
  v_cvt_pk_bf16_f32 v43, v14, v15
  v_mfma_f32_32x32x16_bf16 v[24:39], a[20:23], a[12:15], v[24:39]
  ds_read_b128 a[36:39], v3 offset:19456
  v_exp_f32 v17, v17
  v_exp_f32 v18, v18
  v_exp_f32 v19, v19
  v_cvt_pk_bf16_f32 v44, v16, v17
  v_cvt_pk_bf16_f32 v45, v18, v19
  v_mfma_f32_32x32x16_bf16 a[64:79], a[44:47], v[52:55], a[64:79]
  v_exp_f32 v20, v20
  v_exp_f32 v21, v21
  v_exp_f32 v22, v22
  v_exp_f32 v23, v23
  s_waitcnt lgkmcnt(0)
  v_mfma_f32_32x32x16_bf16 a[48:63], a[32:35], v[40:43], a[48:63]
  v_cvt_pk_bf16_f32 v46, v20, v21
  v_cvt_pk_bf16_f32 v47, v22, v23
  v_exp_f32 v24, v24
  v_exp_f32 v25, v25
  v_exp_f32 v26, v26
  v_mfma_f32_32x32x16_bf16 v[8:23], a[24:27], a[0:3], 0
  v_exp_f32 v27, v27
  v_exp_f32 v28, v28
  v_exp_f32 v29, v29
  v_cvt_pk_bf16_f32 v48, v24, v25
  v_cvt_pk_bf16_f32 v49, v26, v27
  v_smfmac_f32_16x16x64_bf16 a[80:83], a[92:95], v[40:47], v117
  v_exp_f32 v30, v30
  v_exp_f32 v31, v31
  v_exp_f32 v32, v32
  v_cvt_pk_bf16_f32 v50, v28, v29
  v_cvt_pk_bf16_f32 v51, v30, v31
  v_mfma_f32_32x32x16_bf16 v[8:23], a[28:31], a[4:7], v[8:23]
  v_exp_f32 v33, v33
  v_exp_f32 v34, v34
  v_exp_f32 v35, v35
  v_cvt_pk_bf16_f32 v52, v32, v33
  v_cvt_pk_bf16_f32 v53, v34, v35
  v_mfma_f32_32x32x16_bf16 a[48:63], a[36:39], v[44:47], a[48:63]
  v_exp_f32 v36, v36
  v_exp_f32 v37, v37
  v_exp_f32 v38, v38
  v_exp_f32 v39, v39
L_att_kernel_t3:
  s_waitcnt vmcnt(4)
  s_barrier
  v_mfma_f32_32x32x16_bf16 a[64:79], a[32:35], v[48:51], a[64:79]
  ds_read_b128 a[16:19], v3 offset:32768
  v_cvt_pk_bf16_f32 v54, v36, v37
  v_cvt_pk_bf16_f32 v55, v38, v39
  v_exp_f32 v8, v8
  v_exp_f32 v9, v9
  v_exp_f32 v10, v10
  v_mfma_f32_32x32x16_bf16 v[24:39], a[24:27], a[8:11], 0
  ds_read_b128 a[20:23], v3 offset:33792
  v_exp_f32 v11, v11
  v_exp_f32 v12, v12
  v_exp_f32 v13, v13
  v_cvt_pk_bf16_f32 v40, v8, v9
  v_cvt_pk_bf16_f32 v41, v10, v11
  v_smfmac_f32_16x16x64_bf16 a[84:87], a[92:95], v[48:55], v117
  ds_read_b128 a[40:43], v3 offset:26624
  v_exp_f32 v14, v14
  v_exp_f32 v15, v15
  v_exp_f32 v16, v16
  v_cvt_pk_bf16_f32 v42, v12, v13
  v_cvt_pk_bf16_f32 v43, v14, v15
  v_mfma_f32_32x32x16_bf16 v[24:39], a[28:31], a[12:15], v[24:39]
  ds_read_b128 a[44:47], v3 offset:27648
  v_exp_f32 v17, v17
  v_exp_f32 v18, v18
  v_exp_f32 v19, v19
  v_cvt_pk_bf16_f32 v44, v16, v17
  v_cvt_pk_bf16_f32 v45, v18, v19
  v_mfma_f32_32x32x16_bf16 a[64:79], a[36:39], v[52:55], a[64:79]
  s_add_u32 m0, s18, 98304
  s_add_u32 s19, s17, 24576
  buffer_load_dwordx4 v2, s[8:11], s19 offen lds
  v_exp_f32 v20, v20
  v_exp_f32 v21, v21
  v_exp_f32 v22, v22
  v_exp_f32 v23, v23
  s_add_u32 m0, s18, 106496
  s_add_u32 s19, s17, 26624
  buffer_load_dwordx4 v2, s[8:11], s19 offen lds
  s_waitcnt lgkmcnt(0)
  v_mfma_f32_32x32x16_bf16 a[48:63], a[40:43], v[40:43], a[48:63]
  v_cvt_pk_bf16_f32 v46, v20, v21
  v_cvt_pk_bf16_f32 v47, v22, v23
  v_exp_f32 v24, v24
  v_exp_f32 v25, v25
  v_exp_f32 v26, v26
  v_mfma_f32_32x32x16_bf16 v[8:23], a[16:19], a[0:3], 0
  s_add_u32 m0, s18, 114688
  s_add_u32 s19, s17, 28672
  buffer_load_dwordx4 v2, s[8:11], s19 offen lds
  v_exp_f32 v27, v27
  v_exp_f32 v28, v28
  v_exp_f32 v29, v29
  v_cvt_pk_bf16_f32 v48, v24, v25
  v_cvt_pk_bf16_f32 v49, v26, v27
  v_smfmac_f32_16x16x64_bf16 a[80:83], a[92:95], v[40:47], v117
  v_exp_f32 v30, v30
  v_exp_f32 v31, v31
  v_exp_f32 v32, v32
  v_cvt_pk_bf16_f32 v50, v28, v29
  v_cvt_pk_bf16_f32 v51, v30, v31
  v_mfma_f32_32x32x16_bf16 v[8:23], a[20:23], a[4:7], v[8:23]
  s_add_u32 m0, s18, 122880
  s_add_u32 s19, s17, 30720
  buffer_load_dwordx4 v2, s[8:11], s19 offen lds
  v_exp_f32 v33, v33
  v_exp_f32 v34, v34
  v_exp_f32 v35, v35
  v_cvt_pk_bf16_f32 v52, v32, v33
  v_cvt_pk_bf16_f32 v53, v34, v35
  v_mfma_f32_32x32x16_bf16 a[48:63], a[44:47], v[44:47], a[48:63]
  v_exp_f32 v36, v36
  v_exp_f32 v37, v37
  v_exp_f32 v38, v38
  v_exp_f32 v39, v39
L_att_kernel_t4:
  v_mfma_f32_32x32x16_bf16 a[64:79], a[40:43], v[48:51], a[64:79]
  ds_read_b128 a[24:27], v3 offset:40960
  v_cvt_pk_bf16_f32 v54, v36, v37
  v_cvt_pk_bf16_f32 v55, v38, v39
  v_exp_f32 v8, v8
  v_exp_f32 v9, v9
  v_exp_f32 v10, v10
  v_mfma_f32_32x32x16_bf16 v[24:39], a[16:19], a[8:11], 0
  ds_read_b128 a[28:31], v3 offset:41984
  v_exp_f32 v11, v11
  v_exp_f32 v12, v12
  v_exp_f32 v13, v13
  v_cvt_pk_bf16_f32 v40, v8, v9
  v_cvt_pk_bf16_f32 v41, v10, v11
  v_smfmac_f32_16x16x64_bf16 a[84:87], a[92:95], v[48:55], v117
  ds_read_b128 a[32:35], v3 offset:34816
  v_exp_f32 v14, v14
  v_exp_f32 v15, v15
  v_exp_f32 v16, v16
  v_cvt_pk_bf16_f32 v42, v12, v13
  v_cvt_pk_bf16_f32 v43, v14, v15
  v_mfma_f32_32x32x16_bf16 v[24:39], a[20:23], a[12:15], v[24:39]
  ds_read_b128 a[36:39], v3 offset:35840
  v_exp_f32 v17, v17
  v_exp_f32 v18, v18
  v_exp_f32 v19, v19
  v_cvt_pk_bf16_f32 v44, v16, v17
  v_cvt_pk_bf16_f32 v45, v18, v19
  v_mfma_f32_32x32x16_bf16 a[64:79], a[44:47], v[52:55], a[64:79]
  v_exp_f32 v20, v20
  v_exp_f32 v21, v21
  v_exp_f32 v22, v22
  v_exp_f32 v23, v23
  s_waitcnt lgkmcnt(0)
  v_mfma_f32_32x32x16_bf16 a[48:63], a[32:35], v[40:43], a[48:63]
  v_cvt_pk_bf16_f32 v46, v20, v21
  v_cvt_pk_bf16_f32 v47, v22, v23
  v_exp_f32 v24, v24
  v_exp_f32 v25, v25
  v_exp_f32 v26, v26
  v_mfma_f32_32x32x16_bf16 v[8:23], a[24:27], a[0:3], 0
  v_exp_f32 v27, v27
  v_exp_f32 v28, v28
  v_exp_f32 v29, v29
  v_cvt_pk_bf16_f32 v48, v24, v25
  v_cvt_pk_bf16_f32 v49, v26, v27
  v_smfmac_f32_16x16x64_bf16 a[80:83], a[92:95], v[40:47], v117
  v_exp_f32 v30, v30
  v_exp_f32 v31, v31
  v_exp_f32 v32, v32
  v_cvt_pk_bf16_f32 v50, v28, v29
  v_cvt_pk_bf16_f32 v51, v30, v31
  v_mfma_f32_32x32x16_bf16 v[8:23], a[28:31], a[4:7], v[8:23]
  v_exp_f32 v33, v33
  v_exp_f32 v34, v34
  v_exp_f32 v35, v35
  v_cvt_pk_bf16_f32 v52, v32, v33
  v_cvt_pk_bf16_f32 v53, v34, v35
  v_mfma_f32_32x32x16_bf16 a[48:63], a[36:39], v[44:47], a[48:63]
  v_exp_f32 v36, v36
  v_exp_f32 v37, v37
  v_exp_f32 v38, v38
  v_exp_f32 v39, v39
L_att_kernel_t5:
  v_mfma_f32_32x32x16_bf16 a[64:79], a[32:35], v[48:51], a[64:79]
  ds_read_b128 a[16:19], v3 offset:49152
  v_cvt_pk_bf16_f32 v54, v36, v37
  v_cvt_pk_bf16_f32 v55, v38, v39
  v_exp_f32 v8, v8
  v_exp_f32 v9, v9
  v_exp_f32 v10, v10
  v_mfma_f32_32x32x16_bf16 v[24:39], a[24:27], a[8:11], 0
  ds_read_b128 a[20:23], v3 offset:50176
  v_exp_f32 v11, v11
  v_exp_f32 v12, v12
  v_exp_f32 v13, v13
  v_cvt_pk_bf16_f32 v40, v8, v9
  v_cvt_pk_bf16_f32 v41, v10, v11
  v_smfmac_f32_16x16x64_bf16 a[84:87], a[92:95], v[48:55], v117
  ds_read_b128 a[40:43], v3 offset:43008
  v_exp_f32 v14, v14
  v_exp_f32 v15, v15
  v_exp_f32 v16, v16
  v_cvt_pk_bf16_f32 v42, v12, v13
  v_cvt_pk_bf16_f32 v43, v14, v15
  v_mfma_f32_32x32x16_bf16 v[24:39], a[28:31], a[12:15], v[24:39]
  ds_read_b128 a[44:47], v3 offset:44032
  v_exp_f32 v17, v17
  v_exp_f32 v18, v18
  v_exp_f32 v19, v19
  v_cvt_pk_bf16_f32 v44, v16, v17
  v_cvt_pk_bf16_f32 v45, v18, v19
  v_mfma_f32_32x32x16_bf16 a[64:79], a[36:39], v[52:55], a[64:79]
  buffer_load_dword v101, v116, s[8:11], s59 offen
  v_exp_f32 v20, v20
  v_exp_f32 v21, v21
  v_exp_f32 v22, v22
  v_exp_f32 v23, v23
  s_waitcnt lgkmcnt(0)
  v_mfma_f32_32x32x16_bf16 a[48:63], a[40:43], v[40:43], a[48:63]
  v_cvt_pk_bf16_f32 v46, v20, v21
  v_cvt_pk_bf16_f32 v47, v22, v23
  v_exp_f32 v24, v24
  v_exp_f32 v25, v25
  v_exp_f32 v26, v26
  v_mfma_f32_32x32x16_bf16 v[8:23], a[16:19], a[0:3], 0
  v_exp_f32 v27, v27
  v_exp_f32 v28, v28
  v_exp_f32 v29, v29
  v_cvt_pk_bf16_f32 v48, v24, v25
  v_cvt_pk_bf16_f32 v49, v26, v27
  v_smfmac_f32_16x16x64_bf16 a[80:83], a[92:95], v[40:47], v117
  v_exp_f32 v30, v30
  v_exp_f32 v31, v31
  v_exp_f32 v32, v32
  v_cvt_pk_bf16_f32 v50, v28, v29
  v_cvt_pk_bf16_f32 v51, v30, v31
  v_mfma_f32_32x32x16_bf16 v[8:23], a[20:23], a[4:7], v[8:23]
  v_exp_f32 v33, v33
  v_exp_f32 v34, v34
  v_exp_f32 v35, v35
  v_cvt_pk_bf16_f32 v52, v32, v33
  v_cvt_pk_bf16_f32 v53, v34, v35
  v_mfma_f32_32x32x16_bf16 a[48:63], a[44:47], v[44:47], a[48:63]
  v_exp_f32 v36, v36
  v_exp_f32 v37, v37
  v_exp_f32 v38, v38
  v_exp_f32 v39, v39
L_att_kernel_t6:
  v_mfma_f32_32x32x16_bf16 a[64:79], a[40:43], v[48:51], a[64:79]
  ds_read_b128 a[24:27], v3 offset:57344
  v_cvt_pk_bf16_f32 v54, v36, v37
  v_cvt_pk_bf16_f32 v55, v38, v39
  v_exp_f32 v8, v8
  v_exp_f32 v9, v9
  v_exp_f32 v10, v10
  v_mfma_f32_32x32x16_bf16 v[24:39], a[16:19], a[8:11], 0
  ds_read_b128 a[28:31], v3 offset:58368
  v_exp_f32 v11, v11
  v_exp_f32 v12, v12
  v_exp_f32 v13, v13
  v_cvt_pk_bf16_f32 v40, v8, v9
  v_cvt_pk_bf16_f32 v41, v10, v11
  v_smfmac_f32_16x16x64_bf16 a[84:87], a[92:95], v[48:55], v117
  ds_read_b128 a[32:35], v3 offset:51200
  v_exp_f32 v14, v14
  v_exp_f32 v15, v15
  v_exp_f32 v16, v16
  v_cvt_pk_bf16_f32 v42, v12, v13
  v_cvt_pk_bf16_f32 v43, v14, v15
  v_mfma_f32_32x32x16_bf16 v[24:39], a[20:23], a[12:15], v[24:39]
  ds_read_b128 a[36:39], v3 offset:52224
  v_exp_f32 v17, v17
  v_exp_f32 v18, v18
  v_exp_f32 v19, v19
  v_cvt_pk_bf16_f32 v44, v16, v17
  v_cvt_pk_bf16_f32 v45, v18, v19
  v_mfma_f32_32x32x16_bf16 a[64:79], a[44:47], v[52:55], a[64:79]
  v_exp_f32 v20, v20
  v_exp_f32 v21, v21
  v_exp_f32 v22, v22
  v_exp_f32 v23, v23
  s_waitcnt lgkmcnt(0)
  v_mfma_f32_32x32x16_bf16 a[48:63], a[32:35], v[40:43], a[48:63]
  v_cvt_pk_bf16_f32 v46, v20, v21
  v_cvt_pk_bf16_f32 v47, v22, v23
  v_exp_f32 v24, v24
  v_exp_f32 v25, v25
  v_exp_f32 v26, v26
  v_mfma_f32_32x32x16_bf16 v[8:23], a[24:27], a[0:3], 0
  v_exp_f32 v27, v27
  v_exp_f32 v28, v28
  v_exp_f32 v29, v29
  v_cvt_pk_bf16_f32 v48, v24, v25
  v_cvt_pk_bf16_f32 v49, v26, v27
  v_smfmac_f32_16x16x64_bf16 a[80:83], a[92:95], v[40:47], v117
  v_exp_f32 v30, v30
  v_exp_f32 v31, v31
  v_exp_f32 v32, v32
  v_cvt_pk_bf16_f32 v50, v28, v29
  v_cvt_pk_bf16_f32 v51, v30, v31
  v_mfma_f32_32x32x16_bf16 v[8:23], a[28:31], a[4:7], v[8:23]
  v_exp_f32 v33, v33
  v_exp_f32 v34, v34
  v_exp_f32 v35, v35
  v_cvt_pk_bf16_f32 v52, v32, v33
  v_cvt_pk_bf16_f32 v53, v34, v35
  v_mfma_f32_32x32x16_bf16 a[48:63], a[36:39], v[44:47], a[48:63]
  v_exp_f32 v36, v36
  v_exp_f32 v37, v37
  v_exp_f32 v38, v38
  v_exp_f32 v39, v39
L_att_kernel_t7:
  s_waitcnt vmcnt(5)
  s_barrier
  v_mfma_f32_32x32x16_bf16 a[64:79], a[32:35], v[48:51], a[64:79]
  ds_read_b128 a[16:19], v4 offset:0
  v_cvt_pk_bf16_f32 v54, v36, v37
  v_cvt_pk_bf16_f32 v55, v38, v39
  v_exp_f32 v8, v8
  v_exp_f32 v9, v9
  v_exp_f32 v10, v10
  v_mfma_f32_32x32x16_bf16 v[24:39], a[24:27], a[8:11], 0
  ds_read_b128 a[20:23], v4 offset:1024
  v_exp_f32 v11, v11
  v_exp_f32 v12, v12
  v_exp_f32 v13, v13
  v_cvt_pk_bf16_f32 v40, v8, v9
  v_cvt_pk_bf16_f32 v41, v10, v11
  v_smfmac_f32_16x16x64_bf16 a[84:87], a[92:95], v[48:55], v117
  ds_read_b128 a[40:43], v3 offset:59392
  v_exp_f32 v14, v14
  v_exp_f32 v15, v15
  v_exp_f32 v16, v16
  v_cvt_pk_bf16_f32 v42, v12, v13
  v_cvt_pk_bf16_f32 v43, v14, v15
  v_mfma_f32_32x32x16_bf16 v[24:39], a[28:31], a[12:15], v[24:39]
  ds_read_b128 a[44:47], v3 offset:60416
  v_exp_f32 v17, v17
  v_exp_f32 v18, v18
  v_exp_f32 v19, v19
  v_cvt_pk_bf16_f32 v44, v16, v17
  v_cvt_pk_bf16_f32 v45, v18, v19
  v_mfma_f32_32x32x16_bf16 a[64:79], a[36:39], v[52:55], a[64:79]
  s_add_u32 m0, s18, 0
  s_add_u32 s19, s17, 32768
  buffer_load_dwordx4 v2, s[8:11], s19 offen lds
  v_exp_f32 v20, v20
  v_exp_f32 v21, v21
  v_exp_f32 v22, v22
  v_exp_f32 v23, v23
  s_add_u32 m0, s18, 8192
  s_add_u32 s19, s17, 34816
  buffer_load_dwordx4 v2, s[8:11], s19 offen lds
  s_waitcnt lgkmcnt(0)
  v_mfma_f32_32x32x16_bf16 a[48:63], a[40:43], v[40:43], a[48:63]
  v_cvt_pk_bf16_f32 v46, v20, v21
  v_cvt_pk_bf16_f32 v47, v22, v23
  v_exp_f32 v24, v24
  v_exp_f32 v25, v25
  v_exp_f32 v26, v26
  v_mfma_f32_32x32x16_bf16 v[8:23], a[16:19], a[0:3], 0
  s_add_u32 m0, s18, 16384
  s_add_u32 s19, s17, 36864
  buffer_load_dwordx4 v2, s[8:11], s19 offen lds
  v_exp_f32 v27, v27
  v_exp_f32 v28, v28
  v_exp_f32 v29, v29
  v_cvt_pk_bf16_f32 v48, v24, v25
  v_cvt_pk_bf16_f32 v49, v26, v27
  v_smfmac_f32_16x16x64_bf16 a[80:83], a[92:95], v[40:47], v117
  v_exp_f32 v30, v30
  v_exp_f32 v31, v31
  v_exp_f32 v32, v32
  v_cvt_pk_bf16_f32 v50, v28, v29
  v_cvt_pk_bf16_f32 v51, v30, v31
  v_mfma_f32_32x32x16_bf16 v[8:23], a[20:23], a[4:7], v[8:23]
  s_add_u32 m0, s18, 24576
  s_add_u32 s19, s17, 38912
  buffer_load_dwordx4 v2, s[8:11], s19 offen lds
  v_exp_f32 v33, v33
  v_exp_f32 v34, v34
  v_exp_f32 v35, v35
  v_cvt_pk_bf16_f32 v52, v32, v33
  v_cvt_pk_bf16_f32 v53, v34, v35
  v_mfma_f32_32x32x16_bf16 a[48:63], a[44:47], v[44:47], a[48:63]
  v_exp_f32 v36, v36
  v_exp_f32 v37, v37
  v_exp_f32 v38, v38
  v_exp_f32 v39, v39
L_att_kernel_t8:
  v_mfma_f32_32x32x16_bf16 a[64:79], a[40:43], v[48:51], a[64:79]
  ds_read_b128 a[24:27], v4 offset:8192
  v_cvt_pk_bf16_f32 v54, v36, v37
  v_cvt_pk_bf16_f32 v55, v38, v39
  v_exp_f32 v8, v8
  v_exp_f32 v9, v9
  v_exp_f32 v10, v10
  v_mfma_f32_32x32x16_bf16 v[24:39], a[16:19], a[8:11], 0
  ds_read_b128 a[28:31], v4 offset:9216
  v_exp_f32 v11, v11
  v_exp_f32 v12, v12
  v_exp_f32 v13, v13
  v_cvt_pk_bf16_f32 v40, v8, v9
  v_cvt_pk_bf16_f32 v41, v10, v11
  v_smfmac_f32_16x16x64_bf16 a[84:87], a[92:95], v[48:55], v117
  ds_read_b128 a[32:35], v4 offset:2048
  v_exp_f32 v14, v14
  v_exp_f32 v15, v15
  v_exp_f32 v16, v16
  v_cvt_pk_bf16_f32 v42, v12, v13
  v_cvt_pk_bf16_f32 v43, v14, v15
  v_mfma_f32_32x32x16_bf16 v[24:39], a[20:23], a[12:15], v[24:39]
  ds_read_b128 a[36:39], v4 offset:3072
  v_exp_f32 v17, v17
  v_exp_f32 v18, v18
  v_exp_f32 v19, v19
  v_cvt_pk_bf16_f32 v44, v16, v17
  v_cvt_pk_bf16_f32 v45, v18, v19
  v_mfma_f32_32x32x16_bf16 a[64:79], a[44:47], v[52:55], a[64:79]
  v_exp_f32 v20, v20
  v_exp_f32 v21, v21
  v_exp_f32 v22, v22
  v_exp_f32 v23, v23
  s_waitcnt lgkmcnt(0)
  v_mfma_f32_32x32x16_bf16 a[48:63], a[32:35], v[40:43], a[48:63]
  v_cvt_pk_bf16_f32 v46, v20, v21
  v_cvt_pk_bf16_f32 v47, v22, v23
  v_exp_f32 v24, v24
  v_exp_f32 v25, v25
  v_exp_f32 v26, v26
  v_mfma_f32_32x32x16_bf16 v[8:23], a[24:27], a[0:3], 0
  v_exp_f32 v27, v27
  v_exp_f32 v28, v28
  v_exp_f32 v29, v29
  v_cvt_pk_bf16_f32 v48, v24, v25
  v_cvt_pk_bf16_f32 v49, v26, v27
  v_smfmac_f32_16x16x64_bf16 a[80:83], a[92:95], v[40:47], v117
  v_exp_f32 v30, v30
  v_exp_f32 v31, v31
  v_exp_f32 v32, v32
  v_cvt_pk_bf16_f32 v50, v28, v29
  v_cvt_pk_bf16_f32 v51, v30, v31
  v_mfma_f32_32x32x16_bf16 v[8:23], a[28:31], a[4:7], v[8:23]
  v_exp_f32 v33, v33
  v_exp_f32 v34, v34
  v_exp_f32 v35, v35
  v_cvt_pk_bf16_f32 v52, v32, v33
  v_cvt_pk_bf16_f32 v53, v34, v35
  v_mfma_f32_32x32x16_bf16 a[48:63], a[36:39], v[44:47], a[48:63]
  v_exp_f32 v36, v36
  v_exp_f32 v37, v37
  v_exp_f32 v38, v38
  v_exp_f32 v39, v39
L_att_kernel_t9:
  v_mfma_f32_32x32x16_bf16 a[64:79], a[32:35], v[48:51], a[64:79]
  ds_read_b128 a[16:19], v4 offset:16384
  v_cvt_pk_bf16_f32 v54, v36, v37
  v_cvt_pk_bf16_f32 v55, v38, v39
  v_exp_f32 v8, v8
  v_exp_f32 v9, v9
  v_exp_f32 v10, v10
  v_mfma_f32_32x32x16_bf16 v[24:39], a[24:27], a[8:11], 0
  ds_read_b128 a[20:23], v4 offset:17408
  v_exp_f32 v11, v11
  v_exp_f32 v12, v12
  v_exp_f32 v13, v13
  v_cvt_pk_bf16_f32 v40, v8, v9
  v_cvt_pk_bf16_f32 v41, v10, v11
  v_smfmac_f32_16x16x64_bf16 a[84:87], a[92:95], v[48:55], v117
  ds_read_b128 a[40:43], v4 offset:10240
  v_exp_f32 v14, v14
  v_exp_f32 v15, v15
  v_exp_f32 v16, v16
  v_cvt_pk_bf16_f32 v42, v12, v13
  v_cvt_pk_bf16_f32 v43, v14, v15
  v_mfma_f32_32x32x16_bf16 v[24:39], a[28:31], a[12:15], v[24:39]
  ds_read_b128 a[44:47], v4 offset:11264
  v_exp_f32 v17, v17
  v_exp_f32 v18, v18
  v_exp_f32 v19, v19
  v_cvt_pk_bf16_f32 v44, v16, v17
  v_cvt_pk_bf16_f32 v45, v18, v19
  v_mfma_f32_32x32x16_bf16 a[64:79], a[36:39], v[52:55], a[64:79]
  v_exp_f32 v20, v20
  v_exp_f32 v21, v21
  v_exp_f32 v22, v22
  v_exp_f32 v23, v23
  s_waitcnt lgkmcnt(0)
  v_mfma_f32_32x32x16_bf16 a[48:63], a[40:43], v[40:43], a[48:63]
  v_cvt_pk_bf16_f32 v46, v20, v21
  v_cvt_pk_bf16_f32 v47, v22, v23
  v_exp_f32 v24, v24
  v_exp_f32 v25, v25
  v_exp_f32 v26, v26
  v_mfma_f32_32x32x16_bf16 v[8:23], a[16:19], a[0:3], 0
  v_exp_f32 v27, v27
  v_exp_f32 v28, v28
  v_exp_f32 v29, v29
  v_cvt_pk_bf16_f32 v48, v24, v25
  v_cvt_pk_bf16_f32 v49, v26, v27
  v_smfmac_f32_16x16x64_bf16 a[80:83], a[92:95], v[40:47], v117
  v_exp_f32 v30, v30
  v_exp_f32 v31, v31
  v_exp_f32 v32, v32
  v_cvt_pk_bf16_f32 v50, v28, v29
  v_cvt_pk_bf16_f32 v51, v30, v31
  v_mfma_f32_32x32x16_bf16 v[8:23], a[20:23], a[4:7], v[8:23]
  v_exp_f32 v33, v33
  v_exp_f32 v34, v34
  v_exp_f32 v35, v35
  v_cvt_pk_bf16_f32 v52, v32, v33
  v_cvt_pk_bf16_f32 v53, v34, v35
  v_mfma_f32_32x32x16_bf16 a[48:63], a[44:47], v[44:47], a[48:63]
  v_exp_f32 v36, v36
  v_exp_f32 v37, v37
  v_exp_f32 v38, v38
  v_exp_f32 v39, v39
L_att_kernel_t10:
  v_mfma_f32_32x32x16_bf16 a[64:79], a[40:43], v[48:51], a[64:79]
  ds_read_b128 a[24:27], v4 offset:24576
  v_cvt_pk_bf16_f32 v54, v36, v37
  v_cvt_pk_bf16_f32 v55, v38, v39
  v_exp_f32 v8, v8
  v_exp_f32 v9, v9
  v_exp_f32 v10, v10
  v_mfma_f32_32x32x16_bf16 v[24:39], a[16:19], a[8:11], 0
  ds_read_b128 a[28:31], v4 offset:25600
  v_exp_f32 v11, v11
  v_exp_f32 v12, v12
  v_exp_f32 v13, v13
  v_cvt_pk_bf16_f32 v40, v8, v9
  v_cvt_pk_bf16_f32 v41, v10, v11
  v_smfmac_f32_16x16x64_bf16 a[84:87], a[92:95], v[48:55], v117
  ds_read_b128 a[32:35], v4 offset:18432
  v_exp_f32 v14, v14
  v_exp_f32 v15, v15
  v_exp_f32 v16, v16
  v_cvt_pk_bf16_f32 v42, v12, v13
  v_cvt_pk_bf16_f32 v43, v14, v15
  v_mfma_f32_32x32x16_bf16 v[24:39], a[20:23], a[12:15], v[24:39]
  ds_read_b128 a[36:39], v4 offset:19456
  v_exp_f32 v17, v17
  v_exp_f32 v18, v18
  v_exp_f32 v19, v19
  v_cvt_pk_bf16_f32 v44, v16, v17
  v_cvt_pk_bf16_f32 v45, v18, v19
  v_mfma_f32_32x32x16_bf16 a[64:79], a[44:47], v[52:55], a[64:79]
  v_exp_f32 v20, v20
  v_exp_f32 v21, v21
  v_exp_f32 v22, v22
  v_exp_f32 v23, v23
  s_waitcnt lgkmcnt(0)
  v_mfma_f32_32x32x16_bf16 a[48:63], a[32:35], v[40:43], a[48:63]
  v_cvt_pk_bf16_f32 v46, v20, v21
  v_cvt_pk_bf16_f32 v47, v22, v23
  v_exp_f32 v24, v24
  v_exp_f32 v25, v25
  v_exp_f32 v26, v26
  v_mfma_f32_32x32x16_bf16 v[8:23], a[24:27], a[0:3], 0
  v_exp_f32 v27, v27
  v_exp_f32 v28, v28
  v_exp_f32 v29, v29
  v_cvt_pk_bf16_f32 v48, v24, v25
  v_cvt_pk_bf16_f32 v49, v26, v27
  v_smfmac_f32_16x16x64_bf16 a[80:83], a[92:95], v[40:47], v117
  v_exp_f32 v30, v30
  v_exp_f32 v31, v31
  v_exp_f32 v32, v32
  v_cvt_pk_bf16_f32 v50, v28, v29
  v_cvt_pk_bf16_f32 v51, v30, v31
  v_mfma_f32_32x32x16_bf16 v[8:23], a[28:31], a[4:7], v[8:23]
  v_exp_f32 v33, v33
  v_exp_f32 v34, v34
  v_exp_f32 v35, v35
  v_cvt_pk_bf16_f32 v52, v32, v33
  v_cvt_pk_bf16_f32 v53, v34, v35
  v_mfma_f32_32x32x16_bf16 a[48:63], a[36:39], v[44:47], a[48:63]
  v_exp_f32 v36, v36
  v_exp_f32 v37, v37
  v_exp_f32 v38, v38
  v_exp_f32 v39, v39
L_att_kernel_t11:
  s_waitcnt vmcnt(5)
  s_barrier
  v_mfma_f32_32x32x16_bf16 a[64:79], a[32:35], v[48:51], a[64:79]
  ds_read_b128 a[16:19], v4 offset:32768
  v_cvt_pk_bf16_f32 v54, v36, v37
  v_cvt_pk_bf16_f32 v55, v38, v39
  v_exp_f32 v8, v8
  v_exp_f32 v9, v9
  v_exp_f32 v10, v10
  v_mfma_f32_32x32x16_bf16 v[24:39], a[24:27], a[8:11], 0
  ds_read_b128 a[20:23], v4 offset:33792
  v_exp_f32 v11, v11
  v_exp_f32 v12, v12
  v_exp_f32 v13, v13
  v_cvt_pk_bf16_f32 v40, v8, v9
  v_cvt_pk_bf16_f32 v41, v10, v11
  v_smfmac_f32_16x16x64_bf16 a[84:87], a[92:95], v[48:55], v117
  ds_read_b128 a[40:43], v4 offset:26624
  v_exp_f32 v14, v14
  v_exp_f32 v15, v15
  v_exp_f32 v16, v16
  v_cvt_pk_bf16_f32 v42, v12, v13
  v_cvt_pk_bf16_f32 v43, v14, v15
  v_mfma_f32_32x32x16_bf16 v[24:39], a[28:31], a[12:15], v[24:39]
  ds_read_b128 a[44:47], v4 offset:27648
  v_exp_f32 v17, v17
  v_exp_f32 v18, v18
  v_exp_f32 v19, v19
  v_cvt_pk_bf16_f32 v44, v16, v17
  v_cvt_pk_bf16_f32 v45, v18, v19
  v_mfma_f32_32x32x16_bf16 a[64:79], a[36:39], v[52:55], a[64:79]
  s_add_u32 m0, s18, 32768
  s_add_u32 s19, s17, 40960
  buffer_load_dwordx4 v2, s[8:11], s19 offen lds
  v_exp_f32 v20, v20
  v_exp_f32 v21, v21
  v_exp_f32 v22, v22
  v_exp_f32 v23, v23
  s_add_u32 m0, s18, 40960
  s_add_u32 s19, s17, 43008
  buffer_load_dwordx4 v2, s[8:11], s19 offen lds
  s_waitcnt lgkmcnt(0)
  v_mfma_f32_32x32x16_bf16 a[48:63], a[40:43], v[40:43], a[48:63]
  v_cvt_pk_bf16_f32 v46, v20, v21
  v_cvt_pk_bf16_f32 v47, v22, v23
  v_exp_f32 v24, v24
  v_exp_f32 v25, v25
  v_exp_f32 v26, v26
  v_mfma_f32_32x32x16_bf16 v[8:23], a[16:19], a[0:3], 0
  s_add_u32 m0, s18, 49152
  s_add_u32 s19, s17, 45056
  buffer_load_dwordx4 v2, s[8:11], s19 offen lds
  v_exp_f32 v27, v27
  v_exp_f32 v28, v28
  v_exp_f32 v29, v29
  v_cvt_pk_bf16_f32 v48, v24, v25
  v_cvt_pk_bf16_f32 v49, v26, v27
  v_smfmac_f32_16x16x64_bf16 a[80:83], a[92:95], v[40:47], v117
  v_exp_f32 v30, v30
  v_exp_f32 v31, v31
  v_exp_f32 v32, v32
  v_cvt_pk_bf16_f32 v50, v28, v29
  v_cvt_pk_bf16_f32 v51, v30, v31
  v_mfma_f32_32x32x16_bf16 v[8:23], a[20:23], a[4:7], v[8:23]
  s_add_u32 m0, s18, 57344
  s_add_u32 s19, s17, 47104
  buffer_load_dwordx4 v2, s[8:11], s19 offen lds
  v_exp_f32 v33, v33
  v_exp_f32 v34, v34
  v_exp_f32 v35, v35
  v_cvt_pk_bf16_f32 v52, v32, v33
  v_cvt_pk_bf16_f32 v53, v34, v35
  v_mfma_f32_32x32x16_bf16 a[48:63], a[44:47], v[44:47], a[48:63]
  v_exp_f32 v36, v36
  v_exp_f32 v37, v37
  v_exp_f32 v38, v38
  v_exp_f32 v39, v39
L_att_kernel_t12:
  v_mfma_f32_32x32x16_bf16 a[64:79], a[40:43], v[48:51], a[64:79]
  ds_read_b128 a[24:27], v4 offset:40960
  v_cvt_pk_bf16_f32 v54, v36, v37
  v_cvt_pk_bf16_f32 v55, v38, v39
  v_exp_f32 v8, v8
  v_exp_f32 v9, v9
  v_exp_f32 v10, v10
  v_mfma_f32_32x32x16_bf16 v[24:39], a[16:19], a[8:11], 0
  ds_read_b128 a[28:31], v4 offset:41984
  v_exp_f32 v11, v11
  v_exp_f32 v12, v12
  v_exp_f32 v13, v13
  v_cvt_pk_bf16_f32 v40, v8, v9
  v_cvt_pk_bf16_f32 v41, v10, v11
  v_smfmac_f32_16x16x64_bf16 a[84:87], a[92:95], v[48:55], v117
  ds_read_b128 a[32:35], v4 offset:34816
  v_exp_f32 v14, v14
  v_exp_f32 v15, v15
  v_exp_f32 v16, v16
  v_cvt_pk_bf16_f32 v42, v12, v13
  v_cvt_pk_bf16_f32 v43, v14, v15
  v_mfma_f32_32x32x16_bf16 v[24:39], a[20:23], a[12:15], v[24:39]
  ds_read_b128 a[36:39], v4 offset:35840
  v_exp_f32 v17, v17
  v_exp_f32 v18, v18
  v_exp_f32 v19, v19
  v_cvt_pk_bf16_f32 v44, v16, v17
  v_cvt_pk_bf16_f32 v45, v18, v19
  v_mfma_f32_32x32x16_bf16 a[64:79], a[44:47], v[52:55], a[64:79]
  v_exp_f32 v20, v20
  v_exp_f32 v21, v21
  v_exp_f32 v22, v22
  v_exp_f32 v23, v23
  s_waitcnt lgkmcnt(0)
  v_mfma_f32_32x32x16_bf16 a[48:63], a[32:35], v[40:43], a[48:63]
  v_cvt_pk_bf16_f32 v46, v20, v21
  v_cvt_pk_bf16_f32 v47, v22, v23
  v_exp_f32 v24, v24
  v_exp_f32 v25, v25
  v_exp_f32 v26, v26
  v_mfma_f32_32x32x16_bf16 v[8:23], a[24:27], a[0:3], 0
  v_exp_f32 v27, v27
  v_exp_f32 v28, v28
  v_exp_f32 v29, v29
  v_cvt_pk_bf16_f32 v48, v24, v25
  v_cvt_pk_bf16_f32 v49, v26, v27
  v_smfmac_f32_16x16x64_bf16 a[80:83], a[92:95], v[40:47], v117
  v_exp_f32 v30, v30
  v_exp_f32 v31, v31
  v_exp_f32 v32, v32
  v_cvt_pk_bf16_f32 v50, v28, v29
  v_cvt_pk_bf16_f32 v51, v30, v31
  v_mfma_f32_32x32x16_bf16 v[8:23], a[28:31], a[4:7], v[8:23]
  v_exp_f32 v33, v33
  v_exp_f32 v34, v34
  v_exp_f32 v35, v35
  v_cvt_pk_bf16_f32 v52, v32, v33
  v_cvt_pk_bf16_f32 v53, v34, v35
  v_mfma_f32_32x32x16_bf16 a[48:63], a[36:39], v[44:47], a[48:63]
  v_exp_f32 v36, v36
  v_exp_f32 v37, v37
  v_exp_f32 v38, v38
  v_exp_f32 v39, v39
L_att_kernel_t13:
  v_mfma_f32_32x32x16_bf16 a[64:79], a[32:35], v[48:51], a[64:79]
  ds_read_b128 a[16:19], v4 offset:49152
  v_cvt_pk_bf16_f32 v54, v36, v37
  v_cvt_pk_bf16_f32 v55, v38, v39
  v_exp_f32 v8, v8
  v_exp_f32 v9, v9
  v_exp_f32 v10, v10
  v_mfma_f32_32x32x16_bf16 v[24:39], a[24:27], a[8:11], 0
  ds_read_b128 a[20:23], v4 offset:50176
  v_exp_f32 v11, v11
  v_exp_f32 v12, v12
  v_exp_f32 v13, v13
  v_cvt_pk_bf16_f32 v40, v8, v9
  v_cvt_pk_bf16_f32 v41, v10, v11
  v_smfmac_f32_16x16x64_bf16 a[84:87], a[92:95], v[48:55], v117
  ds_read_b128 a[40:43], v4 offset:43008
  v_exp_f32 v14, v14
  v_exp_f32 v15, v15
  v_exp_f32 v16, v16
  v_cvt_pk_bf16_f32 v42, v12, v13
  v_cvt_pk_bf16_f32 v43, v14, v15
  v_mfma_f32_32x32x16_bf16 v[24:39], a[28:31], a[12:15], v[24:39]
  ds_read_b128 a[44:47], v4 offset:44032
  v_exp_f32 v17, v17
  v_exp_f32 v18, v18
  v_exp_f32 v19, v19
  v_cvt_pk_bf16_f32 v44, v16, v17
  v_cvt_pk_bf16_f32 v45, v18, v19
  v_mfma_f32_32x32x16_bf16 a[64:79], a[36:39], v[52:55], a[64:79]
  v_exp_f32 v20, v20
  v_exp_f32 v21, v21
  v_exp_f32 v22, v22
  v_exp_f32 v23, v23
  s_waitcnt lgkmcnt(0)
  v_mfma_f32_32x32x16_bf16 a[48:63], a[40:43], v[40:43], a[48:63]
  v_cvt_pk_bf16_f32 v46, v20, v21
  v_cvt_pk_bf16_f32 v47, v22, v23
  v_exp_f32 v24, v24
  v_exp_f32 v25, v25
  v_exp_f32 v26, v26
  v_mfma_f32_32x32x16_bf16 v[8:23], a[16:19], a[0:3], 0
  v_exp_f32 v27, v27
  v_exp_f32 v28, v28
  v_exp_f32 v29, v29
  v_cvt_pk_bf16_f32 v48, v24, v25
  v_cvt_pk_bf16_f32 v49, v26, v27
  v_smfmac_f32_16x16x64_bf16 a[80:83], a[92:95], v[40:47], v117
  v_exp_f32 v30, v30
  v_exp_f32 v31, v31
  v_exp_f32 v32, v32
  v_cvt_pk_bf16_f32 v50, v28, v29
  v_cvt_pk_bf16_f32 v51, v30, v31
  v_mfma_f32_32x32x16_bf16 v[8:23], a[20:23], a[4:7], v[8:23]
  v_exp_f32 v33, v33
  v_exp_f32 v34, v34
  v_exp_f32 v35, v35
  v_cvt_pk_bf16_f32 v52, v32, v33
  v_cvt_pk_bf16_f32 v53, v34, v35
  v_mfma_f32_32x32x16_bf16 a[48:63], a[44:47], v[44:47], a[48:63]
  v_exp_f32 v36, v36
  v_exp_f32 v37, v37
  v_exp_f32 v38, v38
  v_exp_f32 v39, v39
L_att_kernel_t14:
  v_mfma_f32_32x32x16_bf16 a[64:79], a[40:43], v[48:51], a[64:79]
  ds_read_b128 a[24:27], v4 offset:57344
  v_cvt_pk_bf16_f32 v54, v36, v37
  v_cvt_pk_bf16_f32 v55, v38, v39
  v_exp_f32 v8, v8
  v_exp_f32 v9, v9
  v_exp_f32 v10, v10
  v_mfma_f32_32x32x16_bf16 v[24:39], a[16:19], a[8:11], 0
  ds_read_b128 a[28:31], v4 offset:58368
  v_exp_f32 v11, v11
  v_exp_f32 v12, v12
  v_exp_f32 v13, v13
  v_cvt_pk_bf16_f32 v40, v8, v9
  v_cvt_pk_bf16_f32 v41, v10, v11
  v_smfmac_f32_16x16x64_bf16 a[84:87], a[92:95], v[48:55], v117
  ds_read_b128 a[32:35], v4 offset:51200
  v_exp_f32 v14, v14
  v_exp_f32 v15, v15
  v_exp_f32 v16, v16
  v_cvt_pk_bf16_f32 v42, v12, v13
  v_cvt_pk_bf16_f32 v43, v14, v15
  v_mfma_f32_32x32x16_bf16 v[24:39], a[20:23], a[12:15], v[24:39]
  ds_read_b128 a[36:39], v4 offset:52224
  v_exp_f32 v17, v17
  v_exp_f32 v18, v18
  v_exp_f32 v19, v19
  v_cvt_pk_bf16_f32 v44, v16, v17
  v_cvt_pk_bf16_f32 v45, v18, v19
  v_mfma_f32_32x32x16_bf16 a[64:79], a[44:47], v[52:55], a[64:79]
  v_exp_f32 v20, v20
  v_exp_f32 v21, v21
  v_exp_f32 v22, v22
  v_exp_f32 v23, v23
  s_waitcnt lgkmcnt(0)
  v_mfma_f32_32x32x16_bf16 a[48:63], a[32:35], v[40:43], a[48:63]
  v_cvt_pk_bf16_f32 v46, v20, v21
  v_cvt_pk_bf16_f32 v47, v22, v23
  v_exp_f32 v24, v24
  v_exp_f32 v25, v25
  v_exp_f32 v26, v26
  v_mfma_f32_32x32x16_bf16 v[8:23], a[24:27], a[0:3], 0
  v_exp_f32 v27, v27
  v_exp_f32 v28, v28
  v_exp_f32 v29, v29
  v_cvt_pk_bf16_f32 v48, v24, v25
  v_cvt_pk_bf16_f32 v49, v26, v27
  v_smfmac_f32_16x16x64_bf16 a[80:83], a[92:95], v[40:47], v117
  v_exp_f32 v30, v30
  v_exp_f32 v31, v31
  v_exp_f32 v32, v32
  v_cvt_pk_bf16_f32 v50, v28, v29
  v_cvt_pk_bf16_f32 v51, v30, v31
  v_mfma_f32_32x32x16_bf16 v[8:23], a[28:31], a[4:7], v[8:23]
  v_exp_f32 v33, v33
  v_exp_f32 v34, v34
  v_exp_f32 v35, v35
  v_cvt_pk_bf16_f32 v52, v32, v33
  v_cvt_pk_bf16_f32 v53, v34, v35
  v_mfma_f32_32x32x16_bf16 a[48:63], a[36:39], v[44:47], a[48:63]
  v_exp_f32 v36, v36
  v_exp_f32 v37, v37
  v_exp_f32 v38, v38
  v_exp_f32 v39, v39
L_att_kernel_t15:
  s_waitcnt vmcnt(4)
  s_barrier
  v_mfma_f32_32x32x16_bf16 a[64:79], a[32:35], v[48:51], a[64:79]
  ds_read_b128 a[16:19], v3 offset:0
  v_cvt_pk_bf16_f32 v54, v36, v37
  v_cvt_pk_bf16_f32 v55, v38, v39
  v_exp_f32 v8, v8
  v_exp_f32 v9, v9
  v_exp_f32 v10, v10
  v_mfma_f32_32x32x16_bf16 v[24:39], a[24:27], a[8:11], 0
  ds_read_b128 a[20:23], v3 offset:1024
  v_exp_f32 v11, v11
  v_exp_f32 v12, v12
  v_exp_f32 v13, v13
  v_cvt_pk_bf16_f32 v40, v8, v9
  v_cvt_pk_bf16_f32 v41, v10, v11
  v_smfmac_f32_16x16x64_bf16 a[84:87], a[92:95], v[48:55], v117
  ds_read_b128 a[40:43], v4 offset:59392
  v_exp_f32 v14, v14
  v_exp_f32 v15, v15
  v_exp_f32 v16, v16
  v_cvt_pk_bf16_f32 v42, v12, v13
  v_cvt_pk_bf16_f32 v43, v14, v15
  v_mfma_f32_32x32x16_bf16 v[24:39], a[28:31], a[12:15], v[24:39]
  ds_read_b128 a[44:47], v4 offset:60416
  v_exp_f32 v17, v17
  v_exp_f32 v18, v18
  v_exp_f32 v19, v19
  v_cvt_pk_bf16_f32 v44, v16, v17
  v_cvt_pk_bf16_f32 v45, v18, v19
  v_mfma_f32_32x32x16_bf16 a[64:79], a[36:39], v[52:55], a[64:79]
  s_add_u32 m0, s18, 65536
  s_add_u32 s19, s17, 49152
  buffer_load_dwordx4 v2, s[8:11], s19 offen lds
  v_exp_f32 v20, v20
  v_exp_f32 v21, v21
  v_exp_f32 v22, v22
  v_exp_f32 v23, v23
  s_add_u32 m0, s18, 73728
  s_add_u32 s19, s17, 51200
  buffer_load_dwordx4 v2, s[8:11], s19 offen lds
  s_waitcnt lgkmcnt(0)
  v_mfma_f32_32x32x16_bf16 a[48:63], a[40:43], v[40:43], a[48:63]
  v_cvt_pk_bf16_f32 v46, v20, v21
  v_cvt_pk_bf16_f32 v47, v22, v23
  v_exp_f32 v24, v24
  v_exp_f32 v25, v25
  v_exp_f32 v26, v26
  v_mfma_f32_32x32x16_bf16 v[8:23], a[16:19], a[0:3], 0
  s_add_u32 m0, s18, 81920
  s_add_u32 s19, s17, 53248
  buffer_load_dwordx4 v2, s[8:11], s19 offen lds
  v_exp_f32 v27, v27
  v_exp_f32 v28, v28
  v_exp_f32 v29, v29
  v_cvt_pk_bf16_f32 v48, v24, v25
  v_cvt_pk_bf16_f32 v49, v26, v27
  v_smfmac_f32_16x16x64_bf16 a[80:83], a[92:95], v[40:47], v117
  v_exp_f32 v30, v30
  v_exp_f32 v31, v31
  v_exp_f32 v32, v32
  v_cvt_pk_bf16_f32 v50, v28, v29
  v_cvt_pk_bf16_f32 v51, v30, v31
  v_mfma_f32_32x32x16_bf16 v[8:23], a[20:23], a[4:7], v[8:23]
  s_add_u32 m0, s18, 90112
  s_add_u32 s19, s17, 55296
  buffer_load_dwordx4 v2, s[8:11], s19 offen lds
  v_exp_f32 v33, v33
  v_exp_f32 v34, v34
  v_exp_f32 v35, v35
  v_cvt_pk_bf16_f32 v52, v32, v33
  v_cvt_pk_bf16_f32 v53, v34, v35
  v_mfma_f32_32x32x16_bf16 a[48:63], a[44:47], v[44:47], a[48:63]
  v_exp_f32 v36, v36
  v_exp_f32 v37, v37
  v_exp_f32 v38, v38
  v_exp_f32 v39, v39
L_att_kernel_t16:
  v_mfma_f32_32x32x16_bf16 a[64:79], a[40:43], v[48:51], a[64:79]
  ds_read_b128 a[24:27], v3 offset:8192
  v_cvt_pk_bf16_f32 v54, v36, v37
  v_cvt_pk_bf16_f32 v55, v38, v39
  v_exp_f32 v8, v8
  v_exp_f32 v9, v9
  v_exp_f32 v10, v10
  v_mfma_f32_32x32x16_bf16 v[24:39], a[16:19], a[8:11], 0
  ds_read_b128 a[28:31], v3 offset:9216
  v_exp_f32 v11, v11
  v_exp_f32 v12, v12
  v_exp_f32 v13, v13
  v_cvt_pk_bf16_f32 v40, v8, v9
  v_cvt_pk_bf16_f32 v41, v10, v11
  v_smfmac_f32_16x16x64_bf16 a[84:87], a[92:95], v[48:55], v117
  ds_read_b128 a[32:35], v3 offset:2048
  v_exp_f32 v14, v14
  v_exp_f32 v15, v15
  v_exp_f32 v16, v16
  v_cvt_pk_bf16_f32 v42, v12, v13
  v_cvt_pk_bf16_f32 v43, v14, v15
  v_mfma_f32_32x32x16_bf16 v[24:39], a[20:23], a[12:15], v[24:39]
  ds_read_b128 a[36:39], v3 offset:3072
  v_exp_f32 v17, v17
  v_exp_f32 v18, v18
  v_exp_f32 v19, v19
  v_cvt_pk_bf16_f32 v44, v16, v17
  v_cvt_pk_bf16_f32 v45, v18, v19
  v_mfma_f32_32x32x16_bf16 a[64:79], a[44:47], v[52:55], a[64:79]
  v_exp_f32 v20, v20
  v_exp_f32 v21, v21
  v_exp_f32 v22, v22
  v_exp_f32 v23, v23
  s_waitcnt lgkmcnt(0)
  v_mfma_f32_32x32x16_bf16 a[48:63], a[32:35], v[40:43], a[48:63]
  v_cvt_pk_bf16_f32 v46, v20, v21
  v_cvt_pk_bf16_f32 v47, v22, v23
  v_exp_f32 v24, v24
  v_exp_f32 v25, v25
  v_exp_f32 v26, v26
  v_mfma_f32_32x32x16_bf16 v[8:23], a[24:27], a[0:3], 0
  v_exp_f32 v27, v27
  v_exp_f32 v28, v28
  v_exp_f32 v29, v29
  v_cvt_pk_bf16_f32 v48, v24, v25
  v_cvt_pk_bf16_f32 v49, v26, v27
  v_smfmac_f32_16x16x64_bf16 a[80:83], a[92:95], v[40:47], v117
  v_exp_f32 v30, v30
  v_exp_f32 v31, v31
  v_exp_f32 v32, v32
  v_cvt_pk_bf16_f32 v50, v28, v29
  v_cvt_pk_bf16_f32 v51, v30, v31
  v_mfma_f32_32x32x16_bf16 v[8:23], a[28:31], a[4:7], v[8:23]
  v_exp_f32 v33, v33
  v_exp_f32 v34, v34
  v_exp_f32 v35, v35
  v_cvt_pk_bf16_f32 v52, v32, v33
  v_cvt_pk_bf16_f32 v53, v34, v35
  v_mfma_f32_32x32x16_bf16 a[48:63], a[36:39], v[44:47], a[48:63]
  v_exp_f32 v36, v36
  v_exp_f32 v37, v37
  v_exp_f32 v38, v38
  v_exp_f32 v39, v39
L_att_kernel_t17:
  v_mfma_f32_32x32x16_bf16 a[64:79], a[32:35], v[48:51], a[64:79]
  ds_read_b128 a[16:19], v3 offset:16384
  v_cvt_pk_bf16_f32 v54, v36, v37
  v_cvt_pk_bf16_f32 v55, v38, v39
  v_exp_f32 v8, v8
  v_exp_f32 v9, v9
  v_exp_f32 v10, v10
  v_mfma_f32_32x32x16_bf16 v[24:39], a[24:27], a[8:11], 0
  ds_read_b128 a[20:23], v3 offset:17408
  v_exp_f32 v11, v11
  v_exp_f32 v12, v12
  v_exp_f32 v13, v13
  v_cvt_pk_bf16_f32 v40, v8, v9
  v_cvt_pk_bf16_f32 v41, v10, v11
  v_smfmac_f32_16x16x64_bf16 a[84:87], a[92:95], v[48:55], v117
  ds_read_b128 a[40:43], v3 offset:10240
  v_exp_f32 v14, v14
  v_exp_f32 v15, v15
  v_exp_f32 v16, v16
  v_cvt_pk_bf16_f32 v42, v12, v13
  v_cvt_pk_bf16_f32 v43, v14, v15
  v_mfma_f32_32x32x16_bf16 v[24:39], a[28:31], a[12:15], v[24:39]
  ds_read_b128 a[44:47], v3 offset:11264
  v_exp_f32 v17, v17
  v_exp_f32 v18, v18
  v_exp_f32 v19, v19
  v_cvt_pk_bf16_f32 v44, v16, v17
  v_cvt_pk_bf16_f32 v45, v18, v19
  v_mfma_f32_32x32x16_bf16 a[64:79], a[36:39], v[52:55], a[64:79]
  v_exp_f32 v20, v20
  v_exp_f32 v21, v21
  v_exp_f32 v22, v22
  v_exp_f32 v23, v23
  s_waitcnt lgkmcnt(0)
  v_mfma_f32_32x32x16_bf16 a[48:63], a[40:43], v[40:43], a[48:63]
  v_cvt_pk_bf16_f32 v46, v20, v21
  v_cvt_pk_bf16_f32 v47, v22, v23
  v_exp_f32 v24, v24
  v_exp_f32 v25, v25
  v_exp_f32 v26, v26
  v_mfma_f32_32x32x16_bf16 v[8:23], a[16:19], a[0:3], 0
  v_exp_f32 v27, v27
  v_exp_f32 v28, v28
  v_exp_f32 v29, v29
  v_cvt_pk_bf16_f32 v48, v24, v25
  v_cvt_pk_bf16_f32 v49, v26, v27
  v_smfmac_f32_16x16x64_bf16 a[80:83], a[92:95], v[40:47], v117
  v_exp_f32 v30, v30
  v_exp_f32 v31, v31
  v_exp_f32 v32, v32
  v_cvt_pk_bf16_f32 v50, v28, v29
  v_cvt_pk_bf16_f32 v51, v30, v31
  v_mfma_f32_32x32x16_bf16 v[8:23], a[20:23], a[4:7], v[8:23]
  v_exp_f32 v33, v33
  v_exp_f32 v34, v34
  v_exp_f32 v35, v35
  v_cvt_pk_bf16_f32 v52, v32, v33
  v_cvt_pk_bf16_f32 v53, v34, v35
  v_mfma_f32_32x32x16_bf16 a[48:63], a[44:47], v[44:47], a[48:63]
  v_exp_f32 v36, v36
  v_exp_f32 v37, v37
  v_exp_f32 v38, v38
  v_exp_f32 v39, v39
L_att_kernel_t18:
  v_mfma_f32_32x32x16_bf16 a[64:79], a[40:43], v[48:51], a[64:79]
  ds_read_b128 a[24:27], v3 offset:24576
  v_cvt_pk_bf16_f32 v54, v36, v37
  v_cvt_pk_bf16_f32 v55, v38, v39
  v_exp_f32 v8, v8
  v_exp_f32 v9, v9
  v_exp_f32 v10, v10
  v_mfma_f32_32x32x16_bf16 v[24:39], a[16:19], a[8:11], 0
  ds_read_b128 a[28:31], v3 offset:25600
  v_exp_f32 v11, v11
  v_exp_f32 v12, v12
  v_exp_f32 v13, v13
  v_cvt_pk_bf16_f32 v40, v8, v9
  v_cvt_pk_bf16_f32 v41, v10, v11
  v_smfmac_f32_16x16x64_bf16 a[84:87], a[92:95], v[48:55], v117
  ds_read_b128 a[32:35], v3 offset:18432
  v_exp_f32 v14, v14
  v_exp_f32 v15, v15
  v_exp_f32 v16, v16
  v_cvt_pk_bf16_f32 v42, v12, v13
  v_cvt_pk_bf16_f32 v43, v14, v15
  v_mfma_f32_32x32x16_bf16 v[24:39], a[20:23], a[12:15], v[24:39]
  ds_read_b128 a[36:39], v3 offset:19456
  v_exp_f32 v17, v17
  v_exp_f32 v18, v18
  v_exp_f32 v19, v19
  v_cvt_pk_bf16_f32 v44, v16, v17
  v_cvt_pk_bf16_f32 v45, v18, v19
  v_mfma_f32_32x32x16_bf16 a[64:79], a[44:47], v[52:55], a[64:79]
  v_exp_f32 v20, v20
  v_exp_f32 v21, v21
  v_exp_f32 v22, v22
  v_exp_f32 v23, v23
  s_waitcnt lgkmcnt(0)
  v_mfma_f32_32x32x16_bf16 a[48:63], a[32:35], v[40:43], a[48:63]
  v_cvt_pk_bf16_f32 v46, v20, v21
  v_cvt_pk_bf16_f32 v47, v22, v23
  v_exp_f32 v24, v24
  v_exp_f32 v25, v25
  v_exp_f32 v26, v26
  v_mfma_f32_32x32x16_bf16 v[8:23], a[24:27], a[0:3], 0
  v_exp_f32 v27, v27
  v_exp_f32 v28, v28
  v_exp_f32 v29, v29
  v_cvt_pk_bf16_f32 v48, v24, v25
  v_cvt_pk_bf16_f32 v49, v26, v27
  v_smfmac_f32_16x16x64_bf16 a[80:83], a[92:95], v[40:47], v117
  v_exp_f32 v30, v30
  v_exp_f32 v31, v31
  v_exp_f32 v32, v32
  v_cvt_pk_bf16_f32 v50, v28, v29
  v_cvt_pk_bf16_f32 v51, v30, v31
  v_mfma_f32_32x32x16_bf16 v[8:23], a[28:31], a[4:7], v[8:23]
  v_exp_f32 v33, v33
  v_exp_f32 v34, v34
  v_exp_f32 v35, v35
  v_cvt_pk_bf16_f32 v52, v32, v33
  v_cvt_pk_bf16_f32 v53, v34, v35
  v_mfma_f32_32x32x16_bf16 a[48:63], a[36:39], v[44:47], a[48:63]
  v_exp_f32 v36, v36
  v_exp_f32 v37, v37
  v_exp_f32 v38, v38
  v_exp_f32 v39, v39
L_att_kernel_t19:
  s_waitcnt vmcnt(4)
  s_barrier
  v_mfma_f32_32x32x16_bf16 a[64:79], a[32:35], v[48:51], a[64:79]
  ds_read_b128 a[16:19], v3 offset:32768
  v_cvt_pk_bf16_f32 v54, v36, v37
  v_cvt_pk_bf16_f32 v55, v38, v39
  v_exp_f32 v8, v8
  v_exp_f32 v9, v9
  v_exp_f32 v10, v10
  v_mfma_f32_32x32x16_bf16 v[24:39], a[24:27], a[8:11], 0
  ds_read_b128 a[20:23], v3 offset:33792
  v_exp_f32 v11, v11
  v_exp_f32 v12, v12
  v_exp_f32 v13, v13
  v_cvt_pk_bf16_f32 v40, v8, v9
  v_cvt_pk_bf16_f32 v41, v10, v11
  v_smfmac_f32_16x16x64_bf16 a[84:87], a[92:95], v[48:55], v117
  ds_read_b128 a[40:43], v3 offset:26624
  v_exp_f32 v14, v14
  v_exp_f32 v15, v15
  v_exp_f32 v16, v16
  v_cvt_pk_bf16_f32 v42, v12, v13
  v_cvt_pk_bf16_f32 v43, v14, v15
  v_mfma_f32_32x32x16_bf16 v[24:39], a[28:31], a[12:15], v[24:39]
  ds_read_b128 a[44:47], v3 offset:27648
  v_exp_f32 v17, v17
  v_exp_f32 v18, v18
  v_exp_f32 v19, v19
  v_cvt_pk_bf16_f32 v44, v16, v17
  v_cvt_pk_bf16_f32 v45, v18, v19
  v_mfma_f32_32x32x16_bf16 a[64:79], a[36:39], v[52:55], a[64:79]
  s_add_u32 m0, s18, 98304
  s_add_u32 s19, s17, 57344
  buffer_load_dwordx4 v2, s[8:11], s19 offen lds
  v_exp_f32 v20, v20
  v_exp_f32 v21, v21
  v_exp_f32 v22, v22
  v_exp_f32 v23, v23
  s_add_u32 m0, s18, 106496
  s_add_u32 s19, s17, 59392
  buffer_load_dwordx4 v2, s[8:11], s19 offen lds
  s_waitcnt lgkmcnt(0)
  v_mfma_f32_32x32x16_bf16 a[48:63], a[40:43], v[40:43], a[48:63]
  v_cvt_pk_bf16_f32 v46, v20, v21
  v_cvt_pk_bf16_f32 v47, v22, v23
  v_exp_f32 v24, v24
  v_exp_f32 v25, v25
  v_exp_f32 v26, v26
  v_mfma_f32_32x32x16_bf16 v[8:23], a[16:19], a[0:3], 0
  s_add_u32 m0, s18, 114688
  s_add_u32 s19, s17, 61440
  buffer_load_dwordx4 v2, s[8:11], s19 offen lds
  v_exp_f32 v27, v27
  v_exp_f32 v28, v28
  v_exp_f32 v29, v29
  v_cvt_pk_bf16_f32 v48, v24, v25
  v_cvt_pk_bf16_f32 v49, v26, v27
  v_smfmac_f32_16x16x64_bf16 a[80:83], a[92:95], v[40:47], v117
  v_exp_f32 v30, v30
  v_exp_f32 v31, v31
  v_exp_f32 v32, v32
  v_cvt_pk_bf16_f32 v50, v28, v29
  v_cvt_pk_bf16_f32 v51, v30, v31
  v_mfma_f32_32x32x16_bf16 v[8:23], a[20:23], a[4:7], v[8:23]
  s_add_u32 m0, s18, 122880
  s_add_u32 s19, s17, 63488
  buffer_load_dwordx4 v2, s[8:11], s19 offen lds
  v_exp_f32 v33, v33
  v_exp_f32 v34, v34
  v_exp_f32 v35, v35
  v_cvt_pk_bf16_f32 v52, v32, v33
  v_cvt_pk_bf16_f32 v53, v34, v35
  v_mfma_f32_32x32x16_bf16 a[48:63], a[44:47], v[44:47], a[48:63]
  v_exp_f32 v36, v36
  v_exp_f32 v37, v37
  v_exp_f32 v38, v38
  v_exp_f32 v39, v39
L_att_kernel_t20:
  v_mfma_f32_32x32x16_bf16 a[64:79], a[40:43], v[48:51], a[64:79]
  ds_read_b128 a[24:27], v3 offset:40960
  v_cvt_pk_bf16_f32 v54, v36, v37
  v_cvt_pk_bf16_f32 v55, v38, v39
  v_exp_f32 v8, v8
  v_exp_f32 v9, v9
  v_exp_f32 v10, v10
  v_mfma_f32_32x32x16_bf16 v[24:39], a[16:19], a[8:11], 0
  ds_read_b128 a[28:31], v3 offset:41984
  v_exp_f32 v11, v11
  v_exp_f32 v12, v12
  v_exp_f32 v13, v13
  v_cvt_pk_bf16_f32 v40, v8, v9
  v_cvt_pk_bf16_f32 v41, v10, v11
  v_smfmac_f32_16x16x64_bf16 a[84:87], a[92:95], v[48:55], v117
  ds_read_b128 a[32:35], v3 offset:34816
  v_exp_f32 v14, v14
  v_exp_f32 v15, v15
  v_exp_f32 v16, v16
  v_cvt_pk_bf16_f32 v42, v12, v13
  v_cvt_pk_bf16_f32 v43, v14, v15
  v_mfma_f32_32x32x16_bf16 v[24:39], a[20:23], a[12:15], v[24:39]
  ds_read_b128 a[36:39], v3 offset:35840
  v_exp_f32 v17, v17
  v_exp_f32 v18, v18
  v_exp_f32 v19, v19
  v_cvt_pk_bf16_f32 v44, v16, v17
  v_cvt_pk_bf16_f32 v45, v18, v19
  v_mfma_f32_32x32x16_bf16 a[64:79], a[44:47], v[52:55], a[64:79]
  v_exp_f32 v20, v20
  v_exp_f32 v21, v21
  v_exp_f32 v22, v22
  v_exp_f32 v23, v23
  s_waitcnt lgkmcnt(0)
  v_mfma_f32_32x32x16_bf16 a[48:63], a[32:35], v[40:43], a[48:63]
  v_cvt_pk_bf16_f32 v46, v20, v21
  v_cvt_pk_bf16_f32 v47, v22, v23
  v_exp_f32 v24, v24
  v_exp_f32 v25, v25
  v_exp_f32 v26, v26
  v_mfma_f32_32x32x16_bf16 v[8:23], a[24:27], a[0:3], 0
  v_exp_f32 v27, v27
  v_exp_f32 v28, v28
  v_exp_f32 v29, v29
  v_cvt_pk_bf16_f32 v48, v24, v25
  v_cvt_pk_bf16_f32 v49, v26, v27
  v_smfmac_f32_16x16x64_bf16 a[80:83], a[92:95], v[40:47], v117
  v_exp_f32 v30, v30
  v_exp_f32 v31, v31
  v_exp_f32 v32, v32
  v_cvt_pk_bf16_f32 v50, v28, v29
  v_cvt_pk_bf16_f32 v51, v30, v31
  v_mfma_f32_32x32x16_bf16 v[8:23], a[28:31], a[4:7], v[8:23]
  v_exp_f32 v33, v33
  v_exp_f32 v34, v34
  v_exp_f32 v35, v35
  v_cvt_pk_bf16_f32 v52, v32, v33
  v_cvt_pk_bf16_f32 v53, v34, v35
  v_mfma_f32_32x32x16_bf16 a[48:63], a[36:39], v[44:47], a[48:63]
  v_exp_f32 v36, v36
  v_exp_f32 v37, v37
  v_exp_f32 v38, v38
  v_exp_f32 v39, v39
L_att_kernel_t21:
  v_mfma_f32_32x32x16_bf16 a[64:79], a[32:35], v[48:51], a[64:79]
  ds_read_b128 a[16:19], v3 offset:49152
  v_cvt_pk_bf16_f32 v54, v36, v37
  v_cvt_pk_bf16_f32 v55, v38, v39
  v_exp_f32 v8, v8
  v_exp_f32 v9, v9
  v_exp_f32 v10, v10
  v_mfma_f32_32x32x16_bf16 v[24:39], a[24:27], a[8:11], 0
  ds_read_b128 a[20:23], v3 offset:50176
  v_exp_f32 v11, v11
  v_exp_f32 v12, v12
  v_exp_f32 v13, v13
  v_cvt_pk_bf16_f32 v40, v8, v9
  v_cvt_pk_bf16_f32 v41, v10, v11
  v_smfmac_f32_16x16x64_bf16 a[84:87], a[92:95], v[48:55], v117
  ds_read_b128 a[40:43], v3 offset:43008
  v_exp_f32 v14, v14
  v_exp_f32 v15, v15
  v_exp_f32 v16, v16
  v_cvt_pk_bf16_f32 v42, v12, v13
  v_cvt_pk_bf16_f32 v43, v14, v15
  v_mfma_f32_32x32x16_bf16 v[24:39], a[28:31], a[12:15], v[24:39]
  ds_read_b128 a[44:47], v3 offset:44032
  v_exp_f32 v17, v17
  v_exp_f32 v18, v18
  v_exp_f32 v19, v19
  v_cvt_pk_bf16_f32 v44, v16, v17
  v_cvt_pk_bf16_f32 v45, v18, v19
  v_mfma_f32_32x32x16_bf16 a[64:79], a[36:39], v[52:55], a[64:79]
  v_exp_f32 v20, v20
  v_exp_f32 v21, v21
  v_exp_f32 v22, v22
  v_exp_f32 v23, v23
  s_waitcnt lgkmcnt(0)
  v_mfma_f32_32x32x16_bf16 a[48:63], a[40:43], v[40:43], a[48:63]
  v_cvt_pk_bf16_f32 v46, v20, v21
  v_cvt_pk_bf16_f32 v47, v22, v23
  v_exp_f32 v24, v24
  v_exp_f32 v25, v25
  v_exp_f32 v26, v26
  v_mfma_f32_32x32x16_bf16 v[8:23], a[16:19], a[0:3], 0
  v_exp_f32 v27, v27
  v_exp_f32 v28, v28
  v_exp_f32 v29, v29
  v_cvt_pk_bf16_f32 v48, v24, v25
  v_cvt_pk_bf16_f32 v49, v26, v27
  v_smfmac_f32_16x16x64_bf16 a[80:83], a[92:95], v[40:47], v117
  v_exp_f32 v30, v30
  v_exp_f32 v31, v31
  v_exp_f32 v32, v32
  v_cvt_pk_bf16_f32 v50, v28, v29
  v_cvt_pk_bf16_f32 v51, v30, v31
  v_mfma_f32_32x32x16_bf16 v[8:23], a[20:23], a[4:7], v[8:23]
  v_exp_f32 v33, v33
  v_exp_f32 v34, v34
  v_exp_f32 v35, v35
  v_cvt_pk_bf16_f32 v52, v32, v33
  v_cvt_pk_bf16_f32 v53, v34, v35
  v_mfma_f32_32x32x16_bf16 a[48:63], a[44:47], v[44:47], a[48:63]
  v_exp_f32 v36, v36
  v_exp_f32 v37, v37
  v_exp_f32 v38, v38
  v_exp_f32 v39, v39
L_att_kernel_t22:
  v_mfma_f32_32x32x16_bf16 a[64:79], a[40:43], v[48:51], a[64:79]
  ds_read_b128 a[24:27], v3 offset:57344
  v_cvt_pk_bf16_f32 v54, v36, v37
  v_cvt_pk_bf16_f32 v55, v38, v39
  v_exp_f32 v8, v8
  v_exp_f32 v9, v9
  v_exp_f32 v10, v10
  v_mfma_f32_32x32x16_bf16 v[24:39], a[16:19], a[8:11], 0
  ds_read_b128 a[28:31], v3 offset:58368
  v_exp_f32 v11, v11
  v_exp_f32 v12, v12
  v_exp_f32 v13, v13
  v_cvt_pk_bf16_f32 v40, v8, v9
  v_cvt_pk_bf16_f32 v41, v10, v11
  v_smfmac_f32_16x16x64_bf16 a[84:87], a[92:95], v[48:55], v117
  ds_read_b128 a[32:35], v3 offset:51200
  v_exp_f32 v14, v14
  v_exp_f32 v15, v15
  v_exp_f32 v16, v16
  v_cvt_pk_bf16_f32 v42, v12, v13
  v_cvt_pk_bf16_f32 v43, v14, v15
  v_mfma_f32_32x32x16_bf16 v[24:39], a[20:23], a[12:15], v[24:39]
  ds_read_b128 a[36:39], v3 offset:52224
  v_exp_f32 v17, v17
  v_exp_f32 v18, v18
  v_exp_f32 v19, v19
  v_cvt_pk_bf16_f32 v44, v16, v17
  v_cvt_pk_bf16_f32 v45, v18, v19
  v_mfma_f32_32x32x16_bf16 a[64:79], a[44:47], v[52:55], a[64:79]
  s_add_u32 s69, s68, 0
  buffer_load_dwordx4 v[104:107], v2, s[64:67], s69 offen
  v_exp_f32 v20, v20
  v_exp_f32 v21, v21
  v_exp_f32 v22, v22
  v_exp_f32 v23, v23
  s_add_u32 s69, s68, 2048
  buffer_load_dwordx4 v[108:111], v2, s[64:67], s69 offen
  s_waitcnt lgkmcnt(0)
  v_mfma_f32_32x32x16_bf16 a[48:63], a[32:35], v[40:43], a[48:63]
  v_cvt_pk_bf16_f32 v46, v20, v21
  v_cvt_pk_bf16_f32 v47, v22, v23
  v_exp_f32 v24, v24
  v_exp_f32 v25, v25
  v_exp_f32 v26, v26
  v_mfma_f32_32x32x16_bf16 v[8:23], a[24:27], a[0:3], 0
  s_add_u32 s69, s68, 4096
  buffer_load_dwordx4 v[104:107], v2, s[64:67], s69 offen
  v_exp_f32 v27, v27
  v_exp_f32 v28, v28
  v_exp_f32 v29, v29
  v_cvt_pk_bf16_f32 v48, v24, v25
  v_cvt_pk_bf16_f32 v49, v26, v27
  v_smfmac_f32_16x16x64_bf16 a[80:83], a[92:95], v[40:47], v117
  v_exp_f32 v30, v30
  v_exp_f32 v31, v31
  v_exp_f32 v32, v32
  v_cvt_pk_bf16_f32 v50, v28, v29
  v_cvt_pk_bf16_f32 v51, v30, v31
  v_mfma_f32_32x32x16_bf16 v[8:23], a[28:31], a[4:7], v[8:23]
  s_add_u32 s69, s68, 6144
  buffer_load_dwordx4 v[108:111], v2, s[64:67], s69 offen
  v_exp_f32 v33, v33
  v_exp_f32 v34, v34
  v_exp_f32 v35, v35
  v_cvt_pk_bf16_f32 v52, v32, v33
  v_cvt_pk_bf16_f32 v53, v34, v35
  v_mfma_f32_32x32x16_bf16 a[48:63], a[36:39], v[44:47], a[48:63]
  v_exp_f32 v36, v36
  v_exp_f32 v37, v37
  v_exp_f32 v38, v38
  v_exp_f32 v39, v39
L_att_kernel_t23:
  s_waitcnt vmcnt(8)
  s_barrier
  v_mfma_f32_32x32x16_bf16 a[64:79], a[32:35], v[48:51], a[64:79]
  ds_read_b128 a[16:19], v4 offset:0
  v_cvt_pk_bf16_f32 v54, v36, v37
  v_cvt_pk_bf16_f32 v55, v38, v39
  v_exp_f32 v8, v8
  v_exp_f32 v9, v9
  v_exp_f32 v10, v10
  v_mfma_f32_32x32x16_bf16 v[24:39], a[24:27], a[8:11], 0
  ds_read_b128 a[20:23], v4 offset:1024
  v_exp_f32 v11, v11
  v_exp_f32 v12, v12
  v_exp_f32 v13, v13
  v_cvt_pk_bf16_f32 v40, v8, v9
  v_cvt_pk_bf16_f32 v41, v10, v11
  v_smfmac_f32_16x16x64_bf16 a[84:87], a[92:95], v[48:55], v117
  ds_read_b128 a[40:43], v3 offset:59392
  v_exp_f32 v14, v14
  v_exp_f32 v15, v15
  v_exp_f32 v16, v16
  v_cvt_pk_bf16_f32 v42, v12, v13
  v_cvt_pk_bf16_f32 v43, v14, v15
  v_mfma_f32_32x32x16_bf16 v[24:39], a[28:31], a[12:15], v[24:39]
  ds_read_b128 a[44:47], v3 offset:60416
  v_exp_f32 v17, v17
  v_exp_f32 v18, v18
  v_exp_f32 v19, v19
  v_cvt_pk_bf16_f32 v44, v16, v17
  v_cvt_pk_bf16_f32 v45, v18, v19
  v_mfma_f32_32x32x16_bf16 a[64:79], a[36:39], v[52:55], a[64:79]
  s_add_u32 s69, s68, 8192
  buffer_load_dwordx4 v[104:107], v2, s[64:67], s69 offen
  v_exp_f32 v20, v20
  v_exp_f32 v21, v21
  v_exp_f32 v22, v22
  v_exp_f32 v23, v23
  s_add_u32 s69, s68, 10240
  buffer_load_dwordx4 v[108:111], v2, s[64:67], s69 offen
  s_waitcnt lgkmcnt(0)
  v_mfma_f32_32x32x16_bf16 a[48:63], a[40:43], v[40:43], a[48:63]
  v_cvt_pk_bf16_f32 v46, v20, v21
  v_cvt_pk_bf16_f32 v47, v22, v23
  v_exp_f32 v24, v24
  v_exp_f32 v25, v25
  v_exp_f32 v26, v26
  v_mfma_f32_32x32x16_bf16 v[8:23], a[16:19], a[0:3], 0
  s_add_u32 s69, s68, 12288
  buffer_load_dwordx4 v[104:107], v2, s[64:67], s69 offen
  v_exp_f32 v27, v27
  v_exp_f32 v28, v28
  v_exp_f32 v29, v29
  v_cvt_pk_bf16_f32 v48, v24, v25
  v_cvt_pk_bf16_f32 v49, v26, v27
  v_smfmac_f32_16x16x64_bf16 a[80:83], a[92:95], v[40:47], v117
  v_exp_f32 v30, v30
  v_exp_f32 v31, v31
  v_exp_f32 v32, v32
  v_cvt_pk_bf16_f32 v50, v28, v29
  v_cvt_pk_bf16_f32 v51, v30, v31
  v_mfma_f32_32x32x16_bf16 v[8:23], a[20:23], a[4:7], v[8:23]
  s_add_u32 s69, s68, 14336
  buffer_load_dwordx4 v[108:111], v2, s[64:67], s69 offen
  v_exp_f32 v33, v33
  v_exp_f32 v34, v34
  v_exp_f32 v35, v35
  v_cvt_pk_bf16_f32 v52, v32, v33
  v_cvt_pk_bf16_f32 v53, v34, v35
  v_mfma_f32_32x32x16_bf16 a[48:63], a[44:47], v[44:47], a[48:63]
  v_exp_f32 v36, v36
  v_exp_f32 v37, v37
  v_exp_f32 v38, v38
  v_exp_f32 v39, v39
L_att_kernel_t24:
  v_mfma_f32_32x32x16_bf16 a[64:79], a[40:43], v[48:51], a[64:79]
  ds_read_b128 a[24:27], v4 offset:8192
  v_cvt_pk_bf16_f32 v54, v36, v37
  v_cvt_pk_bf16_f32 v55, v38, v39
  v_exp_f32 v8, v8
  v_exp_f32 v9, v9
  v_exp_f32 v10, v10
  v_mfma_f32_32x32x16_bf16 v[24:39], a[16:19], a[8:11], 0
  ds_read_b128 a[28:31], v4 offset:9216
  v_exp_f32 v11, v11
  v_exp_f32 v12, v12
  v_exp_f32 v13, v13
  v_cvt_pk_bf16_f32 v40, v8, v9
  v_cvt_pk_bf16_f32 v41, v10, v11
  v_smfmac_f32_16x16x64_bf16 a[84:87], a[92:95], v[48:55], v117
  ds_read_b128 a[32:35], v4 offset:2048
  v_exp_f32 v14, v14
  v_exp_f32 v15, v15
  v_exp_f32 v16, v16
  v_cvt_pk_bf16_f32 v42, v12, v13
  v_cvt_pk_bf16_f32 v43, v14, v15
  v_mfma_f32_32x32x16_bf16 v[24:39], a[20:23], a[12:15], v[24:39]
  ds_read_b128 a[36:39], v4 offset:3072
  v_exp_f32 v17, v17
  v_exp_f32 v18, v18
  v_exp_f32 v19, v19
  v_cvt_pk_bf16_f32 v44, v16, v17
  v_cvt_pk_bf16_f32 v45, v18, v19
  v_mfma_f32_32x32x16_bf16 a[64:79], a[44:47], v[52:55], a[64:79]
  s_getpc_b64 s[70:71]
L_att_kernel_pcl0:
  s_add_u32 s70, s70, proj_kernel - L_att_kernel_pcl0
  s_addc_u32 s71, s71, 0
  v_lshlrev_b32 v64, 7, v0
  v_min_u32 v64, L_code_end - proj_kernel - 4, v64
  v_mov_b32 v65, s71
  v_add_co_u32 v64, vcc, s70, v64
  s_nop 1
  v_addc_co_u32 v65, vcc, 0, v65, vcc
  global_load_dword v66, v[64:65], off
  v_exp_f32 v20, v20
  v_exp_f32 v21, v21
  v_exp_f32 v22, v22
  v_exp_f32 v23, v23
  s_waitcnt lgkmcnt(0)
  v_mfma_f32_32x32x16_bf16 a[48:63], a[32:35], v[40:43], a[48:63]
  v_cvt_pk_bf16_f32 v46, v20, v21
  v_cvt_pk_bf16_f32 v47, v22, v23
  v_exp_f32 v24, v24
  v_exp_f32 v25, v25
  v_exp_f32 v26, v26
  v_mfma_f32_32x32x16_bf16 v[8:23], a[24:27], a[0:3], 0
  v_exp_f32 v27, v27
  v_exp_f32 v28, v28
  v_exp_f32 v29, v29
  v_cvt_pk_bf16_f32 v48, v24, v25
  v_cvt_pk_bf16_f32 v49, v26, v27
  v_smfmac_f32_16x16x64_bf16 a[80:83], a[92:95], v[40:47], v117
  v_exp_f32 v30, v30
  v_exp_f32 v31, v31
  v_exp_f32 v32, v32
  v_cvt_pk_bf16_f32 v50, v28, v29
  v_cvt_pk_bf16_f32 v51, v30, v31
  v_mfma_f32_32x32x16_bf16 v[8:23], a[28:31], a[4:7], v[8:23]
  v_exp_f32 v33, v33
  v_exp_f32 v34, v34
  v_exp_f32 v35, v35
  v_cvt_pk_bf16_f32 v52, v32, v33
  v_cvt_pk_bf16_f32 v53, v34, v35
  v_mfma_f32_32x32x16_bf16 a[48:63], a[36:39], v[44:47], a[48:63]
  v_exp_f32 v36, v36
  v_exp_f32 v37, v37
  v_exp_f32 v38, v38
  v_exp_f32 v39, v39
L_att_kernel_t25:
  v_mfma_f32_32x32x16_bf16 a[64:79], a[32:35], v[48:51], a[64:79]
  ds_read_b128 a[16:19], v4 offset:16384
  v_cvt_pk_bf16_f32 v54, v36, v37
  v_cvt_pk_bf16_f32 v55, v38, v39
  v_exp_f32 v8, v8
  v_exp_f32 v9, v9
  v_exp_f32 v10, v10
  v_mfma_f32_32x32x16_bf16 v[24:39], a[24:27], a[8:11], 0
  ds_read_b128 a[20:23], v4 offset:17408
  v_exp_f32 v11, v11
  v_exp_f32 v12, v12
  v_exp_f32 v13, v13
  v_cvt_pk_bf16_f32 v40, v8, v9
  v_cvt_pk_bf16_f32 v41, v10, v11
  v_smfmac_f32_16x16x64_bf16 a[84:87], a[92:95], v[48:55], v117
  ds_read_b128 a[40:43], v4 offset:10240
  v_exp_f32 v14, v14
  v_exp_f32 v15, v15
  v_exp_f32 v16, v16
  v_cvt_pk_bf16_f32 v42, v12, v13
  v_cvt_pk_bf16_f32 v43, v14, v15
  v_mfma_f32_32x32x16_bf16 v[24:39], a[28:31], a[12:15], v[24:39]
  ds_read_b128 a[44:47], v4 offset:11264
  v_exp_f32 v17, v17
  v_exp_f32 v18, v18
  v_exp_f32 v19, v19
  v_cvt_pk_bf16_f32 v44, v16, v17
  v_cvt_pk_bf16_f32 v45, v18, v19
  v_mfma_f32_32x32x16_bf16 a[64:79], a[36:39], v[52:55], a[64:79]
  v_exp_f32 v20, v20
  v_exp_f32 v21, v21
  v_exp_f32 v22, v22
  v_exp_f32 v23, v23
  s_waitcnt lgkmcnt(0)
  v_mfma_f32_32x32x16_bf16 a[48:63], a[40:43], v[40:43], a[48:63]
  v_cvt_pk_bf16_f32 v46, v20, v21
  v_cvt_pk_bf16_f32 v47, v22, v23
  v_exp_f32 v24, v24
  v_exp_f32 v25, v25
  v_exp_f32 v26, v26
  v_mfma_f32_32x32x16_bf16 v[8:23], a[16:19], a[0:3], 0
  v_exp_f32 v27, v27
  v_exp_f32 v28, v28
  v_exp_f32 v29, v29
  v_cvt_pk_bf16_f32 v48, v24, v25
  v_cvt_pk_bf16_f32 v49, v26, v27
  v_smfmac_f32_16x16x64_bf16 a[80:83], a[92:95], v[40:47], v117
  v_exp_f32 v30, v30
  v_exp_f32 v31, v31
  v_exp_f32 v32, v32
  v_cvt_pk_bf16_f32 v50, v28, v29
  v_cvt_pk_bf16_f32 v51, v30, v31
  v_mfma_f32_32x32x16_bf16 v[8:23], a[20:23], a[4:7], v[8:23]
  v_exp_f32 v33, v33
  v_exp_f32 v34, v34
  v_exp_f32 v35, v35
  v_cvt_pk_bf16_f32 v52, v32, v33
  v_cvt_pk_bf16_f32 v53, v34, v35
  v_mfma_f32_32x32x16_bf16 a[48:63], a[44:47], v[44:47], a[48:63]
  v_exp_f32 v36, v36
  v_exp_f32 v37, v37
  v_exp_f32 v38, v38
  v_exp_f32 v39, v39
L_att_kernel_t26:
  v_mfma_f32_32x32x16_bf16 a[64:79], a[40:43], v[48:51], a[64:79]
  ds_read_b128 a[24:27], v4 offset:24576
  v_cvt_pk_bf16_f32 v54, v36, v37
  v_cvt_pk_bf16_f32 v55, v38, v39
  v_exp_f32 v8, v8
  v_exp_f32 v9, v9
  v_exp_f32 v10, v10
  v_mfma_f32_32x32x16_bf16 v[24:39], a[16:19], a[8:11], 0
  ds_read_b128 a[28:31], v4 offset:25600
  v_exp_f32 v11, v11
  v_exp_f32 v12, v12
  v_exp_f32 v13, v13
  v_cvt_pk_bf16_f32 v40, v8, v9
  v_cvt_pk_bf16_f32 v41, v10, v11
  v_smfmac_f32_16x16x64_bf16 a[84:87], a[92:95], v[48:55], v117
  ds_read_b128 a[32:35], v4 offset:18432
  v_exp_f32 v14, v14
  v_exp_f32 v15, v15
  v_exp_f32 v16, v16
  v_cvt_pk_bf16_f32 v42, v12, v13
  v_cvt_pk_bf16_f32 v43, v14, v15
  v_mfma_f32_32x32x16_bf16 v[24:39], a[20:23], a[12:15], v[24:39]
  ds_read_b128 a[36:39], v4 offset:19456
  v_exp_f32 v17, v17
  v_exp_f32 v18, v18
  v_exp_f32 v19, v19
  v_cvt_pk_bf16_f32 v44, v16, v17
  v_cvt_pk_bf16_f32 v45, v18, v19
  v_mfma_f32_32x32x16_bf16 a[64:79], a[44:47], v[52:55], a[64:79]
  v_exp_f32 v20, v20
  v_exp_f32 v21, v21
  v_exp_f32 v22, v22
  v_exp_f32 v23, v23
  s_waitcnt lgkmcnt(0)
  v_mfma_f32_32x32x16_bf16 a[48:63], a[32:35], v[40:43], a[48:63]
  v_cvt_pk_bf16_f32 v46, v20, v21
  v_cvt_pk_bf16_f32 v47, v22, v23
  v_exp_f32 v24, v24
  v_exp_f32 v25, v25
  v_exp_f32 v26, v26
  v_mfma_f32_32x32x16_bf16 v[8:23], a[24:27], a[0:3], 0
  v_exp_f32 v27, v27
  v_exp_f32 v28, v28
  v_exp_f32 v29, v29
  v_cvt_pk_bf16_f32 v48, v24, v25
  v_cvt_pk_bf16_f32 v49, v26, v27
  v_smfmac_f32_16x16x64_bf16 a[80:83], a[92:95], v[40:47], v117
  v_exp_f32 v30, v30
  v_exp_f32 v31, v31
  v_exp_f32 v32, v32
  v_cvt_pk_bf16_f32 v50, v28, v29
  v_cvt_pk_bf16_f32 v51, v30, v31
  v_mfma_f32_32x32x16_bf16 v[8:23], a[28:31], a[4:7], v[8:23]
  v_exp_f32 v33, v33
  v_exp_f32 v34, v34
  v_exp_f32 v35, v35
  v_cvt_pk_bf16_f32 v52, v32, v33
  v_cvt_pk_bf16_f32 v53, v34, v35
  v_mfma_f32_32x32x16_bf16 a[48:63], a[36:39], v[44:47], a[48:63]
  v_exp_f32 v36, v36
  v_exp_f32 v37, v37
  v_exp_f32 v38, v38
  v_exp_f32 v39, v39
L_att_kernel_t27:
  s_waitcnt vmcnt(9)
  s_barrier
  v_mfma_f32_32x32x16_bf16 a[64:79], a[32:35], v[48:51], a[64:79]
  ds_read_b128 a[16:19], v4 offset:32768
  v_cvt_pk_bf16_f32 v54, v36, v37
  v_cvt_pk_bf16_f32 v55, v38, v39
  v_exp_f32 v8, v8
  v_exp_f32 v9, v9
  v_exp_f32 v10, v10
  v_mfma_f32_32x32x16_bf16 v[24:39], a[24:27], a[8:11], 0
  ds_read_b128 a[20:23], v4 offset:33792
  v_exp_f32 v11, v11
  v_exp_f32 v12, v12
  v_exp_f32 v13, v13
  v_cvt_pk_bf16_f32 v40, v8, v9
  v_cvt_pk_bf16_f32 v41, v10, v11
  v_smfmac_f32_16x16x64_bf16 a[84:87], a[92:95], v[48:55], v117
  ds_read_b128 a[40:43], v4 offset:26624
  v_exp_f32 v14, v14
  v_exp_f32 v15, v15
  v_exp_f32 v16, v16
  v_cvt_pk_bf16_f32 v42, v12, v13
  v_cvt_pk_bf16_f32 v43, v14, v15
  v_mfma_f32_32x32x16_bf16 v[24:39], a[28:31], a[12:15], v[24:39]
  ds_read_b128 a[44:47], v4 offset:27648
  v_exp_f32 v17, v17
  v_exp_f32 v18, v18
  v_exp_f32 v19, v19
  v_cvt_pk_bf16_f32 v44, v16, v17
  v_cvt_pk_bf16_f32 v45, v18, v19
  v_mfma_f32_32x32x16_bf16 a[64:79], a[36:39], v[52:55], a[64:79]
  v_exp_f32 v20, v20
  v_exp_f32 v21, v21
  v_exp_f32 v22, v22
  v_exp_f32 v23, v23
  s_waitcnt lgkmcnt(0)
  v_mfma_f32_32x32x16_bf16 a[48:63], a[40:43], v[40:43], a[48:63]
  v_cvt_pk_bf16_f32 v46, v20, v21
  v_cvt_pk_bf16_f32 v47, v22, v23
  v_exp_f32 v24, v24
  v_exp_f32 v25, v25
  v_exp_f32 v26, v26
  v_mfma_f32_32x32x16_bf16 v[8:23], a[16:19], a[0:3], 0
  v_exp_f32 v27, v27
  v_exp_f32 v28, v28
  v_exp_f32 v29, v29
  v_cvt_pk_bf16_f32 v48, v24, v25
  v_cvt_pk_bf16_f32 v49, v26, v27
  v_smfmac_f32_16x16x64_bf16 a[80:83], a[92:95], v[40:47], v117
  v_exp_f32 v30, v30
  v_exp_f32 v31, v31
  v_exp_f32 v32, v32
  v_cvt_pk_bf16_f32 v50, v28, v29
  v_cvt_pk_bf16_f32 v51, v30, v31
  v_mfma_f32_32x32x16_bf16 v[8:23], a[20:23], a[4:7], v[8:23]
  v_exp_f32 v33, v33
  v_exp_f32 v34, v34
  v_exp_f32 v35, v35
  v_cvt_pk_bf16_f32 v52, v32, v33
  v_cvt_pk_bf16_f32 v53, v34, v35
  v_mfma_f32_32x32x16_bf16 a[48:63], a[44:47], v[44:47], a[48:63]
  v_exp_f32 v36, v36
  v_exp_f32 v37, v37
  v_exp_f32 v38, v38
  v_exp_f32 v39, v39
L_att_kernel_t28:
  v_mfma_f32_32x32x16_bf16 a[64:79], a[40:43], v[48:51], a[64:79]
  ds_read_b128 a[24:27], v4 offset:40960
  v_cvt_pk_bf16_f32 v54, v36, v37
  v_cvt_pk_bf16_f32 v55, v38, v39
  v_exp_f32 v8, v8
  v_exp_f32 v9, v9
  v_exp_f32 v10, v10
  v_mfma_f32_32x32x16_bf16 v[24:39], a[16:19], a[8:11], 0
  ds_read_b128 a[28:31], v4 offset:41984
  v_exp_f32 v11, v11
  v_exp_f32 v12, v12
  v_exp_f32 v13, v13
  v_cvt_pk_bf16_f32 v40, v8, v9
  v_cvt_pk_bf16_f32 v41, v10, v11
  v_smfmac_f32_16x16x64_bf16 a[84:87], a[92:95], v[48:55], v117
  ds_read_b128 a[32:35], v4 offset:34816
  v_exp_f32 v14, v14
  v_exp_f32 v15, v15
  v_exp_f32 v16, v16
  v_cvt_pk_bf16_f32 v42, v12, v13
  v_cvt_pk_bf16_f32 v43, v14, v15
  v_mfma_f32_32x32x16_bf16 v[24:39], a[20:23], a[12:15], v[24:39]
  ds_read_b128 a[36:39], v4 offset:35840
  v_exp_f32 v17, v17
  v_exp_f32 v18, v18
  v_exp_f32 v19, v19
  v_cvt_pk_bf16_f32 v44, v16, v17
  v_cvt_pk_bf16_f32 v45, v18, v19
  v_mfma_f32_32x32x16_bf16 a[64:79], a[44:47], v[52:55], a[64:79]
  v_exp_f32 v20, v20
  v_exp_f32 v21, v21
  v_exp_f32 v22, v22
  v_exp_f32 v23, v23
  s_waitcnt lgkmcnt(0)
  v_mfma_f32_32x32x16_bf16 a[48:63], a[32:35], v[40:43], a[48:63]
  v_cvt_pk_bf16_f32 v46, v20, v21
  v_cvt_pk_bf16_f32 v47, v22, v23
  v_exp_f32 v24, v24
  v_exp_f32 v25, v25
  v_exp_f32 v26, v26
  v_mfma_f32_32x32x16_bf16 v[8:23], a[24:27], a[0:3], 0
  v_exp_f32 v27, v27
  v_exp_f32 v28, v28
  v_exp_f32 v29, v29
  v_cvt_pk_bf16_f32 v48, v24, v25
  v_cvt_pk_bf16_f32 v49, v26, v27
  v_smfmac_f32_16x16x64_bf16 a[80:83], a[92:95], v[40:47], v117
  v_exp_f32 v30, v30
  v_exp_f32 v31, v31
  v_exp_f32 v32, v32
  v_cvt_pk_bf16_f32 v50, v28, v29
  v_cvt_pk_bf16_f32 v51, v30, v31
  v_mfma_f32_32x32x16_bf16 v[8:23], a[28:31], a[4:7], v[8:23]
  v_exp_f32 v33, v33
  v_exp_f32 v34, v34
  v_exp_f32 v35, v35
  v_cvt_pk_bf16_f32 v52, v32, v33
  v_cvt_pk_bf16_f32 v53, v34, v35
  v_mfma_f32_32x32x16_bf16 a[48:63], a[36:39], v[44:47], a[48:63]
  v_exp_f32 v36, v36
  v_exp_f32 v37, v37
  v_exp_f32 v38, v38
  v_exp_f32 v39, v39
L_att_kernel_t29:
  v_mfma_f32_32x32x16_bf16 a[64:79], a[32:35], v[48:51], a[64:79]
  ds_read_b128 a[16:19], v4 offset:49152
  v_cvt_pk_bf16_f32 v54, v36, v37
  v_cvt_pk_bf16_f32 v55, v38, v39
  v_exp_f32 v8, v8
  v_exp_f32 v9, v9
  v_exp_f32 v10, v10
  v_mfma_f32_32x32x16_bf16 v[24:39], a[24:27], a[8:11], 0
  ds_read_b128 a[20:23], v4 offset:50176
  v_exp_f32 v11, v11
  v_exp_f32 v12, v12
  v_exp_f32 v13, v13
  v_cvt_pk_bf16_f32 v40, v8, v9
  v_cvt_pk_bf16_f32 v41, v10, v11
  v_smfmac_f32_16x16x64_bf16 a[84:87], a[92:95], v[48:55], v117
  ds_read_b128 a[40:43], v4 offset:43008
  v_exp_f32 v14, v14
  v_exp_f32 v15, v15
  v_exp_f32 v16, v16
  v_cvt_pk_bf16_f32 v42, v12, v13
  v_cvt_pk_bf16_f32 v43, v14, v15
  v_mfma_f32_32x32x16_bf16 v[24:39], a[28:31], a[12:15], v[24:39]
  ds_read_b128 a[44:47], v4 offset:44032
  v_exp_f32 v17, v17
  v_exp_f32 v18, v18
  v_exp_f32 v19, v19
  v_cvt_pk_bf16_f32 v44, v16, v17
  v_cvt_pk_bf16_f32 v45, v18, v19
  v_mfma_f32_32x32x16_bf16 a[64:79], a[36:39], v[52:55], a[64:79]
  v_exp_f32 v20, v20
  v_exp_f32 v21, v21
  v_exp_f32 v22, v22
  v_exp_f32 v23, v23
  s_waitcnt lgkmcnt(0)
  v_mfma_f32_32x32x16_bf16 a[48:63], a[40:43], v[40:43], a[48:63]
  v_cvt_pk_bf16_f32 v46, v20, v21
  v_cvt_pk_bf16_f32 v47, v22, v23
  v_exp_f32 v24, v24
  v_exp_f32 v25, v25
  v_exp_f32 v26, v26
  v_mfma_f32_32x32x16_bf16 v[8:23], a[16:19], a[0:3], 0
  v_exp_f32 v27, v27
  v_exp_f32 v28, v28
  v_exp_f32 v29, v29
  v_cvt_pk_bf16_f32 v48, v24, v25
  v_cvt_pk_bf16_f32 v49, v26, v27
  v_smfmac_f32_16x16x64_bf16 a[80:83], a[92:95], v[40:47], v117
  v_exp_f32 v30, v30
  v_exp_f32 v31, v31
  v_exp_f32 v32, v32
  v_cvt_pk_bf16_f32 v50, v28, v29
  v_cvt_pk_bf16_f32 v51, v30, v31
  v_mfma_f32_32x32x16_bf16 v[8:23], a[20:23], a[4:7], v[8:23]
  v_exp_f32 v33, v33
  v_exp_f32 v34, v34
  v_exp_f32 v35, v35
  v_cvt_pk_bf16_f32 v52, v32, v33
  v_cvt_pk_bf16_f32 v53, v34, v35
  v_mfma_f32_32x32x16_bf16 a[48:63], a[44:47], v[44:47], a[48:63]
  v_exp_f32 v36, v36
  v_exp_f32 v37, v37
  v_exp_f32 v38, v38
  v_exp_f32 v39, v39
L_att_kernel_t30:
  v_mfma_f32_32x32x16_bf16 a[64:79], a[40:43], v[48:51], a[64:79]
  ds_read_b128 a[24:27], v4 offset:57344
  v_cvt_pk_bf16_f32 v54, v36, v37
  v_cvt_pk_bf16_f32 v55, v38, v39
  v_exp_f32 v8, v8
  v_exp_f32 v9, v9
  v_exp_f32 v10, v10
  v_mfma_f32_32x32x16_bf16 v[24:39], a[16:19], a[8:11], 0
  ds_read_b128 a[28:31], v4 offset:58368
  v_exp_f32 v11, v11
  v_exp_f32 v12, v12
  v_exp_f32 v13, v13
  v_cvt_pk_bf16_f32 v40, v8, v9
  v_cvt_pk_bf16_f32 v41, v10, v11
  v_smfmac_f32_16x16x64_bf16 a[84:87], a[92:95], v[48:55], v117
  ds_read_b128 a[32:35], v4 offset:51200
  v_exp_f32 v14, v14
  v_exp_f32 v15, v15
  v_exp_f32 v16, v16
  v_cvt_pk_bf16_f32 v42, v12, v13
  v_cvt_pk_bf16_f32 v43, v14, v15
  v_mfma_f32_32x32x16_bf16 v[24:39], a[20:23], a[12:15], v[24:39]
  ds_read_b128 a[36:39], v4 offset:52224
  v_exp_f32 v17, v17
  v_exp_f32 v18, v18
  v_exp_f32 v19, v19
  v_cvt_pk_bf16_f32 v44, v16, v17
  v_cvt_pk_bf16_f32 v45, v18, v19
  v_mfma_f32_32x32x16_bf16 a[64:79], a[44:47], v[52:55], a[64:79]
  v_exp_f32 v20, v20
  v_exp_f32 v21, v21
  v_exp_f32 v22, v22
  v_exp_f32 v23, v23
  s_waitcnt lgkmcnt(0)
  v_mfma_f32_32x32x16_bf16 a[48:63], a[32:35], v[40:43], a[48:63]
  v_cvt_pk_bf16_f32 v46, v20, v21
  v_cvt_pk_bf16_f32 v47, v22, v23
  v_exp_f32 v24, v24
  v_exp_f32 v25, v25
  v_exp_f32 v26, v26
  v_mfma_f32_32x32x16_bf16 v[8:23], a[24:27], a[0:3], 0
  v_exp_f32 v27, v27
  v_exp_f32 v28, v28
  v_exp_f32 v29, v29
  v_cvt_pk_bf16_f32 v48, v24, v25
  v_cvt_pk_bf16_f32 v49, v26, v27
  v_smfmac_f32_16x16x64_bf16 a[80:83], a[92:95], v[40:47], v117
  v_exp_f32 v30, v30
  v_exp_f32 v31, v31
  v_exp_f32 v32, v32
  v_cvt_pk_bf16_f32 v50, v28, v29
  v_cvt_pk_bf16_f32 v51, v30, v31
  v_mfma_f32_32x32x16_bf16 v[8:23], a[28:31], a[4:7], v[8:23]
  v_exp_f32 v33, v33
  v_exp_f32 v34, v34
  v_exp_f32 v35, v35
  v_cvt_pk_bf16_f32 v52, v32, v33
  v_cvt_pk_bf16_f32 v53, v34, v35
  v_mfma_f32_32x32x16_bf16 a[48:63], a[36:39], v[44:47], a[48:63]
  v_exp_f32 v36, v36
  v_exp_f32 v37, v37
  v_exp_f32 v38, v38
  v_exp_f32 v39, v39
L_att_kernel_t31:
  v_mfma_f32_32x32x16_bf16 a[64:79], a[32:35], v[48:51], a[64:79]
  ds_read_b128 a[40:43], v4 offset:59392
  v_cvt_pk_bf16_f32 v54, v36, v37
  v_cvt_pk_bf16_f32 v55, v38, v39
  v_exp_f32 v8, v8
  v_exp_f32 v9, v9
  v_exp_f32 v10, v10
  v_mfma_f32_32x32x16_bf16 v[24:39], a[24:27], a[8:11], 0
  ds_read_b128 a[44:47], v4 offset:60416
  v_exp_f32 v11, v11
  v_exp_f32 v12, v12
  v_exp_f32 v13, v13
  v_cvt_pk_bf16_f32 v40, v8, v9
  v_cvt_pk_bf16_f32 v41, v10, v11
  v_smfmac_f32_16x16x64_bf16 a[84:87], a[92:95], v[48:55], v117
  v_exp_f32 v14, v14
  v_exp_f32 v15, v15
  v_exp_f32 v16, v16
  v_cvt_pk_bf16_f32 v42, v12, v13
  v_cvt_pk_bf16_f32 v43, v14, v15
  v_mfma_f32_32x32x16_bf16 v[24:39], a[28:31], a[12:15], v[24:39]
  v_exp_f32 v17, v17
  v_exp_f32 v18, v18
  v_exp_f32 v19, v19
  v_cvt_pk_bf16_f32 v44, v16, v17
  v_cvt_pk_bf16_f32 v45, v18, v19
  v_mfma_f32_32x32x16_bf16 a[64:79], a[36:39], v[52:55], a[64:79]
  v_exp_f32 v20, v20
  v_exp_f32 v21, v21
  v_exp_f32 v22, v22
  v_exp_f32 v23, v23
  s_waitcnt lgkmcnt(0)
  v_mfma_f32_32x32x16_bf16 a[48:63], a[40:43], v[40:43], a[48:63]
  v_cvt_pk_bf16_f32 v46, v20, v21
  v_cvt_pk_bf16_f32 v47, v22, v23
  v_exp_f32 v24, v24
  v_exp_f32 v25, v25
  v_exp_f32 v26, v26
  v_exp_f32 v27, v27
  v_exp_f32 v28, v28
  v_exp_f32 v29, v29
  v_cvt_pk_bf16_f32 v48, v24, v25
  v_cvt_pk_bf16_f32 v49, v26, v27
  v_smfmac_f32_16x16x64_bf16 a[80:83], a[92:95], v[40:47], v117
  v_exp_f32 v30, v30
  v_exp_f32 v31, v31
  v_exp_f32 v32, v32
  v_cvt_pk_bf16_f32 v50, v28, v29
  v_cvt_pk_bf16_f32 v51, v30, v31
  v_exp_f32 v33, v33
  v_exp_f32 v34, v34
  v_exp_f32 v35, v35
  v_cvt_pk_bf16_f32 v52, v32, v33
  v_cvt_pk_bf16_f32 v53, v34, v35
  v_mfma_f32_32x32x16_bf16 a[48:63], a[44:47], v[44:47], a[48:63]
  v_exp_f32 v36, v36
  v_exp_f32 v37, v37
  v_exp_f32 v38, v38
  v_exp_f32 v39, v39
  s_nop 0
  v_cvt_pk_bf16_f32 v54, v36, v37
  v_cvt_pk_bf16_f32 v55, v38, v39
  s_nop 1
  v_mfma_f32_32x32x16_bf16 a[64:79], a[40:43], v[48:51], a[64:79]
  v_mfma_f32_32x32x16_bf16 a[64:79], a[44:47], v[52:55], a[64:79]
  v_smfmac_f32_16x16x64_bf16 a[84:87], a[92:95], v[48:55], v117
L_att_kernel_epi:
  s_lshl_b32 s20, s12, 12
  v_add_u32 v3, s20, v2
  s_xor_b32 s21, s20, 0x4000
  v_add_u32 v4, s21, v2
  s_lshl_b32 s20, s12, 8
  s_add_u32 s20, s20, 0x8000
  s_xor_b32 s21, s20, 0x400
  v_lshlrev_b32 v6, 2, v1
  v_add_u32 v7, s21, v6
  v_add_u32 v6, s20, v6
  s_nop 7
  s_cmp_eq_u32 s13, 0
  s_cbranch_scc0 L_att_kernel_x1
  ds_write_b128 v3, a[64:67] offset:0
  ds_write_b128 v3, a[68:71] offset:1024
  ds_write_b128 v3, a[72:75] offset:2048
  ds_write_b128 v3, a[76:79] offset:3072
  v_accvgpr_read_b32 v24, a84
  v_accvgpr_read_b32 v25, a85
  v_accvgpr_read_b32 v5, a80
  v_accvgpr_read_b32 v26, a81
  v_add_f32 v24, v24, v25
  v_add_f32 v5, v5, v26
  ds_write_b32 v6, v24
  v_accvgpr_read_b32 v8, a48
  v_accvgpr_read_b32 v9, a49
  v_accvgpr_read_b32 v10, a50
  v_accvgpr_read_b32 v11, a51
  v_accvgpr_read_b32 v12, a52
  v_accvgpr_read_b32 v13, a53
  v_accvgpr_read_b32 v14, a54
  v_accvgpr_read_b32 v15, a55
  v_accvgpr_read_b32 v16, a56
  v_accvgpr_read_b32 v17, a57
  v_accvgpr_read_b32 v18, a58
  v_accvgpr_read_b32 v19, a59
  v_accvgpr_read_b32 v20, a60
  v_accvgpr_read_b32 v21, a61
  v_accvgpr_read_b32 v22, a62
  v_accvgpr_read_b32 v23, a63
  s_branch L_att_kernel_x2
L_att_kernel_x1:
  ds_write_b128 v3, a[48:51] offset:0
  ds_write_b128 v3, a[52:55] offset:1024
  ds_write_b128 v3, a[56:59] offset:2048
  ds_write_b128 v3, a[60:63] offset:3072
  v_accvgpr_read_b32 v24, a80
  v_accvgpr_read_b32 v25, a81
  v_accvgpr_read_b32 v5, a84
  v_accvgpr_read_b32 v26, a85
  v_add_f32 v24, v24, v25
  v_add_f32 v5, v5, v26
  ds_write_b32 v6, v24
  v_accvgpr_read_b32 v8, a64
  v_accvgpr_read_b32 v9, a65
  v_accvgpr_read_b32 v10, a66
  v_accvgpr_read_b32 v11, a67
  v_accvgpr_read_b32 v12, a68
  v_accvgpr_read_b32 v13, a69
  v_accvgpr_read_b32 v14, a70
  v_accvgpr_read_b32 v15, a71
  v_accvgpr_read_b32 v16, a72
  v_accvgpr_read_b32 v17, a73
  v_accvgpr_read_b32 v18, a74
  v_accvgpr_read_b32 v19, a75
  v_accvgpr_read_b32 v20, a76
  v_accvgpr_read_b32 v21, a77
  v_accvgpr_read_b32 v22, a78
  v_accvgpr_read_b32 v23, a79
L_att_kernel_x2:
  s_waitcnt lgkmcnt(0)
  s_barrier
  ds_read_b128 v[24:27], v4 offset:0
  ds_read_b128 v[28:31], v4 offset:1024
  ds_read_b128 v[32:35], v4 offset:2048
  ds_read_b128 v[36:39], v4 offset:3072
  ds_read_b32 v7, v7
  s_waitcnt lgkmcnt(0)
  v_add_f32 v5, v5, v7
  v_add_f32 v8, v8, v24
  v_add_f32 v9, v9, v25
  v_add_f32 v10, v10, v26
  v_add_f32 v11, v11, v27
  v_add_f32 v12, v12, v28
  v_add_f32 v13, v13, v29
  v_add_f32 v14, v14, v30
  v_add_f32 v15, v15, v31
  v_add_f32 v16, v16, v32
  v_add_f32 v17, v17, v33
  v_add_f32 v18, v18, v34
  v_add_f32 v19, v19, v35
  v_add_f32 v20, v20, v36
  v_add_f32 v21, v21, v37
  v_add_f32 v22, v22, v38
  v_add_f32 v23, v23, v39
  v_mov_b32 v6, 0
  v_fma_f32 v6, v8, 0, v6
  v_fma_f32 v6, v9, 0, v6
  v_fma_f32 v6, v10, 0, v6
  v_fma_f32 v6, v11, 0, v6
  v_fma_f32 v6, v12, 0, v6
  v_fma_f32 v6, v13, 0, v6
  v_fma_f32 v6, v14, 0, v6
  v_fma_f32 v6, v15, 0, v6
  v_fma_f32 v6, v16, 0, v6
  v_fma_f32 v6, v17, 0, v6
  v_fma_f32 v6, v18, 0, v6
  v_fma_f32 v6, v19, 0, v6
  v_fma_f32 v6, v20, 0, v6
  v_fma_f32 v6, v21, 0, v6
  v_fma_f32 v6, v22, 0, v6
  v_fma_f32 v6, v23, 0, v6
  v_mov_b32 v7, 0x5d800000
  v_cmp_le_f32 vcc, 0x2b800000, v5
  v_cmp_ge_f32 s[20:21], v7, v5
  v_cmp_eq_f32 s[22:23], 0, v6
  s_nop 1
  s_and_b64 vcc, vcc, s[20:21]
  s_and_b64 vcc, vcc, s[22:23]
  s_cmp_eq_u64 vcc, -1
  s_cbranch_scc0 L_att_kernel_slow
L_att_kernel_fin:
  v_rcp_f32 v6, v5
  s_lshl_b32 s20, s33, 17
  s_add_u32 s21, s15, 0
  s_lshl_b32 s21, s21, 11
  s_add_u32 s20, s20, s21
  s_add_u32 s20, s20, 25165824
  v_mul_f32 v6, v6, v101
  v_mul_f32 v8, v8, v6
  v_mul_f32 v9, v9, v6
  v_mul_f32 v10, v10, v6
  v_mul_f32 v11, v11, v6
  v_mul_f32 v12, v12, v6
  v_mul_f32 v13, v13, v6
  v_mul_f32 v14, v14, v6
  v_mul_f32 v15, v15, v6
  v_mul_f32 v16, v16, v6
  v_mul_f32 v17, v17, v6
  v_mul_f32 v18, v18, v6
  v_mul_f32 v19, v19, v6
  v_mul_f32 v20, v20, v6
  v_mul_f32 v21, v21, v6
  v_mul_f32 v22, v22, v6
  v_mul_f32 v23, v23, v6
  v_cvt_pk_bf16_f32 v40, v8, v9
  v_cvt_pk_bf16_f32 v41, v10, v11
  v_cvt_pk_bf16_f32 v42, v12, v13
  v_cvt_pk_bf16_f32 v43, v14, v15
  buffer_store_dwordx4 v[40:43], v2, s[8:11], s20 offen offset:0 sc1
  v_cvt_pk_bf16_f32 v44, v16, v17
  v_cvt_pk_bf16_f32 v45, v18, v19
  v_cvt_pk_bf16_f32 v46, v20, v21
  v_cvt_pk_bf16_f32 v47, v22, v23
  buffer_store_dwordx4 v[44:47], v2, s[8:11], s20 offen offset:1024 sc1
  s_endpgm
L_att_kernel_slow:
  s_lshl_b32 s20, s15, 17
  s_lshl_b32 s21, s33, 11
  s_add_u32 s21, s21, s20
  s_add_u32 s22, s20, 4194304
  s_add_u32 s23, s20, 8388608
  buffer_load_dwordx4 v[40:43], v2, s[8:11], s21 offen
  buffer_load_dwordx4 v[44:47], v2, s[8:11], s21 offen offset:1024
  v_mov_b32 v110, 0xff800000
  v_mov_b32 v5, 0
  v_mov_b32 v8, 0
  v_mov_b32 v9, 0
  v_mov_b32 v10, 0
  v_mov_b32 v11, 0
  v_mov_b32 v12, 0
  v_mov_b32 v13, 0
  v_mov_b32 v14, 0
  v_mov_b32 v15, 0
  v_mov_b32 v16, 0
  v_mov_b32 v17, 0
  v_mov_b32 v18, 0
  v_mov_b32 v19, 0
  v_mov_b32 v20, 0
  v_mov_b32 v21, 0
  v_mov_b32 v22, 0
  v_mov_b32 v23, 0
  s_mov_b32 s35, 0
L_att_kernel_sloop:
  buffer_load_dwordx4 v[48:51], v2, s[8:11], s22 offen
  buffer_load_dwordx4 v[52:55], v2, s[8:11], s22 offen offset:1024
  buffer_load_dwordx4 v[102:105], v2, s[8:11], s23 offen
  buffer_load_dwordx4 v[106:109], v2, s[8:11], s23 offen offset:1024
  s_add_u32 s22, s22, 2048
  s_add_u32 s23, s23, 2048
  s_waitcnt vmcnt(0)
  v_mfma_f32_32x32x16_bf16 v[24:39], v[48:51], v[40:43], 0
  v_mfma_f32_32x32x16_bf16 v[24:39], v[52:55], v[44:47], v[24:39]
  s_nop 7
  s_nop 7
  v_max3_f32 v112, v24, v25, v110
  v_max3_f32 v112, v26, v27, v112
  v_max3_f32 v112, v28, v29, v112
  v_max3_f32 v112, v30, v31, v112
  v_max3_f32 v112, v32, v33, v112
  v_max3_f32 v112, v34, v35, v112
  v_max3_f32 v112, v36, v37, v112
  v_max3_f32 v112, v38, v39, v112
  v_mov_b32 v113, v112
  s_nop 1
  v_permlane32_swap_b32 v112, v113
  v_max_f32 v112, v112, v113
  v_sub_f32 v111, v110, v112
  v_exp_f32 v111, v111
  v_mov_b32 v110, v112
  s_nop 0
  v_mul_f32 v5, v5, v111
  v_sub_f32 v24, v24, v110
  v_sub_f32 v25, v25, v110
  v_sub_f32 v26, v26, v110
  v_sub_f32 v27, v27, v110
  v_sub_f32 v28, v28, v110
  v_sub_f32 v29, v29, v110
  v_sub_f32 v30, v30, v110
  v_sub_f32 v31, v31, v110
  v_sub_f32 v32, v32, v110
  v_sub_f32 v33, v33, v110
  v_sub_f32 v34, v34, v110
  v_sub_f32 v35, v35, v110
  v_sub_f32 v36, v36, v110
  v_sub_f32 v37, v37, v110
  v_sub_f32 v38, v38, v110
  v_sub_f32 v39, v39, v110
  v_exp_f32 v24, v24
  v_exp_f32 v25, v25
  v_exp_f32 v26, v26
  v_exp_f32 v27, v27
  v_exp_f32 v28, v28
  v_exp_f32 v29, v29
  v_exp_f32 v30, v30
  v_exp_f32 v31, v31
  v_exp_f32 v32, v32
  v_exp_f32 v33, v33
  v_exp_f32 v34, v34
  v_exp_f32 v35, v35
  v_exp_f32 v36, v36
  v_exp_f32 v37, v37
  v_exp_f32 v38, v38
  v_exp_f32 v39, v39
  s_nop 0
  v_add_f32 v5, v5, v24
  v_add_f32 v5, v5, v25
  v_add_f32 v5, v5, v26
  v_add_f32 v5, v5, v27
  v_add_f32 v5, v5, v28
  v_add_f32 v5, v5, v29
  v_add_f32 v5, v5, v30
  v_add_f32 v5, v5, v31
  v_add_f32 v5, v5, v32
  v_add_f32 v5, v5, v33
  v_add_f32 v5, v5, v34
  v_add_f32 v5, v5, v35
  v_add_f32 v5, v5, v36
  v_add_f32 v5, v5, v37
  v_add_f32 v5, v5, v38
  v_add_f32 v5, v5, v39
  v_mul_f32 v8, v8, v111
  v_mul_f32 v9, v9, v111
  v_mul_f32 v10, v10, v111
  v_mul_f32 v11, v11, v111
  v_mul_f32 v12, v12, v111
  v_mul_f32 v13, v13, v111
  v_mul_f32 v14, v14, v111
  v_mul_f32 v15, v15, v111
  v_mul_f32 v16, v16, v111
  v_mul_f32 v17, v17, v111
  v_mul_f32 v18, v18, v111
  v_mul_f32 v19, v19, v111
  v_mul_f32 v20, v20, v111
  v_mul_f32 v21, v21, v111
  v_mul_f32 v22, v22, v111
  v_mul_f32 v23, v23, v111
  v_cvt_pk_bf16_f32 v56, v24, v25
  v_cvt_pk_bf16_f32 v57, v26, v27
  v_cvt_pk_bf16_f32 v58, v28, v29
  v_cvt_pk_bf16_f32 v59, v30, v31
  v_cvt_pk_bf16_f32 v60, v32, v33
  v_cvt_pk_bf16_f32 v61, v34, v35
  v_cvt_pk_bf16_f32 v62, v36, v37
  v_cvt_pk_bf16_f32 v63, v38, v39
  s_nop 1
  v_mfma_f32_32x32x16_bf16 v[8:23], v[102:105], v[56:59], v[8:23]
  v_mfma_f32_32x32x16_bf16 v[8:23], v[106:109], v[60:63], v[8:23]
  s_nop 7
  s_nop 7
  s_add_u32 s35, s35, 1
  s_cmp_lt_u32 s35, 64
  s_cbranch_scc1 L_att_kernel_sloop
  v_mov_b32 v112, v5
  s_nop 1
  v_permlane32_swap_b32 v5, v112
  v_add_f32 v5, v5, v112
  s_branch L_att_kernel_fin
L_att_kernel_end:
  s_endpgm
.section .rodata,"a"
.p2align 6
.amdhsa_kernel att_kernel
  .amdhsa_next_free_vgpr 256
  .amdhsa_next_free_sgpr 96
  .amdhsa_accum_offset 128
  .amdhsa_group_segment_fixed_size 0
  .amdhsa_kernarg_size 80
  .amdhsa_user_sgpr_count 2
  .amdhsa_user_sgpr_kernarg_segment_ptr 1
  .amdhsa_system_sgpr_workgroup_id_x 1
  .amdhsa_float_denorm_mode_32 3
.end_amdhsa_kernel
.text
.text
.globl proj_kernel
.p2align 8
.type proj_kernel,@function
proj_kernel:
  s_cmp_lt_u32 s2, 256
  s_cbranch_scc1 L_proj_kernel_go
  s_endpgm
L_proj_kernel_go:
  s_load_dwordx2 s[4:5], s[0:1], 72
  s_load_dwordx2 s[6:7], s[0:1], 16
  s_load_dwordx2 s[34:35], s[0:1], 40
  s_load_dwordx2 s[36:37], s[0:1], 56
  v_and_b32 v1, 63, v0
  v_lshrrev_b32 v5, 6, v0
  s_and_b32 s32, s2, 7
  v_readfirstlane_b32 s24, v5
  s_lshr_b32 s33, s2, 3
  s_lshr_b32 s25, s32, 1
  s_lshl_b32 s25, s25, 2
  s_and_b32 s26, s33, 3
  s_add_u32 s25, s25, s26
  s_and_b32 s26, s32, 1
  s_lshl_b32 s26, s26, 3
  s_lshr_b32 s33, s33, 2
  s_add_u32 s26, s26, s33
  v_lshlrev_b32 v2, 4, v1
  s_lshl_b32 s27, s25, 2
  s_add_u32 s27, s27, s24
  s_lshl_b32 s27, s27, 17
  s_add_u32 s27, s27, 25165824
  s_lshl_b32 s29, s24, 10
  v_lshrrev_b32 v5, 3, v1
  s_lshl_b32 s32, s24, 3
  v_add_u32 v3, s32, v5
  v_lshlrev_b32 v3, 11, v3
  v_and_b32 v6, 7, v1
  v_bfe_u32 v5, v1, 4, 1
  v_lshlrev_b32 v5, 2, v5
  v_xor_b32 v5, v5, v6
  v_lshlrev_b32 v5, 4, v5
  s_lshl_b32 s32, s26, 7
  v_add3_u32 v3, v3, v5, s32
  v_lshrrev_b32 v5, 5, v1
  v_lshlrev_b32 v4, 9, v5
  v_bfe_u32 v5, v1, 2, 2
  v_lshlrev_b32 v6, 7, v5
  v_add_u32 v4, v4, v6
  v_lshrrev_b32 v5, 1, v5
  v_lshlrev_b32 v5, 6, v5
  v_bfe_u32 v6, v1, 4, 1
  v_lshlrev_b32 v6, 5, v6
  v_add3_u32 v4, v4, v5, v6
  v_and_b32 v5, 3, v1
  v_lshlrev_b32 v5, 3, v5
  v_add_u32 v4, v4, v5
  v_xor_b32 v6, 64, v4
  v_add_u32 v7, 0x10000, v4
  s_waitcnt lgkmcnt(0)
  v_xor_b32 v5, 64, v7
  s_mov_b32 s8, s4
  s_and_b32 s9, s5, 0xffff
  s_mov_b32 s10, 0x3000000
  s_mov_b32 s11, 0x20000
  s_mov_b32 s12, s6
  s_and_b32 s13, s7, 0xffff
  s_mov_b32 s14, 0x200000
  s_mov_b32 s15, 0x20000
  s_mov_b32 s16, s34
  s_and_b32 s17, s35, 0xffff
  s_mov_b32 s18, 0x200000
  s_mov_b32 s19, 0x20000
  s_mov_b32 s20, s36
  s_and_b32 s21, s37, 0xffff
  s_mov_b32 s22, 0x400000
  s_mov_b32 s23, 0x20000
  s_lshl_b32 s32, s25, 2
  s_add_u32 s32, s32, s24
  s_lshl_b32 s32, s32, 7
  s_add_u32 s32, s32, 33562624
  v_and_b32 v97, 31, v1
  v_lshlrev_b32 v97, 2, v97
  buffer_load_dword v96, v97, s[8:11], s32 offen
  s_add_u32 m0, s29, 0
  s_mov_b32 s30, 0
  buffer_load_dwordx4 v3, s[16:19], s30 offen lds
  s_add_u32 m0, s29, 4096
  s_mov_b32 s30, 65536
  buffer_load_dwordx4 v3, s[16:19], s30 offen lds
  s_add_u32 m0, s29, 8192
  s_mov_b32 s30, 131072
  buffer_load_dwordx4 v3, s[16:19], s30 offen lds
  s_add_u32 m0, s29, 12288
  s_mov_b32 s30, 196608
  buffer_load_dwordx4 v3, s[16:19], s30 offen lds
  s_add_u32 m0, s29, 16384
  s_mov_b32 s30, 262144
  buffer_load_dwordx4 v3, s[16:19], s30 offen lds
  s_add_u32 s28, s27, 65536
  buffer_load_dwordx4 v[40:43], v2, s[8:11], s28 offen offset:0
  buffer_load_dwordx4 v[44:47], v2, s[8:11], s28 offen offset:1024
  s_barrier
  s_add_u32 m0, s29, 20480
  s_mov_b32 s30, 327680
  buffer_load_dwordx4 v3, s[16:19], s30 offen lds
  s_add_u32 s28, s27, 67584
  buffer_load_dwordx4 v[48:51], v2, s[8:11], s28 offen offset:0
  buffer_load_dwordx4 v[52:55], v2, s[8:11], s28 offen offset:1024
  s_add_u32 m0, s29, 24576
  s_mov_b32 s30, 393216
  buffer_load_dwordx4 v3, s[16:19], s30 offen lds
  s_add_u32 s28, s27, 69632
  buffer_load_dwordx4 v[56:59], v2, s[8:11], s28 offen offset:0
  buffer_load_dwordx4 v[60:63], v2, s[8:11], s28 offen offset:1024
  s_add_u32 m0, s29, 28672
  s_mov_b32 s30, 458752
  buffer_load_dwordx4 v3, s[16:19], s30 offen lds
  s_add_u32 s28, s27, 71680
  buffer_load_dwordx4 v[64:67], v2, s[8:11], s28 offen offset:0
  buffer_load_dwordx4 v[68:71], v2, s[8:11], s28 offen offset:1024
  s_add_u32 m0, s29, 32768
  s_mov_b32 s30, 524288
  buffer_load_dwordx4 v3, s[16:19], s30 offen lds
  s_add_u32 s28, s27, 73728
  buffer_load_dwordx4 v[72:75], v2, s[8:11], s28 offen offset:0
  buffer_load_dwordx4 v[76:79], v2, s[8:11], s28 offen offset:1024
  s_add_u32 m0, s29, 36864
  s_mov_b32 s30, 589824
  buffer_load_dwordx4 v3, s[16:19], s30 offen lds
  s_add_u32 s28, s27, 75776
  buffer_load_dwordx4 v[80:83], v2, s[8:11], s28 offen offset:0
  buffer_load_dwordx4 v[84:87], v2, s[8:11], s28 offen offset:1024
  s_waitcnt vmcnt(18)
  s_barrier
  ds_read_b64_tr_b16 v[8:9], v4 offset:0
  ds_read_b64_tr_b16 v[10:11], v4 offset:1024
  ds_read_b64_tr_b16 v[12:13], v6 offset:0
  ds_read_b64_tr_b16 v[14:15], v6 offset:1024
  ds_read_b64_tr_b16 v[16:17], v4 offset:2048
  ds_read_b64_tr_b16 v[18:19], v4 offset:3072
  ds_read_b64_tr_b16 v[20:21], v6 offset:2048
  ds_read_b64_tr_b16 v[22:23], v6 offset:3072
  s_waitcnt vmcnt(15)
  s_waitcnt lgkmcnt(6)
  v_mfma_f32_32x32x16_bf16 v[100:115], v[8:11], v[40:43], 0
  ds_read_b64_tr_b16 v[24:25], v4 offset:4096
  ds_read_b64_tr_b16 v[26:27], v4 offset:5120
  s_waitcnt lgkmcnt(6)
  v_mfma_f32_32x32x16_bf16 v[116:131], v[12:15], v[40:43], 0
  ds_read_b64_tr_b16 v[28:29], v6 offset:4096
  ds_read_b64_tr_b16 v[30:31], v6 offset:5120
  s_waitcnt lgkmcnt(6)
  v_mfma_f32_32x32x16_bf16 v[100:115], v[16:19], v[44:47], v[100:115]
  ds_read_b64_tr_b16 v[32:33], v4 offset:6144
  ds_read_b64_tr_b16 v[34:35], v4 offset:7168
  s_waitcnt lgkmcnt(6)
  v_mfma_f32_32x32x16_bf16 v[116:131], v[20:23], v[44:47], v[116:131]
  ds_read_b64_tr_b16 v[36:37], v6 offset:6144
  ds_read_b64_tr_b16 v[38:39], v6 offset:7168
  s_add_u32 m0, s29, 40960
  s_mov_b32 s30, 655360
  buffer_load_dwordx4 v3, s[16:19], s30 offen lds
  s_add_u32 s28, s27, 77824
  buffer_load_dwordx4 v[88:91], v2, s[8:11], s28 offen offset:0
  buffer_load_dwordx4 v[92:95], v2, s[8:11], s28 offen offset:1024
  s_waitcnt vmcnt(15)
  s_waitcnt lgkmcnt(6)
  v_mfma_f32_32x32x16_bf16 v[100:115], v[24:27], v[48:51], v[100:115]
  ds_read_b64_tr_b16 v[8:9], v4 offset:8192
  ds_read_b64_tr_b16 v[10:11], v4 offset:9216
  s_waitcnt lgkmcnt(6)
  v_mfma_f32_32x32x16_bf16 v[116:131], v[28:31], v[48:51], v[116:131]
  ds_read_b64_tr_b16 v[12:13], v6 offset:8192
  ds_read_b64_tr_b16 v[14:15], v6 offset:9216
  s_waitcnt lgkmcnt(6)
  v_mfma_f32_32x32x16_bf16 v[100:115], v[32:35], v[52:55], v[100:115]
  ds_read_b64_tr_b16 v[16:17], v4 offset:10240
  ds_read_b64_tr_b16 v[18:19], v4 offset:11264
  s_waitcnt lgkmcnt(6)
  v_mfma_f32_32x32x16_bf16 v[116:131], v[36:39], v[52:55], v[116:131]
  ds_read_b64_tr_b16 v[20:21], v6 offset:10240
  ds_read_b64_tr_b16 v[22:23], v6 offset:11264
  s_add_u32 m0, s29, 45056
  s_mov_b32 s30, 720896
  buffer_load_dwordx4 v3, s[16:19], s30 offen lds
  s_add_u32 s28, s27, 79872
  buffer_load_dwordx4 v[40:43], v2, s[8:11], s28 offen offset:0
  buffer_load_dwordx4 v[44:47], v2, s[8:11], s28 offen offset:1024
  s_waitcnt vmcnt(15)
  s_waitcnt lgkmcnt(6)
  v_mfma_f32_32x32x16_bf16 v[100:115], v[8:11], v[56:59], v[100:115]
  ds_read_b64_tr_b16 v[24:25], v4 offset:12288
  ds_read_b64_tr_b16 v[26:27], v4 offset:13312
  s_waitcnt lgkmcnt(6)
  v_mfma_f32_32x32x16_bf16 v[116:131], v[12:15], v[56:59], v[116:131]
  ds_read_b64_tr_b16 v[28:29], v6 offset:12288
  ds_read_b64_tr_b16 v[30:31], v6 offset:13312
  s_waitcnt lgkmcnt(6)
  v_mfma_f32_32x32x16_bf16 v[100:115], v[16:19], v[60:63], v[100:115]
  ds_read_b64_tr_b16 v[32:33], v4 offset:14336
  ds_read_b64_tr_b16 v[34:35], v4 offset:15360
  s_waitcnt lgkmcnt(6)
  v_mfma_f32_32x32x16_bf16 v[116:131], v[20:23], v[60:63], v[116:131]
  ds_read_b64_tr_b16 v[36:37], v6 offset:14336
  ds_read_b64_tr_b16 v[38:39], v6 offset:15360
  s_add_u32 m0, s29, 49152
  s_mov_b32 s30, 786432
  buffer_load_dwordx4 v3, s[16:19], s30 offen lds
  s_add_u32 s28, s27, 81920
  buffer_load_dwordx4 v[48:51], v2, s[8:11], s28 offen offset:0
  buffer_load_dwordx4 v[52:55], v2, s[8:11], s28 offen offset:1024
  s_waitcnt vmcnt(17)
  s_barrier
  s_waitcnt vmcnt(15)
  s_waitcnt lgkmcnt(6)
  v_mfma_f32_32x32x16_bf16 v[100:115], v[24:27], v[64:67], v[100:115]
  ds_read_b64_tr_b16 v[8:9], v4 offset:16384
  ds_read_b64_tr_b16 v[10:11], v4 offset:17408
  s_waitcnt lgkmcnt(6)
  v_mfma_f32_32x32x16_bf16 v[116:131], v[28:31], v[64:67], v[116:131]
  ds_read_b64_tr_b16 v[12:13], v6 offset:16384
  ds_read_b64_tr_b16 v[14:15], v6 offset:17408
  s_waitcnt lgkmcnt(6)
  v_mfma_f32_32x32x16_bf16 v[100:115], v[32:35], v[68:71], v[100:115]
  ds_read_b64_tr_b16 v[16:17], v4 offset:18432
  ds_read_b64_tr_b16 v[18:19], v4 offset:19456
  s_waitcnt lgkmcnt(6)
  v_mfma_f32_32x32x16_bf16 v[116:131], v[36:39], v[68:71], v[116:131]
  ds_read_b64_tr_b16 v[20:21], v6 offset:18432
  ds_read_b64_tr_b16 v[22:23], v6 offset:19456
  s_add_u32 m0, s29, 53248
  s_mov_b32 s30, 851968
  buffer_load_dwordx4 v3, s[16:19], s30 offen lds
  s_add_u32 s28, s27, 83968
  buffer_load_dwordx4 v[56:59], v2, s[8:11], s28 offen offset:0
  buffer_load_dwordx4 v[60:63], v2, s[8:11], s28 offen offset:1024
  s_waitcnt vmcnt(15)
  s_waitcnt lgkmcnt(6)
  v_mfma_f32_32x32x16_bf16 v[100:115], v[8:11], v[72:75], v[100:115]
  ds_read_b64_tr_b16 v[24:25], v4 offset:20480
  ds_read_b64_tr_b16 v[26:27], v4 offset:21504
  s_waitcnt lgkmcnt(6)
  v_mfma_f32_32x32x16_bf16 v[116:131], v[12:15], v[72:75], v[116:131]
  ds_read_b64_tr_b16 v[28:29], v6 offset:20480
  ds_read_b64_tr_b16 v[30:31], v6 offset:21504
  s_waitcnt lgkmcnt(6)
  v_mfma_f32_32x32x16_bf16 v[100:115], v[16:19], v[76:79], v[100:115]
  ds_read_b64_tr_b16 v[32:33], v4 offset:22528
  ds_read_b64_tr_b16 v[34:35], v4 offset:23552
  s_waitcnt lgkmcnt(6)
  v_mfma_f32_32x32x16_bf16 v[116:131], v[20:23], v[76:79], v[116:131]
  ds_read_b64_tr_b16 v[36:37], v6 offset:22528
  ds_read_b64_tr_b16 v[38:39], v6 offset:23552
  s_add_u32 m0, s29, 57344
  s_mov_b32 s30, 917504
  buffer_load_dwordx4 v3, s[16:19], s30 offen lds
  s_add_u32 s28, s27, 86016
  buffer_load_dwordx4 v[64:67], v2, s[8:11], s28 offen offset:0
  buffer_load_dwordx4 v[68:71], v2, s[8:11], s28 offen offset:1024
  s_waitcnt vmcnt(15)
  s_waitcnt lgkmcnt(6)
  v_mfma_f32_32x32x16_bf16 v[100:115], v[24:27], v[80:83], v[100:115]
  ds_read_b64_tr_b16 v[8:9], v4 offset:24576
  ds_read_b64_tr_b16 v[10:11], v4 offset:25600
  s_waitcnt lgkmcnt(6)
  v_mfma_f32_32x32x16_bf16 v[116:131], v[28:31], v[80:83], v[116:131]
  ds_read_b64_tr_b16 v[12:13], v6 offset:24576
  ds_read_b64_tr_b16 v[14:15], v6 offset:25600
  s_waitcnt lgkmcnt(6)
  v_mfma_f32_32x32x16_bf16 v[100:115], v[32:35], v[84:87], v[100:115]
  ds_read_b64_tr_b16 v[16:17], v4 offset:26624
  ds_read_b64_tr_b16 v[18:19], v4 offset:27648
  s_waitcnt lgkmcnt(6)
  v_mfma_f32_32x32x16_bf16 v[116:131], v[36:39], v[84:87], v[116:131]
  ds_read_b64_tr_b16 v[20:21], v6 offset:26624
  ds_read_b64_tr_b16 v[22:23], v6 offset:27648
  s_add_u32 m0, s29, 61440
  s_mov_b32 s30, 983040
  buffer_load_dwordx4 v3, s[16:19], s30 offen lds
  s_add_u32 s28, s27, 88064
  buffer_load_dwordx4 v[72:75], v2, s[8:11], s28 offen offset:0
  buffer_load_dwordx4 v[76:79], v2, s[8:11], s28 offen offset:1024
  s_waitcnt vmcnt(15)
  s_waitcnt lgkmcnt(6)
  v_mfma_f32_32x32x16_bf16 v[100:115], v[8:11], v[88:91], v[100:115]
  ds_read_b64_tr_b16 v[24:25], v4 offset:28672
  ds_read_b64_tr_b16 v[26:27], v4 offset:29696
  s_waitcnt lgkmcnt(6)
  v_mfma_f32_32x32x16_bf16 v[116:131], v[12:15], v[88:91], v[116:131]
  ds_read_b64_tr_b16 v[28:29], v6 offset:28672
  ds_read_b64_tr_b16 v[30:31], v6 offset:29696
  s_waitcnt lgkmcnt(6)
  v_mfma_f32_32x32x16_bf16 v[100:115], v[16:19], v[92:95], v[100:115]
  ds_read_b64_tr_b16 v[32:33], v4 offset:30720
  ds_read_b64_tr_b16 v[34:35], v4 offset:31744
  s_waitcnt lgkmcnt(6)
  v_mfma_f32_32x32x16_bf16 v[116:131], v[20:23], v[92:95], v[116:131]
  ds_read_b64_tr_b16 v[36:37], v6 offset:30720
  ds_read_b64_tr_b16 v[38:39], v6 offset:31744
  s_add_u32 m0, s29, 0
  s_mov_b32 s30, 1048576
  buffer_load_dwordx4 v3, s[16:19], s30 offen lds
  s_add_u32 s28, s27, 90112
  buffer_load_dwordx4 v[80:83], v2, s[8:11], s28 offen offset:0
  buffer_load_dwordx4 v[84:87], v2, s[8:11], s28 offen offset:1024
  s_waitcnt vmcnt(17)
  s_barrier
  s_waitcnt vmcnt(15)
  s_waitcnt lgkmcnt(6)
  v_mfma_f32_32x32x16_bf16 v[100:115], v[24:27], v[40:43], v[100:115]
  ds_read_b64_tr_b16 v[8:9], v4 offset:32768
  ds_read_b64_tr_b16 v[10:11], v4 offset:33792
  s_waitcnt lgkmcnt(6)
  v_mfma_f32_32x32x16_bf16 v[116:131], v[28:31], v[40:43], v[116:131]
  ds_read_b64_tr_b16 v[12:13], v6 offset:32768
  ds_read_b64_tr_b16 v[14:15], v6 offset:33792
  s_waitcnt lgkmcnt(6)
  v_mfma_f32_32x32x16_bf16 v[100:115], v[32:35], v[44:47], v[100:115]
  ds_read_b64_tr_b16 v[16:17], v4 offset:34816
  ds_read_b64_tr_b16 v[18:19], v4 offset:35840
  s_waitcnt lgkmcnt(6)
  v_mfma_f32_32x32x16_bf16 v[116:131], v[36:39], v[44:47], v[116:131]
  ds_read_b64_tr_b16 v[20:21], v6 offset:34816
  ds_read_b64_tr_b16 v[22:23], v6 offset:35840
  s_add_u32 m0, s29, 4096
  s_mov_b32 s30, 1114112
  buffer_load_dwordx4 v3, s[16:19], s30 offen lds
  s_add_u32 s28, s27, 92160
  buffer_load_dwordx4 v[88:91], v2, s[8:11], s28 offen offset:0
  buffer_load_dwordx4 v[92:95], v2, s[8:11], s28 offen offset:1024
  s_waitcnt vmcnt(15)
  s_waitcnt lgkmcnt(6)
  v_mfma_f32_32x32x16_bf16 v[100:115], v[8:11], v[48:51], v[100:115]
  ds_read_b64_tr_b16 v[24:25], v4 offset:36864
  ds_read_b64_tr_b16 v[26:27], v4 offset:37888
  s_waitcnt lgkmcnt(6)
  v_mfma_f32_32x32x16_bf16 v[116:131], v[12:15], v[48:51], v[116:131]
  ds_read_b64_tr_b16 v[28:29], v6 offset:36864
  ds_read_b64_tr_b16 v[30:31], v6 offset:37888
  s_waitcnt lgkmcnt(6)
  v_mfma_f32_32x32x16_bf16 v[100:115], v[16:19], v[52:55], v[100:115]
  ds_read_b64_tr_b16 v[32:33], v4 offset:38912
  ds_read_b64_tr_b16 v[34:35], v4 offset:39936
  s_waitcnt lgkmcnt(6)
  v_mfma_f32_32x32x16_bf16 v[116:131], v[20:23], v[52:55], v[116:131]
  ds_read_b64_tr_b16 v[36:37], v6 offset:38912
  ds_read_b64_tr_b16 v[38:39], v6 offset:39936
  s_add_u32 m0, s29, 8192
  s_mov_b32 s30, 1179648
  buffer_load_dwordx4 v3, s[16:19], s30 offen lds
  s_add_u32 s28, s27, 94208
  buffer_load_dwordx4 v[40:43], v2, s[8:11], s28 offen offset:0
  buffer_load_dwordx4 v[44:47], v2, s[8:11], s28 offen offset:1024
  s_waitcnt vmcnt(15)
  s_waitcnt lgkmcnt(6)
  v_mfma_f32_32x32x16_bf16 v[100:115], v[24:27], v[56:59], v[100:115]
  ds_read_b64_tr_b16 v[8:9], v4 offset:40960
  ds_read_b64_tr_b16 v[10:11], v4 offset:41984
  s_waitcnt lgkmcnt(6)
  v_mfma_f32_32x32x16_bf16 v[116:131], v[28:31], v[56:59], v[116:131]
  ds_read_b64_tr_b16 v[12:13], v6 offset:40960
  ds_read_b64_tr_b16 v[14:15], v6 offset:41984
  s_waitcnt lgkmcnt(6)
  v_mfma_f32_32x32x16_bf16 v[100:115], v[32:35], v[60:63], v[100:115]
  ds_read_b64_tr_b16 v[16:17], v4 offset:43008
  ds_read_b64_tr_b16 v[18:19], v4 offset:44032
  s_waitcnt lgkmcnt(6)
  v_mfma_f32_32x32x16_bf16 v[116:131], v[36:39], v[60:63], v[116:131]
  ds_read_b64_tr_b16 v[20:21], v6 offset:43008
  ds_read_b64_tr_b16 v[22:23], v6 offset:44032
  s_add_u32 m0, s29, 12288
  s_mov_b32 s30, 1245184
  buffer_load_dwordx4 v3, s[16:19], s30 offen lds
  s_add_u32 s28, s27, 96256
  buffer_load_dwordx4 v[48:51], v2, s[8:11], s28 offen offset:0
  buffer_load_dwordx4 v[52:55], v2, s[8:11], s28 offen offset:1024
  s_waitcnt vmcnt(15)
  s_waitcnt lgkmcnt(6)
  v_mfma_f32_32x32x16_bf16 v[100:115], v[8:11], v[64:67], v[100:115]
  ds_read_b64_tr_b16 v[24:25], v4 offset:45056
  ds_read_b64_tr_b16 v[26:27], v4 offset:46080
  s_waitcnt lgkmcnt(6)
  v_mfma_f32_32x32x16_bf16 v[116:131], v[12:15], v[64:67], v[116:131]
  ds_read_b64_tr_b16 v[28:29], v6 offset:45056
  ds_read_b64_tr_b16 v[30:31], v6 offset:46080
  s_waitcnt lgkmcnt(6)
  v_mfma_f32_32x32x16_bf16 v[100:115], v[16:19], v[68:71], v[100:115]
  ds_read_b64_tr_b16 v[32:33], v4 offset:47104
  ds_read_b64_tr_b16 v[34:35], v4 offset:48128
  s_waitcnt lgkmcnt(6)
  v_mfma_f32_32x32x16_bf16 v[116:131], v[20:23], v[68:71], v[116:131]
  ds_read_b64_tr_b16 v[36:37], v6 offset:47104
  ds_read_b64_tr_b16 v[38:39], v6 offset:48128
  s_add_u32 m0, s29, 16384
  s_mov_b32 s30, 1310720
  buffer_load_dwordx4 v3, s[16:19], s30 offen lds
  s_add_u32 s28, s27, 98304
  buffer_load_dwordx4 v[56:59], v2, s[8:11], s28 offen offset:0
  buffer_load_dwordx4 v[60:63], v2, s[8:11], s28 offen offset:1024
  s_waitcnt vmcnt(17)
  s_barrier
  s_waitcnt vmcnt(15)
  s_waitcnt lgkmcnt(6)
  v_mfma_f32_32x32x16_bf16 v[100:115], v[24:27], v[72:75], v[100:115]
  ds_read_b64_tr_b16 v[8:9], v4 offset:49152
  ds_read_b64_tr_b16 v[10:11], v4 offset:50176
  s_waitcnt lgkmcnt(6)
  v_mfma_f32_32x32x16_bf16 v[116:131], v[28:31], v[72:75], v[116:131]
  ds_read_b64_tr_b16 v[12:13], v6 offset:49152
  ds_read_b64_tr_b16 v[14:15], v6 offset:50176
  s_waitcnt lgkmcnt(6)
  v_mfma_f32_32x32x16_bf16 v[100:115], v[32:35], v[76:79], v[100:115]
  ds_read_b64_tr_b16 v[16:17], v4 offset:51200
  ds_read_b64_tr_b16 v[18:19], v4 offset:52224
  s_waitcnt lgkmcnt(6)
  v_mfma_f32_32x32x16_bf16 v[116:131], v[36:39], v[76:79], v[116:131]
  ds_read_b64_tr_b16 v[20:21], v6 offset:51200
  ds_read_b64_tr_b16 v[22:23], v6 offset:52224
  s_add_u32 m0, s29, 20480
  s_mov_b32 s30, 1376256
  buffer_load_dwordx4 v3, s[16:19], s30 offen lds
  s_add_u32 s28, s27, 100352
  buffer_load_dwordx4 v[64:67], v2, s[8:11], s28 offen offset:0
  buffer_load_dwordx4 v[68:71], v2, s[8:11], s28 offen offset:1024
  s_waitcnt vmcnt(15)
  s_waitcnt lgkmcnt(6)
  v_mfma_f32_32x32x16_bf16 v[100:115], v[8:11], v[80:83], v[100:115]
  ds_read_b64_tr_b16 v[24:25], v4 offset:53248
  ds_read_b64_tr_b16 v[26:27], v4 offset:54272
  s_waitcnt lgkmcnt(6)
  v_mfma_f32_32x32x16_bf16 v[116:131], v[12:15], v[80:83], v[116:131]
  ds_read_b64_tr_b16 v[28:29], v6 offset:53248
  ds_read_b64_tr_b16 v[30:31], v6 offset:54272
  s_waitcnt lgkmcnt(6)
  v_mfma_f32_32x32x16_bf16 v[100:115], v[16:19], v[84:87], v[100:115]
  ds_read_b64_tr_b16 v[32:33], v4 offset:55296
  ds_read_b64_tr_b16 v[34:35], v4 offset:56320
  s_waitcnt lgkmcnt(6)
  v_mfma_f32_32x32x16_bf16 v[116:131], v[20:23], v[84:87], v[116:131]
  ds_read_b64_tr_b16 v[36:37], v6 offset:55296
  ds_read_b64_tr_b16 v[38:39], v6 offset:56320
  s_add_u32 m0, s29, 24576
  s_mov_b32 s30, 1441792
  buffer_load_dwordx4 v3, s[16:19], s30 offen lds
  s_add_u32 s28, s27, 102400
  buffer_load_dwordx4 v[72:75], v2, s[8:11], s28 offen offset:0
  buffer_load_dwordx4 v[76:79], v2, s[8:11], s28 offen offset:1024
  s_waitcnt vmcnt(15)
  s_waitcnt lgkmcnt(6)
  v_mfma_f32_32x32x16_bf16 v[100:115], v[24:27], v[88:91], v[100:115]
  ds_read_b64_tr_b16 v[8:9], v4 offset:57344
  ds_read_b64_tr_b16 v[10:11], v4 offset:58368
  s_waitcnt lgkmcnt(6)
  v_mfma_f32_32x32x16_bf16 v[116:131], v[28:31], v[88:91], v[116:131]
  ds_read_b64_tr_b16 v[12:13], v6 offset:57344
  ds_read_b64_tr_b16 v[14:15], v6 offset:58368
  s_waitcnt lgkmcnt(6)
  v_mfma_f32_32x32x16_bf16 v[100:115], v[32:35], v[92:95], v[100:115]
  ds_read_b64_tr_b16 v[16:17], v4 offset:59392
  ds_read_b64_tr_b16 v[18:19], v4 offset:60416
  s_waitcnt lgkmcnt(6)
  v_mfma_f32_32x32x16_bf16 v[116:131], v[36:39], v[92:95], v[116:131]
  ds_read_b64_tr_b16 v[20:21], v6 offset:59392
  ds_read_b64_tr_b16 v[22:23], v6 offset:60416
  s_add_u32 m0, s29, 28672
  s_mov_b32 s30, 1507328
  buffer_load_dwordx4 v3, s[16:19], s30 offen lds
  s_add_u32 s28, s27, 104448
  buffer_load_dwordx4 v[80:83], v2, s[8:11], s28 offen offset:0
  buffer_load_dwordx4 v[84:87], v2, s[8:11], s28 offen offset:1024
  s_waitcnt vmcnt(15)
  s_waitcnt lgkmcnt(6)
  v_mfma_f32_32x32x16_bf16 v[100:115], v[8:11], v[40:43], v[100:115]
  ds_read_b64_tr_b16 v[24:25], v4 offset:61440
  ds_read_b64_tr_b16 v[26:27], v4 offset:62464
  s_waitcnt lgkmcnt(6)
  v_mfma_f32_32x32x16_bf16 v[116:131], v[12:15], v[40:43], v[116:131]
  ds_read_b64_tr_b16 v[28:29], v6 offset:61440
  ds_read_b64_tr_b16 v[30:31], v6 offset:62464
  s_waitcnt lgkmcnt(6)
  v_mfma_f32_32x32x16_bf16 v[100:115], v[16:19], v[44:47], v[100:115]
  ds_read_b64_tr_b16 v[32:33], v4 offset:63488
  ds_read_b64_tr_b16 v[34:35], v4 offset:64512
  s_waitcnt lgkmcnt(6)
  v_mfma_f32_32x32x16_bf16 v[116:131], v[20:23], v[44:47], v[116:131]
  ds_read_b64_tr_b16 v[36:37], v6 offset:63488
  ds_read_b64_tr_b16 v[38:39], v6 offset:64512
  s_add_u32 m0, s29, 32768
  s_mov_b32 s30, 1572864
  buffer_load_dwordx4 v3, s[16:19], s30 offen lds
  s_add_u32 s28, s27, 106496
  buffer_load_dwordx4 v[88:91], v2, s[8:11], s28 offen offset:0
  buffer_load_dwordx4 v[92:95], v2, s[8:11], s28 offen offset:1024
  s_waitcnt vmcnt(17)
  s_barrier
  s_waitcnt vmcnt(15)
  s_waitcnt lgkmcnt(6)
  v_mfma_f32_32x32x16_bf16 v[100:115], v[24:27], v[48:51], v[100:115]
  ds_read_b64_tr_b16 v[8:9], v4 offset:0
  ds_read_b64_tr_b16 v[10:11], v4 offset:1024
  s_waitcnt lgkmcnt(6)
  v_mfma_f32_32x32x16_bf16 v[116:131], v[28:31], v[48:51], v[116:131]
  ds_read_b64_tr_b16 v[12:13], v6 offset:0
  ds_read_b64_tr_b16 v[14:15], v6 offset:1024
  s_waitcnt lgkmcnt(6)
  v_mfma_f32_32x32x16_bf16 v[100:115], v[32:35], v[52:55], v[100:115]
  ds_read_b64_tr_b16 v[16:17], v4 offset:2048
  ds_read_b64_tr_b16 v[18:19], v4 offset:3072
  s_waitcnt lgkmcnt(6)
  v_mfma_f32_32x32x16_bf16 v[116:131], v[36:39], v[52:55], v[116:131]
  ds_read_b64_tr_b16 v[20:21], v6 offset:2048
  ds_read_b64_tr_b16 v[22:23], v6 offset:3072
  s_add_u32 m0, s29, 36864
  s_mov_b32 s30, 1638400
  buffer_load_dwordx4 v3, s[16:19], s30 offen lds
  s_add_u32 s28, s27, 108544
  buffer_load_dwordx4 v[40:43], v2, s[8:11], s28 offen offset:0
  buffer_load_dwordx4 v[44:47], v2, s[8:11], s28 offen offset:1024
  s_waitcnt vmcnt(15)
  s_waitcnt lgkmcnt(6)
  v_mfma_f32_32x32x16_bf16 v[100:115], v[8:11], v[56:59], v[100:115]
  ds_read_b64_tr_b16 v[24:25], v4 offset:4096
  ds_read_b64_tr_b16 v[26:27], v4 offset:5120
  s_waitcnt lgkmcnt(6)
  v_mfma_f32_32x32x16_bf16 v[116:131], v[12:15], v[56:59], v[116:131]
  ds_read_b64_tr_b16 v[28:29], v6 offset:4096
  ds_read_b64_tr_b16 v[30:31], v6 offset:5120
  s_waitcnt lgkmcnt(6)
  v_mfma_f32_32x32x16_bf16 v[100:115], v[16:19], v[60:63], v[100:115]
  ds_read_b64_tr_b16 v[32:33], v4 offset:6144
  ds_read_b64_tr_b16 v[34:35], v4 offset:7168
  s_waitcnt lgkmcnt(6)
  v_mfma_f32_32x32x16_bf16 v[116:131], v[20:23], v[60:63], v[116:131]
  ds_read_b64_tr_b16 v[36:37], v6 offset:6144
  ds_read_b64_tr_b16 v[38:39], v6 offset:7168
  s_add_u32 m0, s29, 40960
  s_mov_b32 s30, 1703936
  buffer_load_dwordx4 v3, s[16:19], s30 offen lds
  s_add_u32 s28, s27, 110592
  buffer_load_dwordx4 v[48:51], v2, s[8:11], s28 offen offset:0
  buffer_load_dwordx4 v[52:55], v2, s[8:11], s28 offen offset:1024
  s_waitcnt vmcnt(15)
  s_waitcnt lgkmcnt(6)
  v_mfma_f32_32x32x16_bf16 v[100:115], v[24:27], v[64:67], v[100:115]
  ds_read_b64_tr_b16 v[8:9], v4 offset:8192
  ds_read_b64_tr_b16 v[10:11], v4 offset:9216
  s_waitcnt lgkmcnt(6)
  v_mfma_f32_32x32x16_bf16 v[116:131], v[28:31], v[64:67], v[116:131]
  ds_read_b64_tr_b16 v[12:13], v6 offset:8192
  ds_read_b64_tr_b16 v[14:15], v6 offset:9216
  s_waitcnt lgkmcnt(6)
  v_mfma_f32_32x32x16_bf16 v[100:115], v[32:35], v[68:71], v[100:115]
  ds_read_b64_tr_b16 v[16:17], v4 offset:10240
  ds_read_b64_tr_b16 v[18:19], v4 offset:11264
  s_waitcnt lgkmcnt(6)
  v_mfma_f32_32x32x16_bf16 v[116:131], v[36:39], v[68:71], v[116:131]
  ds_read_b64_tr_b16 v[20:21], v6 offset:10240
  ds_read_b64_tr_b16 v[22:23], v6 offset:11264
  s_add_u32 m0, s29, 45056
  s_mov_b32 s30, 1769472
  buffer_load_dwordx4 v3, s[16:19], s30 offen lds
  s_add_u32 s28, s27, 112640
  buffer_load_dwordx4 v[56:59], v2, s[8:11], s28 offen offset:0
  buffer_load_dwordx4 v[60:63], v2, s[8:11], s28 offen offset:1024
  s_waitcnt vmcnt(15)
  s_waitcnt lgkmcnt(6)
  v_mfma_f32_32x32x16_bf16 v[100:115], v[8:11], v[72:75], v[100:115]
  ds_read_b64_tr_b16 v[24:25], v4 offset:12288
  ds_read_b64_tr_b16 v[26:27], v4 offset:13312
  s_waitcnt lgkmcnt(6)
  v_mfma_f32_32x32x16_bf16 v[116:131], v[12:15], v[72:75], v[116:131]
  ds_read_b64_tr_b16 v[28:29], v6 offset:12288
  ds_read_b64_tr_b16 v[30:31], v6 offset:13312
  s_waitcnt lgkmcnt(6)
  v_mfma_f32_32x32x16_bf16 v[100:115], v[16:19], v[76:79], v[100:115]
  ds_read_b64_tr_b16 v[32:33], v4 offset:14336
  ds_read_b64_tr_b16 v[34:35], v4 offset:15360
  s_waitcnt lgkmcnt(6)
  v_mfma_f32_32x32x16_bf16 v[116:131], v[20:23], v[76:79], v[116:131]
  ds_read_b64_tr_b16 v[36:37], v6 offset:14336
  ds_read_b64_tr_b16 v[38:39], v6 offset:15360
  s_add_u32 m0, s29, 49152
  s_mov_b32 s30, 1835008
  buffer_load_dwordx4 v3, s[16:19], s30 offen lds
  s_add_u32 s28, s27, 114688
  buffer_load_dwordx4 v[64:67], v2, s[8:11], s28 offen offset:0
  buffer_load_dwordx4 v[68:71], v2, s[8:11], s28 offen offset:1024
  s_waitcnt vmcnt(17)
  s_barrier
  s_waitcnt vmcnt(15)
  s_waitcnt lgkmcnt(6)
  v_mfma_f32_32x32x16_bf16 v[100:115], v[24:27], v[80:83], v[100:115]
  ds_read_b64_tr_b16 v[8:9], v4 offset:16384
  ds_read_b64_tr_b16 v[10:11], v4 offset:17408
  s_waitcnt lgkmcnt(6)
  v_mfma_f32_32x32x16_bf16 v[116:131], v[28:31], v[80:83], v[116:131]
  ds_read_b64_tr_b16 v[12:13], v6 offset:16384
  ds_read_b64_tr_b16 v[14:15], v6 offset:17408
  s_waitcnt lgkmcnt(6)
  v_mfma_f32_32x32x16_bf16 v[100:115], v[32:35], v[84:87], v[100:115]
  ds_read_b64_tr_b16 v[16:17], v4 offset:18432
  ds_read_b64_tr_b16 v[18:19], v4 offset:19456
  s_waitcnt lgkmcnt(6)
  v_mfma_f32_32x32x16_bf16 v[116:131], v[36:39], v[84:87], v[116:131]
  ds_read_b64_tr_b16 v[20:21], v6 offset:18432
  ds_read_b64_tr_b16 v[22:23], v6 offset:19456
  s_add_u32 m0, s29, 53248
  s_mov_b32 s30, 1900544
  buffer_load_dwordx4 v3, s[16:19], s30 offen lds
  s_add_u32 s28, s27, 116736
  buffer_load_dwordx4 v[72:75], v2, s[8:11], s28 offen offset:0
  buffer_load_dwordx4 v[76:79], v2, s[8:11], s28 offen offset:1024
  s_waitcnt vmcnt(15)
  s_waitcnt lgkmcnt(6)
  v_mfma_f32_32x32x16_bf16 v[100:115], v[8:11], v[88:91], v[100:115]
  ds_read_b64_tr_b16 v[24:25], v4 offset:20480
  ds_read_b64_tr_b16 v[26:27], v4 offset:21504
  s_waitcnt lgkmcnt(6)
  v_mfma_f32_32x32x16_bf16 v[116:131], v[12:15], v[88:91], v[116:131]
  ds_read_b64_tr_b16 v[28:29], v6 offset:20480
  ds_read_b64_tr_b16 v[30:31], v6 offset:21504
  s_waitcnt lgkmcnt(6)
  v_mfma_f32_32x32x16_bf16 v[100:115], v[16:19], v[92:95], v[100:115]
  ds_read_b64_tr_b16 v[32:33], v4 offset:22528
  ds_read_b64_tr_b16 v[34:35], v4 offset:23552
  s_waitcnt lgkmcnt(6)
  v_mfma_f32_32x32x16_bf16 v[116:131], v[20:23], v[92:95], v[116:131]
  ds_read_b64_tr_b16 v[36:37], v6 offset:22528
  ds_read_b64_tr_b16 v[38:39], v6 offset:23552
  s_add_u32 m0, s29, 57344
  s_mov_b32 s30, 1966080
  buffer_load_dwordx4 v3, s[16:19], s30 offen lds
  s_add_u32 s28, s27, 118784
  buffer_load_dwordx4 v[80:83], v2, s[8:11], s28 offen offset:0
  buffer_load_dwordx4 v[84:87], v2, s[8:11], s28 offen offset:1024
  s_waitcnt vmcnt(15)
  s_waitcnt lgkmcnt(6)
  v_mfma_f32_32x32x16_bf16 v[100:115], v[24:27], v[40:43], v[100:115]
  ds_read_b64_tr_b16 v[8:9], v4 offset:24576
  ds_read_b64_tr_b16 v[10:11], v4 offset:25600
  s_waitcnt lgkmcnt(6)
  v_mfma_f32_32x32x16_bf16 v[116:131], v[28:31], v[40:43], v[116:131]
  ds_read_b64_tr_b16 v[12:13], v6 offset:24576
  ds_read_b64_tr_b16 v[14:15], v6 offset:25600
  s_waitcnt lgkmcnt(6)
  v_mfma_f32_32x32x16_bf16 v[100:115], v[32:35], v[44:47], v[100:115]
  ds_read_b64_tr_b16 v[16:17], v4 offset:26624
  ds_read_b64_tr_b16 v[18:19], v4 offset:27648
  s_waitcnt lgkmcnt(6)
  v_mfma_f32_32x32x16_bf16 v[116:131], v[36:39], v[44:47], v[116:131]
  ds_read_b64_tr_b16 v[20:21], v6 offset:26624
  ds_read_b64_tr_b16 v[22:23], v6 offset:27648
  s_add_u32 m0, s29, 61440
  s_mov_b32 s30, 2031616
  buffer_load_dwordx4 v3, s[16:19], s30 offen lds
  s_add_u32 s28, s27, 120832
  buffer_load_dwordx4 v[88:91], v2, s[8:11], s28 offen offset:0
  buffer_load_dwordx4 v[92:95], v2, s[8:11], s28 offen offset:1024
  s_waitcnt vmcnt(15)
  s_waitcnt lgkmcnt(6)
  v_mfma_f32_32x32x16_bf16 v[100:115], v[8:11], v[48:51], v[100:115]
  ds_read_b64_tr_b16 v[24:25], v4 offset:28672
  ds_read_b64_tr_b16 v[26:27], v4 offset:29696
  s_waitcnt lgkmcnt(6)
  v_mfma_f32_32x32x16_bf16 v[116:131], v[12:15], v[48:51], v[116:131]
  ds_read_b64_tr_b16 v[28:29], v6 offset:28672
  ds_read_b64_tr_b16 v[30:31], v6 offset:29696
  s_waitcnt lgkmcnt(6)
  v_mfma_f32_32x32x16_bf16 v[100:115], v[16:19], v[52:55], v[100:115]
  ds_read_b64_tr_b16 v[32:33], v4 offset:30720
  ds_read_b64_tr_b16 v[34:35], v4 offset:31744
  s_waitcnt lgkmcnt(6)
  v_mfma_f32_32x32x16_bf16 v[116:131], v[20:23], v[52:55], v[116:131]
  ds_read_b64_tr_b16 v[36:37], v6 offset:30720
  ds_read_b64_tr_b16 v[38:39], v6 offset:31744
  s_add_u32 m0, s29, 0
  s_mov_b32 s30, 0
  buffer_load_dwordx4 v3, s[12:15], s30 offen lds
  s_add_u32 s28, s27, 122880
  buffer_load_dwordx4 v[40:43], v2, s[8:11], s28 offen offset:0
  buffer_load_dwordx4 v[44:47], v2, s[8:11], s28 offen offset:1024
  s_waitcnt vmcnt(17)
  s_barrier
  s_waitcnt vmcnt(15)
  s_waitcnt lgkmcnt(6)
  v_mfma_f32_32x32x16_bf16 v[100:115], v[24:27], v[56:59], v[100:115]
  ds_read_b64_tr_b16 v[8:9], v4 offset:32768
  ds_read_b64_tr_b16 v[10:11], v4 offset:33792
  s_waitcnt lgkmcnt(6)
  v_mfma_f32_32x32x16_bf16 v[116:131], v[28:31], v[56:59], v[116:131]
  ds_read_b64_tr_b16 v[12:13], v6 offset:32768
  ds_read_b64_tr_b16 v[14:15], v6 offset:33792
  s_waitcnt lgkmcnt(6)
  v_mfma_f32_32x32x16_bf16 v[100:115], v[32:35], v[60:63], v[100:115]
  ds_read_b64_tr_b16 v[16:17], v4 offset:34816
  ds_read_b64_tr_b16 v[18:19], v4 offset:35840
  s_waitcnt lgkmcnt(6)
  v_mfma_f32_32x32x16_bf16 v[116:131], v[36:39], v[60:63], v[116:131]
  ds_read_b64_tr_b16 v[20:21], v6 offset:34816
  ds_read_b64_tr_b16 v[22:23], v6 offset:35840
  s_add_u32 m0, s29, 4096
  s_mov_b32 s30, 65536
  buffer_load_dwordx4 v3, s[12:15], s30 offen lds
  s_add_u32 s28, s27, 124928
  buffer_load_dwordx4 v[48:51], v2, s[8:11], s28 offen offset:0
  buffer_load_dwordx4 v[52:55], v2, s[8:11], s28 offen offset:1024
  s_waitcnt vmcnt(15)
  s_waitcnt lgkmcnt(6)
  v_mfma_f32_32x32x16_bf16 v[100:115], v[8:11], v[64:67], v[100:115]
  ds_read_b64_tr_b16 v[24:25], v4 offset:36864
  ds_read_b64_tr_b16 v[26:27], v4 offset:37888
  s_waitcnt lgkmcnt(6)
  v_mfma_f32_32x32x16_bf16 v[116:131], v[12:15], v[64:67], v[116:131]
  ds_read_b64_tr_b16 v[28:29], v6 offset:36864
  ds_read_b64_tr_b16 v[30:31], v6 offset:37888
  s_waitcnt lgkmcnt(6)
  v_mfma_f32_32x32x16_bf16 v[100:115], v[16:19], v[68:71], v[100:115]
  ds_read_b64_tr_b16 v[32:33], v4 offset:38912
  ds_read_b64_tr_b16 v[34:35], v4 offset:39936
  s_waitcnt lgkmcnt(6)
  v_mfma_f32_32x32x16_bf16 v[116:131], v[20:23], v[68:71], v[116:131]
  ds_read_b64_tr_b16 v[36:37], v6 offset:38912
  ds_read_b64_tr_b16 v[38:39], v6 offset:39936
  s_add_u32 m0, s29, 8192
  s_mov_b32 s30, 131072
  buffer_load_dwordx4 v3, s[12:15], s30 offen lds
  s_add_u32 s28, s27, 126976
  buffer_load_dwordx4 v[56:59], v2, s[8:11], s28 offen offset:0
  buffer_load_dwordx4 v[60:63], v2, s[8:11], s28 offen offset:1024
  s_waitcnt vmcnt(15)
  s_waitcnt lgkmcnt(6)
  v_mfma_f32_32x32x16_bf16 v[100:115], v[24:27], v[72:75], v[100:115]
  ds_read_b64_tr_b16 v[8:9], v4 offset:40960
  ds_read_b64_tr_b16 v[10:11], v4 offset:41984
  s_waitcnt lgkmcnt(6)
  v_mfma_f32_32x32x16_bf16 v[116:131], v[28:31], v[72:75], v[116:131]
  ds_read_b64_tr_b16 v[12:13], v6 offset:40960
  ds_read_b64_tr_b16 v[14:15], v6 offset:41984
  s_waitcnt lgkmcnt(6)
  v_mfma_f32_32x32x16_bf16 v[100:115], v[32:35], v[76:79], v[100:115]
  ds_read_b64_tr_b16 v[16:17], v4 offset:43008
  ds_read_b64_tr_b16 v[18:19], v4 offset:44032
  s_waitcnt lgkmcnt(6)
  v_mfma_f32_32x32x16_bf16 v[116:131], v[36:39], v[76:79], v[116:131]
  ds_read_b64_tr_b16 v[20:21], v6 offset:43008
  ds_read_b64_tr_b16 v[22:23], v6 offset:44032
  s_add_u32 m0, s29, 12288
  s_mov_b32 s30, 196608
  buffer_load_dwordx4 v3, s[12:15], s30 offen lds
  s_add_u32 s28, s27, 129024
  buffer_load_dwordx4 v[64:67], v2, s[8:11], s28 offen offset:0
  buffer_load_dwordx4 v[68:71], v2, s[8:11], s28 offen offset:1024
  s_waitcnt vmcnt(15)
  s_waitcnt lgkmcnt(6)
  v_mfma_f32_32x32x16_bf16 v[100:115], v[8:11], v[80:83], v[100:115]
  ds_read_b64_tr_b16 v[24:25], v4 offset:45056
  ds_read_b64_tr_b16 v[26:27], v4 offset:46080
  s_waitcnt lgkmcnt(6)
  v_mfma_f32_32x32x16_bf16 v[116:131], v[12:15], v[80:83], v[116:131]
  ds_read_b64_tr_b16 v[28:29], v6 offset:45056
  ds_read_b64_tr_b16 v[30:31], v6 offset:46080
  s_waitcnt lgkmcnt(6)
  v_mfma_f32_32x32x16_bf16 v[100:115], v[16:19], v[84:87], v[100:115]
  ds_read_b64_tr_b16 v[32:33], v4 offset:47104
  ds_read_b64_tr_b16 v[34:35], v4 offset:48128
  s_waitcnt lgkmcnt(6)
  v_mfma_f32_32x32x16_bf16 v[116:131], v[20:23], v[84:87], v[116:131]
  ds_read_b64_tr_b16 v[36:37], v6 offset:47104
  ds_read_b64_tr_b16 v[38:39], v6 offset:48128
  s_add_u32 m0, s29, 16384
  s_mov_b32 s30, 262144
  buffer_load_dwordx4 v3, s[12:15], s30 offen lds
  s_add_u32 s28, s27, 0
  buffer_load_dwordx4 v[72:75], v2, s[8:11], s28 offen offset:0
  buffer_load_dwordx4 v[76:79], v2, s[8:11], s28 offen offset:1024
  s_waitcnt vmcnt(17)
  s_barrier
  s_waitcnt vmcnt(15)
  s_waitcnt lgkmcnt(6)
  v_mfma_f32_32x32x16_bf16 v[100:115], v[24:27], v[88:91], v[100:115]
  ds_read_b64_tr_b16 v[8:9], v4 offset:49152
  ds_read_b64_tr_b16 v[10:11], v4 offset:50176
  s_waitcnt lgkmcnt(6)
  v_mfma_f32_32x32x16_bf16 v[116:131], v[28:31], v[88:91], v[116:131]
  ds_read_b64_tr_b16 v[12:13], v6 offset:49152
  ds_read_b64_tr_b16 v[14:15], v6 offset:50176
  s_waitcnt lgkmcnt(6)
  v_mfma_f32_32x32x16_bf16 v[100:115], v[32:35], v[92:95], v[100:115]
  ds_read_b64_tr_b16 v[16:17], v4 offset:51200
  ds_read_b64_tr_b16 v[18:19], v4 offset:52224
  s_waitcnt lgkmcnt(6)
  v_mfma_f32_32x32x16_bf16 v[116:131], v[36:39], v[92:95], v[116:131]
  ds_read_b64_tr_b16 v[20:21], v6 offset:51200
  ds_read_b64_tr_b16 v[22:23], v6 offset:52224
  s_add_u32 m0, s29, 20480
  s_mov_b32 s30, 327680
  buffer_load_dwordx4 v3, s[12:15], s30 offen lds
  s_add_u32 s28, s27, 2048
  buffer_load_dwordx4 v[80:83], v2, s[8:11], s28 offen offset:0
  buffer_load_dwordx4 v[84:87], v2, s[8:11], s28 offen offset:1024
  s_waitcnt vmcnt(15)
  s_waitcnt lgkmcnt(6)
  v_mfma_f32_32x32x16_bf16 v[100:115], v[8:11], v[40:43], v[100:115]
  ds_read_b64_tr_b16 v[24:25], v4 offset:53248
  ds_read_b64_tr_b16 v[26:27], v4 offset:54272
  s_waitcnt lgkmcnt(6)
  v_mfma_f32_32x32x16_bf16 v[116:131], v[12:15], v[40:43], v[116:131]
  ds_read_b64_tr_b16 v[28:29], v6 offset:53248
  ds_read_b64_tr_b16 v[30:31], v6 offset:54272
  s_waitcnt lgkmcnt(6)
  v_mfma_f32_32x32x16_bf16 v[100:115], v[16:19], v[44:47], v[100:115]
  ds_read_b64_tr_b16 v[32:33], v4 offset:55296
  ds_read_b64_tr_b16 v[34:35], v4 offset:56320
  s_waitcnt lgkmcnt(6)
  v_mfma_f32_32x32x16_bf16 v[116:131], v[20:23], v[44:47], v[116:131]
  ds_read_b64_tr_b16 v[36:37], v6 offset:55296
  ds_read_b64_tr_b16 v[38:39], v6 offset:56320
  s_add_u32 m0, s29, 24576
  s_mov_b32 s30, 393216
  buffer_load_dwordx4 v3, s[12:15], s30 offen lds
  s_add_u32 s28, s27, 4096
  buffer_load_dwordx4 v[88:91], v2, s[8:11], s28 offen offset:0
  buffer_load_dwordx4 v[92:95], v2, s[8:11], s28 offen offset:1024
  s_waitcnt vmcnt(15)
  s_waitcnt lgkmcnt(6)
  v_mfma_f32_32x32x16_bf16 v[100:115], v[24:27], v[48:51], v[100:115]
  ds_read_b64_tr_b16 v[8:9], v4 offset:57344
  ds_read_b64_tr_b16 v[10:11], v4 offset:58368
  s_waitcnt lgkmcnt(6)
  v_mfma_f32_32x32x16_bf16 v[116:131], v[28:31], v[48:51], v[116:131]
  ds_read_b64_tr_b16 v[12:13], v6 offset:57344
  ds_read_b64_tr_b16 v[14:15], v6 offset:58368
  s_waitcnt lgkmcnt(6)
  v_mfma_f32_32x32x16_bf16 v[100:115], v[32:35], v[52:55], v[100:115]
  ds_read_b64_tr_b16 v[16:17], v4 offset:59392
  ds_read_b64_tr_b16 v[18:19], v4 offset:60416
  s_waitcnt lgkmcnt(6)
  v_mfma_f32_32x32x16_bf16 v[116:131], v[36:39], v[52:55], v[116:131]
  ds_read_b64_tr_b16 v[20:21], v6 offset:59392
  ds_read_b64_tr_b16 v[22:23], v6 offset:60416
  s_add_u32 m0, s29, 28672
  s_mov_b32 s30, 458752
  buffer_load_dwordx4 v3, s[12:15], s30 offen lds
  s_add_u32 s28, s27, 6144
  buffer_load_dwordx4 v[40:43], v2, s[8:11], s28 offen offset:0
  buffer_load_dwordx4 v[44:47], v2, s[8:11], s28 offen offset:1024
  s_waitcnt vmcnt(15)
  s_waitcnt lgkmcnt(6)
  v_mfma_f32_32x32x16_bf16 v[100:115], v[8:11], v[56:59], v[100:115]
  ds_read_b64_tr_b16 v[24:25], v4 offset:61440
  ds_read_b64_tr_b16 v[26:27], v4 offset:62464
  s_waitcnt lgkmcnt(6)
  v_mfma_f32_32x32x16_bf16 v[116:131], v[12:15], v[56:59], v[116:131]
  ds_read_b64_tr_b16 v[28:29], v6 offset:61440
  ds_read_b64_tr_b16 v[30:31], v6 offset:62464
  s_waitcnt lgkmcnt(6)
  v_mfma_f32_32x32x16_bf16 v[100:115], v[16:19], v[60:63], v[100:115]
  ds_read_b64_tr_b16 v[32:33], v4 offset:63488
  ds_read_b64_tr_b16 v[34:35], v4 offset:64512
  s_waitcnt lgkmcnt(6)
  v_mfma_f32_32x32x16_bf16 v[116:131], v[20:23], v[60:63], v[116:131]
  ds_read_b64_tr_b16 v[36:37], v6 offset:63488
  ds_read_b64_tr_b16 v[38:39], v6 offset:64512
  s_add_u32 m0, s29, 32768
  s_mov_b32 s30, 524288
  buffer_load_dwordx4 v3, s[12:15], s30 offen lds
  s_add_u32 s28, s27, 8192
  buffer_load_dwordx4 v[48:51], v2, s[8:11], s28 offen offset:0
  buffer_load_dwordx4 v[52:55], v2, s[8:11], s28 offen offset:1024
  s_waitcnt vmcnt(17)
  s_barrier
  s_waitcnt vmcnt(15)
  s_waitcnt lgkmcnt(6)
  v_mfma_f32_32x32x16_bf16 v[100:115], v[24:27], v[64:67], v[100:115]
  ds_read_b64_tr_b16 v[8:9], v4 offset:0
  ds_read_b64_tr_b16 v[10:11], v4 offset:1024
  s_waitcnt lgkmcnt(6)
  v_mfma_f32_32x32x16_bf16 v[116:131], v[28:31], v[64:67], v[116:131]
  ds_read_b64_tr_b16 v[12:13], v6 offset:0
  ds_read_b64_tr_b16 v[14:15], v6 offset:1024
  s_waitcnt lgkmcnt(6)
  v_mfma_f32_32x32x16_bf16 v[100:115], v[32:35], v[68:71], v[100:115]
  ds_read_b64_tr_b16 v[16:17], v4 offset:2048
  ds_read_b64_tr_b16 v[18:19], v4 offset:3072
  s_waitcnt lgkmcnt(6)
  v_mfma_f32_32x32x16_bf16 v[116:131], v[36:39], v[68:71], v[116:131]
  ds_read_b64_tr_b16 v[20:21], v6 offset:2048
  ds_read_b64_tr_b16 v[22:23], v6 offset:3072
  s_add_u32 m0, s29, 36864
  s_mov_b32 s30, 589824
  buffer_load_dwordx4 v3, s[12:15], s30 offen lds
  s_add_u32 s28, s27, 10240
  buffer_load_dwordx4 v[56:59], v2, s[8:11], s28 offen offset:0
  buffer_load_dwordx4 v[60:63], v2, s[8:11], s28 offen offset:1024
  s_waitcnt vmcnt(15)
  s_nop 7
  s_nop 3
  v_pk_mul_f32 v[100:101], v[100:101], v[96:97] op_sel_hi:[1,0]
  v_pk_mul_f32 v[102:103], v[102:103], v[96:97] op_sel_hi:[1,0]
  v_pk_mul_f32 v[104:105], v[104:105], v[96:97] op_sel_hi:[1,0]
  v_pk_mul_f32 v[106:107], v[106:107], v[96:97] op_sel_hi:[1,0]
  v_pk_mul_f32 v[108:109], v[108:109], v[96:97] op_sel_hi:[1,0]
  v_pk_mul_f32 v[110:111], v[110:111], v[96:97] op_sel_hi:[1,0]
  v_pk_mul_f32 v[112:113], v[112:113], v[96:97] op_sel_hi:[1,0]
  v_pk_mul_f32 v[114:115], v[114:115], v[96:97] op_sel_hi:[1,0]
  v_pk_mul_f32 v[116:117], v[116:117], v[96:97] op_sel_hi:[1,0]
  v_pk_mul_f32 v[118:119], v[118:119], v[96:97] op_sel_hi:[1,0]
  v_pk_mul_f32 v[120:121], v[120:121], v[96:97] op_sel_hi:[1,0]
  v_pk_mul_f32 v[122:123], v[122:123], v[96:97] op_sel_hi:[1,0]
  v_pk_mul_f32 v[124:125], v[124:125], v[96:97] op_sel_hi:[1,0]
  v_pk_mul_f32 v[126:127], v[126:127], v[96:97] op_sel_hi:[1,0]
  v_pk_mul_f32 v[128:129], v[128:129], v[96:97] op_sel_hi:[1,0]
  v_pk_mul_f32 v[130:131], v[130:131], v[96:97] op_sel_hi:[1,0]
  s_nop 1
  s_waitcnt lgkmcnt(6)
  v_mfma_f32_32x32x16_bf16 v[100:115], v[8:11], v[72:75], v[100:115]
  ds_read_b64_tr_b16 v[24:25], v4 offset:4096
  ds_read_b64_tr_b16 v[26:27], v4 offset:5120
  s_waitcnt lgkmcnt(6)
  v_mfma_f32_32x32x16_bf16 v[116:131], v[12:15], v[72:75], v[116:131]
  ds_read_b64_tr_b16 v[28:29], v6 offset:4096
  ds_read_b64_tr_b16 v[30:31], v6 offset:5120
  s_waitcnt lgkmcnt(6)
  v_mfma_f32_32x32x16_bf16 v[100:115], v[16:19], v[76:79], v[100:115]
  ds_read_b64_tr_b16 v[32:33], v4 offset:6144
  ds_read_b64_tr_b16 v[34:35], v4 offset:7168
  s_waitcnt lgkmcnt(6)
  v_mfma_f32_32x32x16_bf16 v[116:131], v[20:23], v[76:79], v[116:131]
  ds_read_b64_tr_b16 v[36:37], v6 offset:6144
  ds_read_b64_tr_b16 v[38:39], v6 offset:7168
  s_add_u32 m0, s29, 40960
  s_mov_b32 s30, 655360
  buffer_load_dwordx4 v3, s[12:15], s30 offen lds
  s_add_u32 s28, s27, 12288
  buffer_load_dwordx4 v[64:67], v2, s[8:11], s28 offen offset:0
  buffer_load_dwordx4 v[68:71], v2, s[8:11], s28 offen offset:1024
  s_waitcnt vmcnt(15)
  s_waitcnt lgkmcnt(6)
  v_mfma_f32_32x32x16_bf16 v[100:115], v[24:27], v[80:83], v[100:115]
  ds_read_b64_tr_b16 v[8:9], v4 offset:8192
  ds_read_b64_tr_b16 v[10:11], v4 offset:9216
  s_waitcnt lgkmcnt(6)
  v_mfma_f32_32x32x16_bf16 v[116:131], v[28:31], v[80:83], v[116:131]
  ds_read_b64_tr_b16 v[12:13], v6 offset:8192
  ds_read_b64_tr_b16 v[14:15], v6 offset:9216
  s_waitcnt lgkmcnt(6)
  v_mfma_f32_32x32x16_bf16 v[100:115], v[32:35], v[84:87], v[100:115]
  ds_read_b64_tr_b16 v[16:17], v4 offset:10240
  ds_read_b64_tr_b16 v[18:19], v4 offset:11264
  s_waitcnt lgkmcnt(6)
  v_mfma_f32_32x32x16_bf16 v[116:131], v[36:39], v[84:87], v[116:131]
  ds_read_b64_tr_b16 v[20:21], v6 offset:10240
  ds_read_b64_tr_b16 v[22:23], v6 offset:11264
  s_add_u32 m0, s29, 45056
  s_mov_b32 s30, 720896
  buffer_load_dwordx4 v3, s[12:15], s30 offen lds
  s_add_u32 s28, s27, 14336
  buffer_load_dwordx4 v[72:75], v2, s[8:11], s28 offen offset:0
  buffer_load_dwordx4 v[76:79], v2, s[8:11], s28 offen offset:1024
  s_waitcnt vmcnt(15)
  s_waitcnt lgkmcnt(6)
  v_mfma_f32_32x32x16_bf16 v[100:115], v[8:11], v[88:91], v[100:115]
  ds_read_b64_tr_b16 v[24:25], v4 offset:12288
  ds_read_b64_tr_b16 v[26:27], v4 offset:13312
  s_waitcnt lgkmcnt(6)
  v_mfma_f32_32x32x16_bf16 v[116:131], v[12:15], v[88:91], v[116:131]
  ds_read_b64_tr_b16 v[28:29], v6 offset:12288
  ds_read_b64_tr_b16 v[30:31], v6 offset:13312
  s_waitcnt lgkmcnt(6)
  v_mfma_f32_32x32x16_bf16 v[100:115], v[16:19], v[92:95], v[100:115]
  ds_read_b64_tr_b16 v[32:33], v4 offset:14336
  ds_read_b64_tr_b16 v[34:35], v4 offset:15360
  s_waitcnt lgkmcnt(6)
  v_mfma_f32_32x32x16_bf16 v[116:131], v[20:23], v[92:95], v[116:131]
  ds_read_b64_tr_b16 v[36:37], v6 offset:14336
  ds_read_b64_tr_b16 v[38:39], v6 offset:15360
  s_add_u32 m0, s29, 49152
  s_mov_b32 s30, 786432
  buffer_load_dwordx4 v3, s[12:15], s30 offen lds
  s_add_u32 s28, s27, 16384
  buffer_load_dwordx4 v[80:83], v2, s[8:11], s28 offen offset:0
  buffer_load_dwordx4 v[84:87], v2, s[8:11], s28 offen offset:1024
  s_waitcnt vmcnt(17)
  s_barrier
  s_waitcnt vmcnt(15)
  s_waitcnt lgkmcnt(6)
  v_mfma_f32_32x32x16_bf16 v[100:115], v[24:27], v[40:43], v[100:115]
  ds_read_b64_tr_b16 v[8:9], v4 offset:16384
  ds_read_b64_tr_b16 v[10:11], v4 offset:17408
  s_waitcnt lgkmcnt(6)
  v_mfma_f32_32x32x16_bf16 v[116:131], v[28:31], v[40:43], v[116:131]
  ds_read_b64_tr_b16 v[12:13], v6 offset:16384
  ds_read_b64_tr_b16 v[14:15], v6 offset:17408
  s_waitcnt lgkmcnt(6)
  v_mfma_f32_32x32x16_bf16 v[100:115], v[32:35], v[44:47], v[100:115]
  ds_read_b64_tr_b16 v[16:17], v4 offset:18432
  ds_read_b64_tr_b16 v[18:19], v4 offset:19456
  s_waitcnt lgkmcnt(6)
  v_mfma_f32_32x32x16_bf16 v[116:131], v[36:39], v[44:47], v[116:131]
  ds_read_b64_tr_b16 v[20:21], v6 offset:18432
  ds_read_b64_tr_b16 v[22:23], v6 offset:19456
  s_add_u32 m0, s29, 53248
  s_mov_b32 s30, 851968
  buffer_load_dwordx4 v3, s[12:15], s30 offen lds
  s_add_u32 s28, s27, 18432
  buffer_load_dwordx4 v[88:91], v2, s[8:11], s28 offen offset:0
  buffer_load_dwordx4 v[92:95], v2, s[8:11], s28 offen offset:1024
  s_waitcnt vmcnt(15)
  s_waitcnt lgkmcnt(6)
  v_mfma_f32_32x32x16_bf16 v[100:115], v[8:11], v[48:51], v[100:115]
  ds_read_b64_tr_b16 v[24:25], v4 offset:20480
  ds_read_b64_tr_b16 v[26:27], v4 offset:21504
  s_waitcnt lgkmcnt(6)
  v_mfma_f32_32x32x16_bf16 v[116:131], v[12:15], v[48:51], v[116:131]
  ds_read_b64_tr_b16 v[28:29], v6 offset:20480
  ds_read_b64_tr_b16 v[30:31], v6 offset:21504
  s_waitcnt lgkmcnt(6)
  v_mfma_f32_32x32x16_bf16 v[100:115], v[16:19], v[52:55], v[100:115]
  ds_read_b64_tr_b16 v[32:33], v4 offset:22528
  ds_read_b64_tr_b16 v[34:35], v4 offset:23552
  s_waitcnt lgkmcnt(6)
  v_mfma_f32_32x32x16_bf16 v[116:131], v[20:23], v[52:55], v[116:131]
  ds_read_b64_tr_b16 v[36:37], v6 offset:22528
  ds_read_b64_tr_b16 v[38:39], v6 offset:23552
  s_add_u32 m0, s29, 57344
  s_mov_b32 s30, 917504
  buffer_load_dwordx4 v3, s[12:15], s30 offen lds
  s_add_u32 s28, s27, 20480
  buffer_load_dwordx4 v[40:43], v2, s[8:11], s28 offen offset:0
  buffer_load_dwordx4 v[44:47], v2, s[8:11], s28 offen offset:1024
  s_waitcnt vmcnt(15)
  s_waitcnt lgkmcnt(6)
  v_mfma_f32_32x32x16_bf16 v[100:115], v[24:27], v[56:59], v[100:115]
  ds_read_b64_tr_b16 v[8:9], v4 offset:24576
  ds_read_b64_tr_b16 v[10:11], v4 offset:25600
  s_waitcnt lgkmcnt(6)
  v_mfma_f32_32x32x16_bf16 v[116:131], v[28:31], v[56:59], v[116:131]
  ds_read_b64_tr_b16 v[12:13], v6 offset:24576
  ds_read_b64_tr_b16 v[14:15], v6 offset:25600
  s_waitcnt lgkmcnt(6)
  v_mfma_f32_32x32x16_bf16 v[100:115], v[32:35], v[60:63], v[100:115]
  ds_read_b64_tr_b16 v[16:17], v4 offset:26624
  ds_read_b64_tr_b16 v[18:19], v4 offset:27648
  s_waitcnt lgkmcnt(6)
  v_mfma_f32_32x32x16_bf16 v[116:131], v[36:39], v[60:63], v[116:131]
  ds_read_b64_tr_b16 v[20:21], v6 offset:26624
  ds_read_b64_tr_b16 v[22:23], v6 offset:27648
  s_add_u32 m0, s29, 61440
  s_mov_b32 s30, 983040
  buffer_load_dwordx4 v3, s[12:15], s30 offen lds
  s_add_u32 s28, s27, 22528
  buffer_load_dwordx4 v[48:51], v2, s[8:11], s28 offen offset:0
  buffer_load_dwordx4 v[52:55], v2, s[8:11], s28 offen offset:1024
  s_waitcnt vmcnt(15)
  s_waitcnt lgkmcnt(6)
  v_mfma_f32_32x32x16_bf16 v[100:115], v[8:11], v[64:67], v[100:115]
  ds_read_b64_tr_b16 v[24:25], v4 offset:28672
  ds_read_b64_tr_b16 v[26:27], v4 offset:29696
  s_waitcnt lgkmcnt(6)
  v_mfma_f32_32x32x16_bf16 v[116:131], v[12:15], v[64:67], v[116:131]
  ds_read_b64_tr_b16 v[28:29], v6 offset:28672
  ds_read_b64_tr_b16 v[30:31], v6 offset:29696
  s_waitcnt lgkmcnt(6)
  v_mfma_f32_32x32x16_bf16 v[100:115], v[16:19], v[68:71], v[100:115]
  ds_read_b64_tr_b16 v[32:33], v4 offset:30720
  ds_read_b64_tr_b16 v[34:35], v4 offset:31744
  s_waitcnt lgkmcnt(6)
  v_mfma_f32_32x32x16_bf16 v[116:131], v[20:23], v[68:71], v[116:131]
  ds_read_b64_tr_b16 v[36:37], v6 offset:30720
  ds_read_b64_tr_b16 v[38:39], v6 offset:31744
  s_add_u32 m0, s29, 0
  s_mov_b32 s30, 1048576
  buffer_load_dwordx4 v3, s[12:15], s30 offen lds
  s_add_u32 s28, s27, 24576
  buffer_load_dwordx4 v[56:59], v2, s[8:11], s28 offen offset:0
  buffer_load_dwordx4 v[60:63], v2, s[8:11], s28 offen offset:1024
  s_waitcnt vmcnt(17)
  s_barrier
  s_waitcnt vmcnt(15)
  s_waitcnt lgkmcnt(6)
  v_mfma_f32_32x32x16_bf16 v[100:115], v[24:27], v[72:75], v[100:115]
  ds_read_b64_tr_b16 v[8:9], v4 offset:32768
  ds_read_b64_tr_b16 v[10:11], v4 offset:33792
  s_waitcnt lgkmcnt(6)
  v_mfma_f32_32x32x16_bf16 v[116:131], v[28:31], v[72:75], v[116:131]
  ds_read_b64_tr_b16 v[12:13], v6 offset:32768
  ds_read_b64_tr_b16 v[14:15], v6 offset:33792
  s_waitcnt lgkmcnt(6)
  v_mfma_f32_32x32x16_bf16 v[100:115], v[32:35], v[76:79], v[100:115]
  ds_read_b64_tr_b16 v[16:17], v4 offset:34816
  ds_read_b64_tr_b16 v[18:19], v4 offset:35840
  s_waitcnt lgkmcnt(6)
  v_mfma_f32_32x32x16_bf16 v[116:131], v[36:39], v[76:79], v[116:131]
  ds_read_b64_tr_b16 v[20:21], v6 offset:34816
  ds_read_b64_tr_b16 v[22:23], v6 offset:35840
  s_add_u32 m0, s29, 4096
  s_mov_b32 s30, 1114112
  buffer_load_dwordx4 v3, s[12:15], s30 offen lds
  s_add_u32 s28, s27, 26624
  buffer_load_dwordx4 v[64:67], v2, s[8:11], s28 offen offset:0
  buffer_load_dwordx4 v[68:71], v2, s[8:11], s28 offen offset:1024
  s_waitcnt vmcnt(15)
  s_waitcnt lgkmcnt(6)
  v_mfma_f32_32x32x16_bf16 v[100:115], v[8:11], v[80:83], v[100:115]
  ds_read_b64_tr_b16 v[24:25], v4 offset:36864
  ds_read_b64_tr_b16 v[26:27], v4 offset:37888
  s_waitcnt lgkmcnt(6)
  v_mfma_f32_32x32x16_bf16 v[116:131], v[12:15], v[80:83], v[116:131]
  ds_read_b64_tr_b16 v[28:29], v6 offset:36864
  ds_read_b64_tr_b16 v[30:31], v6 offset:37888
  s_waitcnt lgkmcnt(6)
  v_mfma_f32_32x32x16_bf16 v[100:115], v[16:19], v[84:87], v[100:115]
  ds_read_b64_tr_b16 v[32:33], v4 offset:38912
  ds_read_b64_tr_b16 v[34:35], v4 offset:39936
  s_waitcnt lgkmcnt(6)
  v_mfma_f32_32x32x16_bf16 v[116:131], v[20:23], v[84:87], v[116:131]
  ds_read_b64_tr_b16 v[36:37], v6 offset:38912
  ds_read_b64_tr_b16 v[38:39], v6 offset:39936
  s_add_u32 m0, s29, 8192
  s_mov_b32 s30, 1179648
  buffer_load_dwordx4 v3, s[12:15], s30 offen lds
  s_add_u32 s28, s27, 28672
  buffer_load_dwordx4 v[72:75], v2, s[8:11], s28 offen offset:0
  buffer_load_dwordx4 v[76:79], v2, s[8:11], s28 offen offset:1024
  s_waitcnt vmcnt(15)
  s_waitcnt lgkmcnt(6)
  v_mfma_f32_32x32x16_bf16 v[100:115], v[24:27], v[88:91], v[100:115]
  ds_read_b64_tr_b16 v[8:9], v4 offset:40960
  ds_read_b64_tr_b16 v[10:11], v4 offset:41984
  s_waitcnt lgkmcnt(6)
  v_mfma_f32_32x32x16_bf16 v[116:131], v[28:31], v[88:91], v[116:131]
  ds_read_b64_tr_b16 v[12:13], v6 offset:40960
  ds_read_b64_tr_b16 v[14:15], v6 offset:41984
  s_waitcnt lgkmcnt(6)
  v_mfma_f32_32x32x16_bf16 v[100:115], v[32:35], v[92:95], v[100:115]
  ds_read_b64_tr_b16 v[16:17], v4 offset:43008
  ds_read_b64_tr_b16 v[18:19], v4 offset:44032
  s_waitcnt lgkmcnt(6)
  v_mfma_f32_32x32x16_bf16 v[116:131], v[36:39], v[92:95], v[116:131]
  ds_read_b64_tr_b16 v[20:21], v6 offset:43008
  ds_read_b64_tr_b16 v[22:23], v6 offset:44032
  s_add_u32 m0, s29, 12288
  s_mov_b32 s30, 1245184
  buffer_load_dwordx4 v3, s[12:15], s30 offen lds
  s_add_u32 s28, s27, 30720
  buffer_load_dwordx4 v[80:83], v2, s[8:11], s28 offen offset:0
  buffer_load_dwordx4 v[84:87], v2, s[8:11], s28 offen offset:1024
  s_waitcnt vmcnt(15)
  s_waitcnt lgkmcnt(6)
  v_mfma_f32_32x32x16_bf16 v[100:115], v[8:11], v[40:43], v[100:115]
  ds_read_b64_tr_b16 v[24:25], v4 offset:45056
  ds_read_b64_tr_b16 v[26:27], v4 offset:46080
  s_waitcnt lgkmcnt(6)
  v_mfma_f32_32x32x16_bf16 v[116:131], v[12:15], v[40:43], v[116:131]
  ds_read_b64_tr_b16 v[28:29], v6 offset:45056
  ds_read_b64_tr_b16 v[30:31], v6 offset:46080
  s_waitcnt lgkmcnt(6)
  v_mfma_f32_32x32x16_bf16 v[100:115], v[16:19], v[44:47], v[100:115]
  ds_read_b64_tr_b16 v[32:33], v4 offset:47104
  ds_read_b64_tr_b16 v[34:35], v4 offset:48128
  s_waitcnt lgkmcnt(6)
  v_mfma_f32_32x32x16_bf16 v[116:131], v[20:23], v[44:47], v[116:131]
  ds_read_b64_tr_b16 v[36:37], v6 offset:47104
  ds_read_b64_tr_b16 v[38:39], v6 offset:48128
  s_add_u32 m0, s29, 16384
  s_mov_b32 s30, 1310720
  buffer_load_dwordx4 v3, s[12:15], s30 offen lds
  s_add_u32 s28, s27, 32768
  buffer_load_dwordx4 v[88:91], v2, s[8:11], s28 offen offset:0
  buffer_load_dwordx4 v[92:95], v2, s[8:11], s28 offen offset:1024
  s_waitcnt vmcnt(17)
  s_barrier
  s_waitcnt vmcnt(15)
  s_waitcnt lgkmcnt(6)
  v_mfma_f32_32x32x16_bf16 v[100:115], v[24:27], v[48:51], v[100:115]
  ds_read_b64_tr_b16 v[8:9], v4 offset:49152
  ds_read_b64_tr_b16 v[10:11], v4 offset:50176
  s_waitcnt lgkmcnt(6)
  v_mfma_f32_32x32x16_bf16 v[116:131], v[28:31], v[48:51], v[116:131]
  ds_read_b64_tr_b16 v[12:13], v6 offset:49152
  ds_read_b64_tr_b16 v[14:15], v6 offset:50176
  s_waitcnt lgkmcnt(6)
  v_mfma_f32_32x32x16_bf16 v[100:115], v[32:35], v[52:55], v[100:115]
  ds_read_b64_tr_b16 v[16:17], v4 offset:51200
  ds_read_b64_tr_b16 v[18:19], v4 offset:52224
  s_waitcnt lgkmcnt(6)
  v_mfma_f32_32x32x16_bf16 v[116:131], v[36:39], v[52:55], v[116:131]
  ds_read_b64_tr_b16 v[20:21], v6 offset:51200
  ds_read_b64_tr_b16 v[22:23], v6 offset:52224
  s_add_u32 m0, s29, 20480
  s_mov_b32 s30, 1376256
  buffer_load_dwordx4 v3, s[12:15], s30 offen lds
  s_add_u32 s28, s27, 34816
  buffer_load_dwordx4 v[40:43], v2, s[8:11], s28 offen offset:0
  buffer_load_dwordx4 v[44:47], v2, s[8:11], s28 offen offset:1024
  s_waitcnt vmcnt(15)
  s_waitcnt lgkmcnt(6)
  v_mfma_f32_32x32x16_bf16 v[100:115], v[8:11], v[56:59], v[100:115]
  ds_read_b64_tr_b16 v[24:25], v4 offset:53248
  ds_read_b64_tr_b16 v[26:27], v4 offset:54272
  s_waitcnt lgkmcnt(6)
  v_mfma_f32_32x32x16_bf16 v[116:131], v[12:15], v[56:59], v[116:131]
  ds_read_b64_tr_b16 v[28:29], v6 offset:53248
  ds_read_b64_tr_b16 v[30:31], v6 offset:54272
  s_waitcnt lgkmcnt(6)
  v_mfma_f32_32x32x16_bf16 v[100:115], v[16:19], v[60:63], v[100:115]
  ds_read_b64_tr_b16 v[32:33], v4 offset:55296
  ds_read_b64_tr_b16 v[34:35], v4 offset:56320
  s_waitcnt lgkmcnt(6)
  v_mfma_f32_32x32x16_bf16 v[116:131], v[20:23], v[60:63], v[116:131]
  ds_read_b64_tr_b16 v[36:37], v6 offset:55296
  ds_read_b64_tr_b16 v[38:39], v6 offset:56320
  s_add_u32 m0, s29, 24576
  s_mov_b32 s30, 1441792
  buffer_load_dwordx4 v3, s[12:15], s30 offen lds
  s_add_u32 s28, s27, 36864
  buffer_load_dwordx4 v[48:51], v2, s[8:11], s28 offen offset:0
  buffer_load_dwordx4 v[52:55], v2, s[8:11], s28 offen offset:1024
  s_waitcnt vmcnt(15)
  s_waitcnt lgkmcnt(6)
  v_mfma_f32_32x32x16_bf16 v[100:115], v[24:27], v[64:67], v[100:115]
  ds_read_b64_tr_b16 v[8:9], v4 offset:57344
  ds_read_b64_tr_b16 v[10:11], v4 offset:58368
  s_waitcnt lgkmcnt(6)
  v_mfma_f32_32x32x16_bf16 v[116:131], v[28:31], v[64:67], v[116:131]
  ds_read_b64_tr_b16 v[12:13], v6 offset:57344
  ds_read_b64_tr_b16 v[14:15], v6 offset:58368
  s_waitcnt lgkmcnt(6)
  v_mfma_f32_32x32x16_bf16 v[100:115], v[32:35], v[68:71], v[100:115]
  ds_read_b64_tr_b16 v[16:17], v4 offset:59392
  ds_read_b64_tr_b16 v[18:19], v4 offset:60416
  s_waitcnt lgkmcnt(6)
  v_mfma_f32_32x32x16_bf16 v[116:131], v[36:39], v[68:71], v[116:131]
  ds_read_b64_tr_b16 v[20:21], v6 offset:59392
  ds_read_b64_tr_b16 v[22:23], v6 offset:60416
  s_add_u32 m0, s29, 28672
  s_mov_b32 s30, 1507328
  buffer_load_dwordx4 v3, s[12:15], s30 offen lds
  s_add_u32 s28, s27, 38912
  buffer_load_dwordx4 v[56:59], v2, s[8:11], s28 offen offset:0
  buffer_load_dwordx4 v[60:63], v2, s[8:11], s28 offen offset:1024
  s_waitcnt vmcnt(15)
  s_waitcnt lgkmcnt(6)
  v_mfma_f32_32x32x16_bf16 v[100:115], v[8:11], v[72:75], v[100:115]
  ds_read_b64_tr_b16 v[24:25], v4 offset:61440
  ds_read_b64_tr_b16 v[26:27], v4 offset:62464
  s_waitcnt lgkmcnt(6)
  v_mfma_f32_32x32x16_bf16 v[116:131], v[12:15], v[72:75], v[116:131]
  ds_read_b64_tr_b16 v[28:29], v6 offset:61440
  ds_read_b64_tr_b16 v[30:31], v6 offset:62464
  s_waitcnt lgkmcnt(6)
  v_mfma_f32_32x32x16_bf16 v[100:115], v[16:19], v[76:79], v[100:115]
  ds_read_b64_tr_b16 v[32:33], v4 offset:63488
  ds_read_b64_tr_b16 v[34:35], v4 offset:64512
  s_waitcnt lgkmcnt(6)
  v_mfma_f32_32x32x16_bf16 v[116:131], v[20:23], v[76:79], v[116:131]
  ds_read_b64_tr_b16 v[36:37], v6 offset:63488
  ds_read_b64_tr_b16 v[38:39], v6 offset:64512
  s_add_u32 m0, s29, 32768
  s_mov_b32 s30, 1572864
  buffer_load_dwordx4 v3, s[12:15], s30 offen lds
  s_add_u32 s28, s27, 40960
  buffer_load_dwordx4 v[64:67], v2, s[8:11], s28 offen offset:0
  buffer_load_dwordx4 v[68:71], v2, s[8:11], s28 offen offset:1024
  s_waitcnt vmcnt(17)
  s_barrier
  s_waitcnt vmcnt(15)
  s_waitcnt lgkmcnt(6)
  v_mfma_f32_32x32x16_bf16 v[100:115], v[24:27], v[80:83], v[100:115]
  ds_read_b64_tr_b16 v[8:9], v4 offset:0
  ds_read_b64_tr_b16 v[10:11], v4 offset:1024
  s_waitcnt lgkmcnt(6)
  v_mfma_f32_32x32x16_bf16 v[116:131], v[28:31], v[80:83], v[116:131]
  ds_read_b64_tr_b16 v[12:13], v6 offset:0
  ds_read_b64_tr_b16 v[14:15], v6 offset:1024
  s_waitcnt lgkmcnt(6)
  v_mfma_f32_32x32x16_bf16 v[100:115], v[32:35], v[84:87], v[100:115]
  ds_read_b64_tr_b16 v[16:17], v4 offset:2048
  ds_read_b64_tr_b16 v[18:19], v4 offset:3072
  s_waitcnt lgkmcnt(6)
  v_mfma_f32_32x32x16_bf16 v[116:131], v[36:39], v[84:87], v[116:131]
  ds_read_b64_tr_b16 v[20:21], v6 offset:2048
  ds_read_b64_tr_b16 v[22:23], v6 offset:3072
  s_add_u32 m0, s29, 36864
  s_mov_b32 s30, 1638400
  buffer_load_dwordx4 v3, s[12:15], s30 offen lds
  s_add_u32 s28, s27, 43008
  buffer_load_dwordx4 v[72:75], v2, s[8:11], s28 offen offset:0
  buffer_load_dwordx4 v[76:79], v2, s[8:11], s28 offen offset:1024
  s_waitcnt vmcnt(15)
  s_waitcnt lgkmcnt(6)
  v_mfma_f32_32x32x16_bf16 v[100:115], v[8:11], v[88:91], v[100:115]
  ds_read_b64_tr_b16 v[24:25], v4 offset:4096
  ds_read_b64_tr_b16 v[26:27], v4 offset:5120
  s_waitcnt lgkmcnt(6)
  v_mfma_f32_32x32x16_bf16 v[116:131], v[12:15], v[88:91], v[116:131]
  ds_read_b64_tr_b16 v[28:29], v6 offset:4096
  ds_read_b64_tr_b16 v[30:31], v6 offset:5120
  s_waitcnt lgkmcnt(6)
  v_mfma_f32_32x32x16_bf16 v[100:115], v[16:19], v[92:95], v[100:115]
  ds_read_b64_tr_b16 v[32:33], v4 offset:6144
  ds_read_b64_tr_b16 v[34:35], v4 offset:7168
  s_waitcnt lgkmcnt(6)
  v_mfma_f32_32x32x16_bf16 v[116:131], v[20:23], v[92:95], v[116:131]
  ds_read_b64_tr_b16 v[36:37], v6 offset:6144
  ds_read_b64_tr_b16 v[38:39], v6 offset:7168
  s_add_u32 m0, s29, 40960
  s_mov_b32 s30, 1703936
  buffer_load_dwordx4 v3, s[12:15], s30 offen lds
  s_add_u32 s28, s27, 45056
  buffer_load_dwordx4 v[80:83], v2, s[8:11], s28 offen offset:0
  buffer_load_dwordx4 v[84:87], v2, s[8:11], s28 offen offset:1024
  s_waitcnt vmcnt(15)
  s_waitcnt lgkmcnt(6)
  v_mfma_f32_32x32x16_bf16 v[100:115], v[24:27], v[40:43], v[100:115]
  ds_read_b64_tr_b16 v[8:9], v4 offset:8192
  ds_read_b64_tr_b16 v[10:11], v4 offset:9216
  s_waitcnt lgkmcnt(6)
  v_mfma_f32_32x32x16_bf16 v[116:131], v[28:31], v[40:43], v[116:131]
  ds_read_b64_tr_b16 v[12:13], v6 offset:8192
  ds_read_b64_tr_b16 v[14:15], v6 offset:9216
  s_waitcnt lgkmcnt(6)
  v_mfma_f32_32x32x16_bf16 v[100:115], v[32:35], v[44:47], v[100:115]
  ds_read_b64_tr_b16 v[16:17], v4 offset:10240
  ds_read_b64_tr_b16 v[18:19], v4 offset:11264
  s_waitcnt lgkmcnt(6)
  v_mfma_f32_32x32x16_bf16 v[116:131], v[36:39], v[44:47], v[116:131]
  ds_read_b64_tr_b16 v[20:21], v6 offset:10240
  ds_read_b64_tr_b16 v[22:23], v6 offset:11264
  s_add_u32 m0, s29, 45056
  s_mov_b32 s30, 1769472
  buffer_load_dwordx4 v3, s[12:15], s30 offen lds
  s_add_u32 s28, s27, 47104
  buffer_load_dwordx4 v[88:91], v2, s[8:11], s28 offen offset:0
  buffer_load_dwordx4 v[92:95], v2, s[8:11], s28 offen offset:1024
  s_waitcnt vmcnt(15)
  s_waitcnt lgkmcnt(6)
  v_mfma_f32_32x32x16_bf16 v[100:115], v[8:11], v[48:51], v[100:115]
  ds_read_b64_tr_b16 v[24:25], v4 offset:12288
  ds_read_b64_tr_b16 v[26:27], v4 offset:13312
  s_waitcnt lgkmcnt(6)
  v_mfma_f32_32x32x16_bf16 v[116:131], v[12:15], v[48:51], v[116:131]
  ds_read_b64_tr_b16 v[28:29], v6 offset:12288
  ds_read_b64_tr_b16 v[30:31], v6 offset:13312
  s_waitcnt lgkmcnt(6)
  v_mfma_f32_32x32x16_bf16 v[100:115], v[16:19], v[52:55], v[100:115]
  ds_read_b64_tr_b16 v[32:33], v4 offset:14336
  ds_read_b64_tr_b16 v[34:35], v4 offset:15360
  s_waitcnt lgkmcnt(6)
  v_mfma_f32_32x32x16_bf16 v[116:131], v[20:23], v[52:55], v[116:131]
  ds_read_b64_tr_b16 v[36:37], v6 offset:14336
  ds_read_b64_tr_b16 v[38:39], v6 offset:15360
  s_add_u32 m0, s29, 49152
  s_mov_b32 s30, 1835008
  buffer_load_dwordx4 v3, s[12:15], s30 offen lds
  s_add_u32 s28, s27, 49152
  buffer_load_dwordx4 v[40:43], v2, s[8:11], s28 offen offset:0
  buffer_load_dwordx4 v[44:47], v2, s[8:11], s28 offen offset:1024
  s_waitcnt vmcnt(17)
  s_barrier
  s_waitcnt vmcnt(15)
  s_waitcnt lgkmcnt(6)
  v_mfma_f32_32x32x16_bf16 v[100:115], v[24:27], v[56:59], v[100:115]
  ds_read_b64_tr_b16 v[8:9], v4 offset:16384
  ds_read_b64_tr_b16 v[10:11], v4 offset:17408
  s_waitcnt lgkmcnt(6)
  v_mfma_f32_32x32x16_bf16 v[116:131], v[28:31], v[56:59], v[116:131]
  ds_read_b64_tr_b16 v[12:13], v6 offset:16384
  ds_read_b64_tr_b16 v[14:15], v6 offset:17408
  s_waitcnt lgkmcnt(6)
  v_mfma_f32_32x32x16_bf16 v[100:115], v[32:35], v[60:63], v[100:115]
  ds_read_b64_tr_b16 v[16:17], v4 offset:18432
  ds_read_b64_tr_b16 v[18:19], v4 offset:19456
  s_waitcnt lgkmcnt(6)
  v_mfma_f32_32x32x16_bf16 v[116:131], v[36:39], v[60:63], v[116:131]
  ds_read_b64_tr_b16 v[20:21], v6 offset:18432
  ds_read_b64_tr_b16 v[22:23], v6 offset:19456
  s_add_u32 m0, s29, 53248
  s_mov_b32 s30, 1900544
  buffer_load_dwordx4 v3, s[12:15], s30 offen lds
  s_add_u32 s28, s27, 51200
  buffer_load_dwordx4 v[48:51], v2, s[8:11], s28 offen offset:0
  buffer_load_dwordx4 v[52:55], v2, s[8:11], s28 offen offset:1024
  s_waitcnt vmcnt(15)
  s_waitcnt lgkmcnt(6)
  v_mfma_f32_32x32x16_bf16 v[100:115], v[8:11], v[64:67], v[100:115]
  ds_read_b64_tr_b16 v[24:25], v4 offset:20480
  ds_read_b64_tr_b16 v[26:27], v4 offset:21504
  s_waitcnt lgkmcnt(6)
  v_mfma_f32_32x32x16_bf16 v[116:131], v[12:15], v[64:67], v[116:131]
  ds_read_b64_tr_b16 v[28:29], v6 offset:20480
  ds_read_b64_tr_b16 v[30:31], v6 offset:21504
  s_waitcnt lgkmcnt(6)
  v_mfma_f32_32x32x16_bf16 v[100:115], v[16:19], v[68:71], v[100:115]
  ds_read_b64_tr_b16 v[32:33], v4 offset:22528
  ds_read_b64_tr_b16 v[34:35], v4 offset:23552
  s_waitcnt lgkmcnt(6)
  v_mfma_f32_32x32x16_bf16 v[116:131], v[20:23], v[68:71], v[116:131]
  ds_read_b64_tr_b16 v[36:37], v6 offset:22528
  ds_read_b64_tr_b16 v[38:39], v6 offset:23552
  s_add_u32 m0, s29, 57344
  s_mov_b32 s30, 1966080
  buffer_load_dwordx4 v3, s[12:15], s30 offen lds
  s_add_u32 s28, s27, 53248
  buffer_load_dwordx4 v[56:59], v2, s[8:11], s28 offen offset:0
  buffer_load_dwordx4 v[60:63], v2, s[8:11], s28 offen offset:1024
  s_waitcnt vmcnt(15)
  s_waitcnt lgkmcnt(6)
  v_mfma_f32_32x32x16_bf16 v[100:115], v[24:27], v[72:75], v[100:115]
  ds_read_b64_tr_b16 v[8:9], v4 offset:24576
  ds_read_b64_tr_b16 v[10:11], v4 offset:25600
  s_waitcnt lgkmcnt(6)
  v_mfma_f32_32x32x16_bf16 v[116:131], v[28:31], v[72:75], v[116:131]
  ds_read_b64_tr_b16 v[12:13], v6 offset:24576
  ds_read_b64_tr_b16 v[14:15], v6 offset:25600
  s_waitcnt lgkmcnt(6)
  v_mfma_f32_32x32x16_bf16 v[100:115], v[32:35], v[76:79], v[100:115]
  ds_read_b64_tr_b16 v[16:17], v4 offset:26624
  ds_read_b64_tr_b16 v[18:19], v4 offset:27648
  s_waitcnt lgkmcnt(6)
  v_mfma_f32_32x32x16_bf16 v[116:131], v[36:39], v[76:79], v[116:131]
  ds_read_b64_tr_b16 v[20:21], v6 offset:26624
  ds_read_b64_tr_b16 v[22:23], v6 offset:27648
  s_add_u32 m0, s29, 61440
  s_mov_b32 s30, 2031616
  buffer_load_dwordx4 v3, s[12:15], s30 offen lds
  s_add_u32 s28, s27, 55296
  buffer_load_dwordx4 v[64:67], v2, s[8:11], s28 offen offset:0
  buffer_load_dwordx4 v[68:71], v2, s[8:11], s28 offen offset:1024
  s_waitcnt vmcnt(15)
  s_waitcnt lgkmcnt(6)
  v_mfma_f32_32x32x16_bf16 v[100:115], v[8:11], v[80:83], v[100:115]
  ds_read_b64_tr_b16 v[24:25], v4 offset:28672
  ds_read_b64_tr_b16 v[26:27], v4 offset:29696
  s_waitcnt lgkmcnt(6)
  v_mfma_f32_32x32x16_bf16 v[116:131], v[12:15], v[80:83], v[116:131]
  ds_read_b64_tr_b16 v[28:29], v6 offset:28672
  ds_read_b64_tr_b16 v[30:31], v6 offset:29696
  s_waitcnt lgkmcnt(6)
  v_mfma_f32_32x32x16_bf16 v[100:115], v[16:19], v[84:87], v[100:115]
  ds_read_b64_tr_b16 v[32:33], v4 offset:30720
  ds_read_b64_tr_b16 v[34:35], v4 offset:31744
  s_waitcnt lgkmcnt(6)
  v_mfma_f32_32x32x16_bf16 v[116:131], v[20:23], v[84:87], v[116:131]
  ds_read_b64_tr_b16 v[36:37], v6 offset:30720
  ds_read_b64_tr_b16 v[38:39], v6 offset:31744
  s_add_u32 s28, s27, 57344
  buffer_load_dwordx4 v[72:75], v2, s[8:11], s28 offen offset:0
  buffer_load_dwordx4 v[76:79], v2, s[8:11], s28 offen offset:1024
  s_waitcnt vmcnt(16)
  s_barrier
  s_waitcnt vmcnt(14)
  s_waitcnt lgkmcnt(6)
  v_mfma_f32_32x32x16_bf16 v[100:115], v[24:27], v[88:91], v[100:115]
  ds_read_b64_tr_b16 v[8:9], v4 offset:32768
  ds_read_b64_tr_b16 v[10:11], v4 offset:33792
  s_waitcnt lgkmcnt(6)
  v_mfma_f32_32x32x16_bf16 v[116:131], v[28:31], v[88:91], v[116:131]
  ds_read_b64_tr_b16 v[12:13], v6 offset:32768
  ds_read_b64_tr_b16 v[14:15], v6 offset:33792
  s_waitcnt lgkmcnt(6)
  v_mfma_f32_32x32x16_bf16 v[100:115], v[32:35], v[92:95], v[100:115]
  ds_read_b64_tr_b16 v[16:17], v4 offset:34816
  ds_read_b64_tr_b16 v[18:19], v4 offset:35840
  s_waitcnt lgkmcnt(6)
  v_mfma_f32_32x32x16_bf16 v[116:131], v[36:39], v[92:95], v[116:131]
  ds_read_b64_tr_b16 v[20:21], v6 offset:34816
  ds_read_b64_tr_b16 v[22:23], v6 offset:35840
  s_add_u32 s28, s27, 59392
  buffer_load_dwordx4 v[80:83], v2, s[8:11], s28 offen offset:0
  buffer_load_dwordx4 v[84:87], v2, s[8:11], s28 offen offset:1024
  s_waitcnt vmcnt(13)
  s_waitcnt lgkmcnt(6)
  v_mfma_f32_32x32x16_bf16 v[100:115], v[8:11], v[40:43], v[100:115]
  ds_read_b64_tr_b16 v[24:25], v4 offset:36864
  ds_read_b64_tr_b16 v[26:27], v4 offset:37888
  s_waitcnt lgkmcnt(6)
  v_mfma_f32_32x32x16_bf16 v[116:131], v[12:15], v[40:43], v[116:131]
  ds_read_b64_tr_b16 v[28:29], v6 offset:36864
  ds_read_b64_tr_b16 v[30:31], v6 offset:37888
  s_waitcnt lgkmcnt(6)
  v_mfma_f32_32x32x16_bf16 v[100:115], v[16:19], v[44:47], v[100:115]
  ds_read_b64_tr_b16 v[32:33], v4 offset:38912
  ds_read_b64_tr_b16 v[34:35], v4 offset:39936
  s_waitcnt lgkmcnt(6)
  v_mfma_f32_32x32x16_bf16 v[116:131], v[20:23], v[44:47], v[116:131]
  ds_read_b64_tr_b16 v[36:37], v6 offset:38912
  ds_read_b64_tr_b16 v[38:39], v6 offset:39936
  s_add_u32 s28, s27, 61440
  buffer_load_dwordx4 v[88:91], v2, s[8:11], s28 offen offset:0
  buffer_load_dwordx4 v[92:95], v2, s[8:11], s28 offen offset:1024
  s_waitcnt vmcnt(12)
  s_waitcnt lgkmcnt(6)
  v_mfma_f32_32x32x16_bf16 v[100:115], v[24:27], v[48:51], v[100:115]
  ds_read_b64_tr_b16 v[8:9], v4 offset:40960
  ds_read_b64_tr_b16 v[10:11], v4 offset:41984
  s_waitcnt lgkmcnt(6)
  v_mfma_f32_32x32x16_bf16 v[116:131], v[28:31], v[48:51], v[116:131]
  ds_read_b64_tr_b16 v[12:13], v6 offset:40960
  ds_read_b64_tr_b16 v[14:15], v6 offset:41984
  s_waitcnt lgkmcnt(6)
  v_mfma_f32_32x32x16_bf16 v[100:115], v[32:35], v[52:55], v[100:115]
  ds_read_b64_tr_b16 v[16:17], v4 offset:43008
  ds_read_b64_tr_b16 v[18:19], v4 offset:44032
  s_waitcnt lgkmcnt(6)
  v_mfma_f32_32x32x16_bf16 v[116:131], v[36:39], v[52:55], v[116:131]
  ds_read_b64_tr_b16 v[20:21], v6 offset:43008
  ds_read_b64_tr_b16 v[22:23], v6 offset:44032
  s_add_u32 s28, s27, 63488
  buffer_load_dwordx4 v[40:43], v2, s[8:11], s28 offen offset:0
  buffer_load_dwordx4 v[44:47], v2, s[8:11], s28 offen offset:1024
  s_waitcnt vmcnt(11)
  s_waitcnt lgkmcnt(6)
  v_mfma_f32_32x32x16_bf16 v[100:115], v[8:11], v[56:59], v[100:115]
  ds_read_b64_tr_b16 v[24:25], v4 offset:45056
  ds_read_b64_tr_b16 v[26:27], v4 offset:46080
  s_waitcnt lgkmcnt(6)
  v_mfma_f32_32x32x16_bf16 v[116:131], v[12:15], v[56:59], v[116:131]
  ds_read_b64_tr_b16 v[28:29], v6 offset:45056
  ds_read_b64_tr_b16 v[30:31], v6 offset:46080
  s_waitcnt lgkmcnt(6)
  v_mfma_f32_32x32x16_bf16 v[100:115], v[16:19], v[60:63], v[100:115]
  ds_read_b64_tr_b16 v[32:33], v4 offset:47104
  ds_read_b64_tr_b16 v[34:35], v4 offset:48128
  s_waitcnt lgkmcnt(6)
  v_mfma_f32_32x32x16_bf16 v[116:131], v[20:23], v[60:63], v[116:131]
  ds_read_b64_tr_b16 v[36:37], v6 offset:47104
  ds_read_b64_tr_b16 v[38:39], v6 offset:48128
  s_waitcnt vmcnt(10)
  s_barrier
  s_waitcnt vmcnt(8)
  s_waitcnt lgkmcnt(6)
  v_mfma_f32_32x32x16_bf16 v[100:115], v[24:27], v[64:67], v[100:115]
  ds_read_b64_tr_b16 v[8:9], v4 offset:49152
  ds_read_b64_tr_b16 v[10:11], v4 offset:50176
  s_waitcnt lgkmcnt(6)
  v_mfma_f32_32x32x16_bf16 v[116:131], v[28:31], v[64:67], v[116:131]
  ds_read_b64_tr_b16 v[12:13], v6 offset:49152
  ds_read_b64_tr_b16 v[14:15], v6 offset:50176
  s_waitcnt lgkmcnt(6)
  v_mfma_f32_32x32x16_bf16 v[100:115], v[32:35], v[68:71], v[100:115]
  ds_read_b64_tr_b16 v[16:17], v4 offset:51200
  ds_read_b64_tr_b16 v[18:19], v4 offset:52224
  s_waitcnt lgkmcnt(6)
  v_mfma_f32_32x32x16_bf16 v[116:131], v[36:39], v[68:71], v[116:131]
  ds_read_b64_tr_b16 v[20:21], v6 offset:51200
  ds_read_b64_tr_b16 v[22:23], v6 offset:52224
  s_waitcnt vmcnt(6)
  s_waitcnt lgkmcnt(6)
  v_mfma_f32_32x32x16_bf16 v[100:115], v[8:11], v[72:75], v[100:115]
  ds_read_b64_tr_b16 v[24:25], v4 offset:53248
  ds_read_b64_tr_b16 v[26:27], v4 offset:54272
  s_waitcnt lgkmcnt(6)
  v_mfma_f32_32x32x16_bf16 v[116:131], v[12:15], v[72:75], v[116:131]
  ds_read_b64_tr_b16 v[28:29], v6 offset:53248
  ds_read_b64_tr_b16 v[30:31], v6 offset:54272
  s_waitcnt lgkmcnt(6)
  v_mfma_f32_32x32x16_bf16 v[100:115], v[16:19], v[76:79], v[100:115]
  ds_read_b64_tr_b16 v[32:33], v4 offset:55296
  ds_read_b64_tr_b16 v[34:35], v4 offset:56320
  s_waitcnt lgkmcnt(6)
  v_mfma_f32_32x32x16_bf16 v[116:131], v[20:23], v[76:79], v[116:131]
  ds_read_b64_tr_b16 v[36:37], v6 offset:55296
  ds_read_b64_tr_b16 v[38:39], v6 offset:56320
  s_waitcnt vmcnt(4)
  s_waitcnt lgkmcnt(6)
  v_mfma_f32_32x32x16_bf16 v[100:115], v[24:27], v[80:83], v[100:115]
  ds_read_b64_tr_b16 v[8:9], v4 offset:57344
  ds_read_b64_tr_b16 v[10:11], v4 offset:58368
  s_waitcnt lgkmcnt(6)
  v_mfma_f32_32x32x16_bf16 v[116:131], v[28:31], v[80:83], v[116:131]
  ds_read_b64_tr_b16 v[12:13], v6 offset:57344
  ds_read_b64_tr_b16 v[14:15], v6 offset:58368
  s_waitcnt lgkmcnt(6)
  v_mfma_f32_32x32x16_bf16 v[100:115], v[32:35], v[84:87], v[100:115]
  ds_read_b64_tr_b16 v[16:17], v4 offset:59392
  ds_read_b64_tr_b16 v[18:19], v4 offset:60416
  s_waitcnt lgkmcnt(6)
  v_mfma_f32_32x32x16_bf16 v[116:131], v[36:39], v[84:87], v[116:131]
  ds_read_b64_tr_b16 v[20:21], v6 offset:59392
  ds_read_b64_tr_b16 v[22:23], v6 offset:60416
  s_waitcnt vmcnt(2)
  s_waitcnt lgkmcnt(6)
  v_mfma_f32_32x32x16_bf16 v[100:115], v[8:11], v[88:91], v[100:115]
  ds_read_b64_tr_b16 v[24:25], v4 offset:61440
  ds_read_b64_tr_b16 v[26:27], v4 offset:62464
  s_waitcnt lgkmcnt(6)
  v_mfma_f32_32x32x16_bf16 v[116:131], v[12:15], v[88:91], v[116:131]
  ds_read_b64_tr_b16 v[28:29], v6 offset:61440
  ds_read_b64_tr_b16 v[30:31], v6 offset:62464
  s_waitcnt lgkmcnt(6)
  v_mfma_f32_32x32x16_bf16 v[100:115], v[16:19], v[92:95], v[100:115]
  ds_read_b64_tr_b16 v[32:33], v4 offset:63488
  ds_read_b64_tr_b16 v[34:35], v4 offset:64512
  s_waitcnt lgkmcnt(6)
  v_mfma_f32_32x32x16_bf16 v[116:131], v[20:23], v[92:95], v[116:131]
  ds_read_b64_tr_b16 v[36:37], v6 offset:63488
  ds_read_b64_tr_b16 v[38:39], v6 offset:64512
  s_waitcnt vmcnt(0)
  s_waitcnt lgkmcnt(6)
  v_mfma_f32_32x32x16_bf16 v[100:115], v[24:27], v[40:43], v[100:115]
  s_waitcnt lgkmcnt(4)
  v_mfma_f32_32x32x16_bf16 v[116:131], v[28:31], v[40:43], v[116:131]
  s_waitcnt lgkmcnt(2)
  v_mfma_f32_32x32x16_bf16 v[100:115], v[32:35], v[44:47], v[100:115]
  s_waitcnt lgkmcnt(0)
  v_mfma_f32_32x32x16_bf16 v[116:131], v[36:39], v[44:47], v[116:131]
  s_lshl_b32 s32, s25, 2
  s_add_u32 s32, s32, s24
  s_lshl_b32 s32, s32, 16
  s_lshl_b32 s33, s26, 7
  s_add_u32 s32, s32, s33
  v_and_b32 v8, 31, v1
  v_lshlrev_b32 v8, 11, v8
  v_lshrrev_b32 v9, 5, v1
  v_lshlrev_b32 v9, 4, v9
  v_add_u32 v8, v8, v9
  s_nop 7
  v_cvt_pk_bf16_f32 v20, v100, v101
  v_cvt_pk_bf16_f32 v21, v102, v103
  v_cvt_pk_bf16_f32 v22, v104, v105
  v_cvt_pk_bf16_f32 v23, v106, v107
  s_nop 1
  v_permlane32_swap_b32 v20, v22
  v_permlane32_swap_b32 v21, v23
  s_nop 1
  buffer_store_dwordx4 v[20:23], v8, s[20:23], s32 offen offset:0
  v_cvt_pk_bf16_f32 v32, v108, v109
  v_cvt_pk_bf16_f32 v33, v110, v111
  v_cvt_pk_bf16_f32 v34, v112, v113
  v_cvt_pk_bf16_f32 v35, v114, v115
  s_nop 1
  v_permlane32_swap_b32 v32, v34
  v_permlane32_swap_b32 v33, v35
  s_nop 1
  buffer_store_dwordx4 v[32:35], v8, s[20:23], s32 offen offset:32
  v_cvt_pk_bf16_f32 v20, v116, v117
  v_cvt_pk_bf16_f32 v21, v118, v119
  v_cvt_pk_bf16_f32 v22, v120, v121
  v_cvt_pk_bf16_f32 v23, v122, v123
  s_nop 1
  v_permlane32_swap_b32 v20, v22
  v_permlane32_swap_b32 v21, v23
  s_nop 1
  buffer_store_dwordx4 v[20:23], v8, s[20:23], s32 offen offset:64
  v_cvt_pk_bf16_f32 v32, v124, v125
  v_cvt_pk_bf16_f32 v33, v126, v127
  v_cvt_pk_bf16_f32 v34, v128, v129
  v_cvt_pk_bf16_f32 v35, v130, v131
  s_nop 1
  v_permlane32_swap_b32 v32, v34
  v_permlane32_swap_b32 v33, v35
  s_nop 1
  buffer_store_dwordx4 v[32:35], v8, s[20:23], s32 offen offset:96
L_proj_kernel_end:
  s_endpgm
L_code_end:
.section .rodata,"a"
.p2align 6
.amdhsa_kernel proj_kernel
  .amdhsa_next_free_vgpr 132
  .amdhsa_next_free_sgpr 96
  .amdhsa_accum_offset 132
  .amdhsa_group_segment_fixed_size 0
  .amdhsa_kernarg_size 80
  .amdhsa_user_sgpr_count 2
  .amdhsa_user_sgpr_kernarg_segment_ptr 1
  .amdhsa_system_sgpr_workgroup_id_x 1
  .amdhsa_float_denorm_mode_32 3
.end_amdhsa_kernel
.text
```
